```python
import torch

def _softmax(x, axis=-1):
    return torch.softmax(x, dim=axis)

def _gelu(x):
    return torch.nn.functional.gelu(x, approximate='tanh')

def _silu(x):
    return torch.nn.functional.silu(x)

def _sigmoid(x):
    return torch.sigmoid(x)

def _layernorm(x, axis=-1, eps=1e-05):
    m = x.mean(dim=axis, keepdim=True)
    v = x.var(dim=axis, keepdim=True, unbiased=False)
    return (x - m) / torch.sqrt(v + eps)

def _scatter_add(tgt, idx, src, axis=0):
    return tgt.clone().index_add_(axis, idx, src)

def _segment_sum(src, seg, n):
    out = torch.zeros((n,) + src.shape[1:], dtype=src.dtype)
    return out.index_add_(0, seg, src)

def _pad(x, pw):
    flat = tuple((v for pair in reversed(pw) for v in pair))
    return torch.nn.functional.pad(x, flat)
kernel_name = 'adaLN_cond__spectral_fnet__dense_activation_relu__prompt'

def setup_inputs():

    _w = lambda a: (lambda t: t.to(torch.bfloat16) if t.is_floating_point() else t)(torch.as_tensor(a))

    def _A_setup():
        B, S, D = (1, 2048, 512)
        ns = torch.arange(S)[:, None] * torch.arange(S)[None, :]
        nd = torch.arange(D)[:, None] * torch.arange(D)[None, :]
        Ws_re = torch.cos(-2.0 * torch.pi * ns / S).to(float)
        Ws_im = torch.sin(-2.0 * torch.pi * ns / S).to(float)
        Wd_re = torch.cos(-2.0 * torch.pi * nd / D).to(float)
        Wd_im = torch.sin(-2.0 * torch.pi * nd / D).to(float)
        return {'x': _w((lambda *s: torch.randn(*s, dtype=torch.bfloat16) * 0.1)(B, S, D)), 'dft_seq_re': _w(Ws_re), 'dft_seq_im': _w(Ws_im), 'dft_hid_re': _w(Wd_re), 'dft_hid_im': _w(Wd_im)}
    _A_in = _A_setup()

    def _B_setup():
        B, S, D, Dff = (1, 2048, 512, 1376)
        return {'x': _w((lambda *s: torch.randn(*s, dtype=torch.bfloat16) * 0.1)(B, S, D)), 'w1': _w((lambda *s: torch.randn(*s, dtype=torch.bfloat16) * 3.2)(D, Dff)), 'w2': _w((lambda *s: torch.randn(*s, dtype=torch.bfloat16) * 3.2)(Dff, D))}
    _B_in = _B_setup()
    return {'A_x': _A_in['x'], 'A_dft_seq_re': _A_in['dft_seq_re'], 'A_dft_seq_im': _A_in['dft_seq_im'], 'A_dft_hid_re': _A_in['dft_hid_re'], 'A_dft_hid_im': _A_in['dft_hid_im'], 'B_x': _B_in['x'], 'B_w1': _B_in['w1'], 'B_w2': _B_in['w2'], 'c': _w((lambda *s: torch.randn(*s, dtype=torch.bfloat16) * 0.2)(1, 512) * 8.0), 'w_mod': _w((lambda *s: torch.randn(*s, dtype=torch.bfloat16) * 0.2)(512, 6 * 512) * 512 ** (-0.5) * 8.0)}

def reference(A_x, A_dft_seq_re, A_dft_seq_im, A_dft_hid_re, A_dft_hid_im, B_x, B_w1, B_w2, c, w_mod):

    def _A_ref(x, dft_seq_re, dft_seq_im, dft_hid_re, dft_hid_im):
        a = torch.einsum('bsd,ed->bse', x, dft_hid_re)
        b = torch.einsum('bsd,ed->bse', x, dft_hid_im)
        y = torch.einsum('ts,bse->bte', dft_seq_re, a) - torch.einsum('ts,bse->bte', dft_seq_im, b)
        return y

    def _B_ref(x, w1, w2):
        h = torch.einsum('bsd,df->bsf', x, w1)
        zero = torch.zeros_like(h)
        h = torch.maximum(h, zero)
        return torch.einsum('bsf,fd->bsd', h, w2)
    x = A_x
    mod = (_silu(c) @ w_mod).reshape(c.shape[0], 6, 1, -1)
    sa, ca, ga, sb, cb, gb = (mod[:, 0].clone(), mod[:, 1].clone(), mod[:, 2].clone(), mod[:, 3].clone(), mod[:, 4].clone(), mod[:, 5].clone())
    h = _layernorm(x, axis=-1) * (1 + ca) + sa
    x = x + ga * _A_ref(h, A_dft_seq_re, A_dft_seq_im, A_dft_hid_re, A_dft_hid_im)
    h = _layernorm(x, axis=-1) * (1 + cb) + sb
    x = x + gb * _B_ref(h, B_w1, B_w2)
    return x
```

```asm
; @launch grid=(256,1,1) block=(512,1,1) lds=163840
.amdgcn_target "amdgcn-amd-amdhsa--gfx950"
.text
.globl adaLN_cond__spectral_fnet__dense_activation_relu__prompt_kernel
.p2align 8
.type adaLN_cond__spectral_fnet__dense_activation_relu__prompt_kernel,@function
adaLN_cond__spectral_fnet__dense_activation_relu__prompt_kernel:
  s_cmp_ge_u32 s2, 256
  s_cbranch_scc1 ABORT
  s_load_dwordx16 s[64:79], s[0:1], 0
  s_load_dwordx8 s[80:87], s[0:1], 64
  s_load_dwordx2 s[88:89], s[0:1], 96
  v_lshrrev_b32 v2, 6, v0
  v_and_b32 v1, 63, v0
  v_readfirstlane_b32 s3, v2
  s_and_b32 s4, s2, 7
  s_lshr_b32 s5, s2, 3
  s_getpc_b64 s[44:45]
PCB:
  s_lshl_b32 s46, s3, 2
  s_add_u32 s46, s46, s5
  s_and_b32 s46, s46, 31
  s_lshl_b32 s46, s46, 12
  v_lshl_add_u32 v2, v1, 6, s46
  v_min_u32 v2, CODE_END-PCB-4, v2
  s_cmp_lt_u32 s3, 7
  s_cbranch_scc1 NOCPF
  global_load_dword v254, v2, s[44:45]
NOCPF:
  s_lshr_b32 s6, s5, 3
  s_bfe_u32 s7, s5, 0x10002
  s_and_b32 s8, s5, 3
  s_mov_b32 s95, 0
  s_mov_b32 s97, s8
  s_lshl_b32 s9, s4, 2
  s_add_u32 s9, s9, s6
  s_and_b32 s10, s5, 7
  s_lshr_b32 s11, s9, 1
  s_and_b32 s12, s5, 15
  s_lshl_b32 s96, s4, 5
  s_add_u32 s96, s96, s5
  s_mov_b32 s13, 0x40000
  s_getreg_b32 s16, hwreg(HW_REG_XCC_ID)
  s_and_b32 s16, s16, 15
  s_sub_u32 s44, s3, 4
  s_add_u32 s45, s44, 1
  s_cmp_lt_u32 s44, 2
  s_cselect_b32 s45, s45, 0
  v_lshlrev_b32 v2, 2, v0
  v_add_u32 v2, 157696, v2
  v_mov_b32 v3, s45
  ds_write_b32 v2, v3
  v_and_b32 v2, 0x1ff, v2
  v_add_u32 v2, 159744, v2
  v_mov_b32 v3, 0
  ds_write_b32 v2, v3
  s_cmp_lt_u32 s3, 4
  s_cbranch_scc1 CONS
  s_cmp_lt_u32 s3, 6
  s_cbranch_scc1 LHEAD
  s_memrealtime s[50:51]
  s_waitcnt lgkmcnt(0)
  s_mov_b32 s40, s86
  s_and_b32 s41, s87, 0xffff
  s_mov_b32 s42, 0x100
  s_mov_b32 s43, 0x00020000
  s_cmp_eq_u32 s3, 6
  s_cbranch_scc1 NOEL
  s_cmp_ge_u32 s2, 1
  s_cbranch_scc1 NOEP
  s_lshl_b64 s[50:51], s[50:51], 4
  s_or_b32 s51, s51, 0x80000000
  v_mov_b32 v12, s50
  v_mov_b32 v13, s51
  v_mov_b32 v14, 0
  v_mov_b32 v15, 0
  s_mov_b64 exec, 1
  buffer_store_dwordx2 v[12:13], v3, s[40:43], 0 offen sc1
  s_mov_b64 exec, -1
NOEP:
NOEL:
  s_barrier
  s_cmp_eq_u32 s3, 6
  s_cbranch_scc1 AUXW
  s_branch POLLER
LHEAD:
  v_lshrrev_b32 v42, 3, v1
  v_and_b32 v43, 7, v1
  v_lshrrev_b32 v44, 4, v1
  s_lshl_b32 s47, s9, 18
  s_lshl_b32 s45, s7, 11
  s_add_u32 s47, s47, s45
  s_add_u32 s44, s97, 0
  s_and_b32 s44, s44, 3
  s_mul_i32 s44, s44, 512
  s_add_u32 s56, s47, s44
  s_add_u32 s44, s97, 1
  s_and_b32 s44, s44, 3
  s_mul_i32 s44, s44, 512
  s_add_u32 s57, s47, s44
  s_add_u32 s44, s97, 2
  s_and_b32 s44, s44, 3
  s_mul_i32 s44, s44, 512
  s_add_u32 s58, s47, s44
  s_add_u32 s44, s97, 3
  s_and_b32 s44, s44, 3
  s_mul_i32 s44, s44, 512
  s_add_u32 s59, s47, s44
  v_xor_b32 v45, v43, v44
  v_xor_b32 v46, 4, v45
  v_lshlrev_b32 v45, 4, v45
  v_lshlrev_b32 v46, 4, v46
  v_lshl_add_u32 v8, v42, 12, v45
  v_lshl_add_u32 v9, v42, 12, v46
  v_add_u32 v9, 31744, v9
  v_add_u32 v10, 63488, v8
  v_add_u32 v11, 63488, v9
  s_sub_u32 s45, s3, 4
  s_lshl_b32 s47, s45, 14
  s_mov_b32 s45, s56
  s_cmp_eq_u32 s3, 4
  s_waitcnt lgkmcnt(0)
  s_cselect_b32 s54, s66, s68
  s_cselect_b32 s55, s67, s69
  s_mov_b32 s28, s54
  s_and_b32 s29, s55, 0xffff
  s_mov_b32 s30, 0x800000
  s_mov_b32 s31, 0x00020000
  v_lshlrev_b32 v47, 12, v1
  s_barrier
  s_add_u32 m0, s47, 0
  s_add_u32 s46, s45, 0
  buffer_load_dwordx4 v8, s[28:31], s46 offen offset:0 lds
  buffer_load_dwordx4 v9, s[28:31], s46 offen offset:1024 lds
  buffer_load_dwordx4 v10, s[28:31], s46 offen offset:2048 lds
  buffer_load_dwordx4 v11, s[28:31], s46 offen offset:3072 lds
  s_add_u32 m0, s47, 4096
  s_add_u32 s46, s45, 131072
  buffer_load_dwordx4 v8, s[28:31], s46 offen offset:0 lds
  buffer_load_dwordx4 v9, s[28:31], s46 offen offset:1024 lds
  buffer_load_dwordx4 v10, s[28:31], s46 offen offset:2048 lds
  buffer_load_dwordx4 v11, s[28:31], s46 offen offset:3072 lds
  s_add_u32 m0, s47, 8192
  s_add_u32 s46, s45, 128
  buffer_load_dwordx4 v8, s[28:31], s46 offen offset:0 lds
  buffer_load_dwordx4 v9, s[28:31], s46 offen offset:1024 lds
  buffer_load_dwordx4 v10, s[28:31], s46 offen offset:2048 lds
  buffer_load_dwordx4 v11, s[28:31], s46 offen offset:3072 lds
  s_add_u32 m0, s47, 12288
  s_add_u32 s46, s45, 131200
  buffer_load_dwordx4 v8, s[28:31], s46 offen offset:0 lds
  buffer_load_dwordx4 v9, s[28:31], s46 offen offset:1024 lds
  buffer_load_dwordx4 v10, s[28:31], s46 offen offset:2048 lds
  buffer_load_dwordx4 v11, s[28:31], s46 offen offset:3072 lds
  s_cmp_eq_u32 s3, 4
  s_cbranch_scc1 LOAD0
  s_branch LOAD1
ABORT:
  s_endpgm
CONS:
  v_lshlrev_b32 v32, 4, v1
  s_lshl_b32 s46, s96, 13
  s_lshl_b32 s44, s3, 11
  s_add_u32 s46, s46, s44
  v_mov_b32 v33, 0
  s_lshl_b32 s49, s3, 8
  s_add_u32 s49, s49, 157696
  v_lshl_add_u32 v30, v1, 2, s49
  s_waitcnt lgkmcnt(0)
  s_mov_b32 s28, s64
  s_and_b32 s29, s65, 0xffff
  s_mov_b32 s30, 0x200000
  s_mov_b32 s31, 0x00020000
  buffer_load_dwordx4 v[104:107], v32, s[28:31], s46 offen offset:0
  buffer_load_dwordx4 v[108:111], v32, s[28:31], s46 offen offset:1024
  s_barrier
  s_mov_b32 s20, s88
  s_and_b32 s21, s89, 0xffff
  s_mov_b32 s22, 0x1800000
  s_mov_b32 s23, 0x00020000
  s_add_u32 s24, s88, 0x1800000
  s_addc_u32 s25, s89, 0
  s_and_b32 s25, s25, 0xffff
  s_mov_b32 s26, 0x100000
  s_mov_b32 s27, 0x00020000
  s_mov_b32 s40, s86
  s_and_b32 s41, s87, 0xffff
  s_mov_b32 s42, 0x100
  s_mov_b32 s43, 0x00020000
  v_and_b32 v4, 15, v1
  v_lshrrev_b32 v5, 4, v1
  v_bfe_u32 v6, v1, 1, 3
  v_xor_b32 v6, v5, v6
  v_lshlrev_b32 v6, 4, v6
  v_lshl_add_u32 v6, v4, 7, v6
  v_xor_b32 v20, 0, v6
  v_add_u32 v22, 0x10000, v20
  v_add_u32 v24, 0x20000, v20
  v_xor_b32 v21, 64, v6
  v_add_u32 v23, 0x10000, v21
  v_add_u32 v25, 0x20000, v21
  v_and_b32 v29, 3, v1
  v_bfe_u32 v7, v1, 1, 1
  v_or_b32 v29, v7, v29
  v_mul_u32_u24 v29, 260, v29
  v_add_u32 v29, 158720, v29
  v_mov_b32 v34, 159488
  v_mov_b32 v31, 1
  v_lshlrev_b32 v35, 4, v5
  v_add_u32 v35, 157696, v35
  v_lshlrev_b32 v36, 2, v4
  v_add_u32 v36, 157696, v36
  v_lshlrev_b32 v2, 17, v5
  v_lshl_add_u32 v2, v4, 4, v2
  s_lshr_b32 s45, s96, 2
  s_lshl_b32 s46, s3, 19
  s_lshl_b32 s44, s45, 11
  s_add_u32 s46, s46, s44
  s_lshl_b32 s44, s8, 8
  s_add_u32 s46, s46, s44
  s_lshr_b32 s45, s96, 4
  s_lshl_b32 s50, s3, 12
  s_lshl_b32 s44, s45, 8
  s_add_u32 s50, s50, s44
  s_lshl_b32 s44, s12, 2
  s_add_u32 s50, s50, s44
  s_add_u32 s50, s50, 0xc0000
  s_lshl_b32 s49, s8, 19
  s_lshl_b32 s44, s3, 17
  s_add_u32 s49, s49, s44
  s_lshl_b32 s44, s7, 16
  s_add_u32 s49, s49, s44
  s_add_u32 s44, s97, 0
  s_and_b32 s44, s44, 3
  s_mul_i32 s44, s44, 16384
  s_add_u32 s56, s49, s44
  s_add_u32 s44, s97, 1
  s_and_b32 s44, s44, 3
  s_mul_i32 s44, s44, 16384
  s_add_u32 s57, s49, s44
  s_add_u32 s44, s97, 2
  s_and_b32 s44, s44, 3
  s_mul_i32 s44, s44, 16384
  s_add_u32 s58, s49, s44
  s_add_u32 s44, s97, 3
  s_and_b32 s44, s44, 3
  s_mul_i32 s44, s44, 16384
  s_add_u32 s59, s49, s44
  s_lshl_b32 s47, s3, 2
  s_add_u32 s47, s47, 147456
  v_mul_u32_u24 v7, 144, v1
  v_add_u32 v7, s47, v7
  v_lshrrev_b32 v8, 2, v1
  v_mul_u32_u24 v8, 144, v8
  v_and_b32 v9, 3, v1
  v_lshl_add_u32 v8, v9, 5, v8
  s_mul_i32 s47, s3, 2304
  s_add_u32 s47, s47, 0x24000
  v_add_u32 v8, s47, v8
  v_mov_b32 v3, 0x3f803f80
  v_mov_b32 v40, 0
  v_mov_b32 v41, 0
  v_mov_b32 v42, 0
  v_mov_b32 v43, 0
  v_mov_b32 v44, 0
  v_mov_b32 v45, 0
  v_mov_b32 v46, 0
  v_mov_b32 v47, 0
  v_mov_b32 v48, 0
  v_mov_b32 v49, 0
  v_mov_b32 v50, 0
  v_mov_b32 v51, 0
  v_mov_b32 v52, 0
  v_mov_b32 v53, 0
  v_mov_b32 v54, 0
  v_mov_b32 v55, 0
  v_mov_b32 v56, 0
  v_mov_b32 v57, 0
  v_mov_b32 v58, 0
  v_mov_b32 v59, 0
  v_mov_b32 v60, 0
  v_mov_b32 v61, 0
  v_mov_b32 v62, 0
  v_mov_b32 v63, 0
  v_mov_b32 v64, 0
  v_mov_b32 v65, 0
  v_mov_b32 v66, 0
  v_mov_b32 v67, 0
  v_mov_b32 v68, 0
  v_mov_b32 v69, 0
  v_mov_b32 v70, 0
  v_mov_b32 v71, 0
  v_mov_b32 v72, 0
  v_mov_b32 v73, 0
  v_mov_b32 v74, 0
  v_mov_b32 v75, 0
  v_mov_b32 v76, 0
  v_mov_b32 v77, 0
  v_mov_b32 v78, 0
  v_mov_b32 v79, 0
  v_mov_b32 v80, 0
  v_mov_b32 v81, 0
  v_mov_b32 v82, 0
  v_mov_b32 v83, 0
  v_mov_b32 v84, 0
  v_mov_b32 v85, 0
  v_mov_b32 v86, 0
  v_mov_b32 v87, 0
  v_mov_b32 v88, 0
  v_mov_b32 v89, 0
  v_mov_b32 v90, 0
  v_mov_b32 v91, 0
  v_mov_b32 v92, 0
  v_mov_b32 v93, 0
  v_mov_b32 v94, 0
  v_mov_b32 v95, 0
  v_mov_b32 v96, 0
  v_mov_b32 v97, 0
  v_mov_b32 v98, 0
  v_mov_b32 v99, 0
  v_mov_b32 v100, 0
  v_mov_b32 v101, 0
  v_mov_b32 v102, 0
  v_mov_b32 v103, 0
  s_waitcnt vmcnt(1)
  v_dot2_f32_bf16 v152, v104, v3, 0
  v_dot2_f32_bf16 v154, v104, v104, 0
  v_dot2_f32_bf16 v152, v105, v3, v152
  v_dot2_f32_bf16 v154, v105, v105, v154
  v_dot2_f32_bf16 v152, v106, v3, v152
  v_dot2_f32_bf16 v154, v106, v106, v154
  v_dot2_f32_bf16 v152, v107, v3, v152
  v_dot2_f32_bf16 v154, v107, v107, v154
  s_waitcnt vmcnt(0)
  v_dot2_f32_bf16 v153, v108, v3, 0
  v_dot2_f32_bf16 v155, v108, v108, 0
  v_dot2_f32_bf16 v153, v109, v3, v153
  v_dot2_f32_bf16 v155, v109, v109, v155
  v_dot2_f32_bf16 v153, v110, v3, v153
  v_dot2_f32_bf16 v155, v110, v110, v155
  v_dot2_f32_bf16 v153, v111, v3, v153
  v_dot2_f32_bf16 v155, v111, v111, v155
  v_lshlrev_b32 v120, 16, v104
  v_and_b32 v122, 0xffff0000, v104
  v_permlane32_swap_b32 v152, v153
  v_permlane32_swap_b32 v154, v155
  v_add_f32 v152, v152, v153
  v_add_f32 v154, v154, v155
  v_lshlrev_b32 v124, 16, v105
  v_and_b32 v126, 0xffff0000, v105
  v_permlane16_swap_b32 v152, v154
  v_add_f32 v152, v152, v154
  v_lshlrev_b32 v128, 16, v106
  v_and_b32 v130, 0xffff0000, v106
  v_add_f32_dpp v152, v152, v152 quad_perm:[1,0,3,2] row_mask:0xf bank_mask:0xf
  v_lshlrev_b32 v132, 16, v107
  v_and_b32 v134, 0xffff0000, v107
  v_add_f32_dpp v152, v152, v152 quad_perm:[2,3,0,1] row_mask:0xf bank_mask:0xf
  v_lshlrev_b32 v121, 16, v108
  v_and_b32 v123, 0xffff0000, v108
  v_add_f32_dpp v152, v152, v152 row_half_mirror row_mask:0xf bank_mask:0xf
  v_lshlrev_b32 v125, 16, v109
  v_and_b32 v127, 0xffff0000, v109
  v_add_f32_dpp v152, v152, v152 row_mirror row_mask:0xf bank_mask:0xf
  v_mov_b32 v154, v152
  v_lshlrev_b32 v129, 16, v110
  v_and_b32 v131, 0xffff0000, v110
  v_permlane16_swap_b32 v152, v154
  v_lshlrev_b32 v133, 16, v111
  v_and_b32 v135, 0xffff0000, v111
  v_mul_f32 v152, 0x3b000000, v152
  v_mul_f32 v154, 0x3b000000, v154
  v_fma_f32 v154, -v152, v152, v154
  v_max_f32 v154, 0, v154
  v_cvt_pk_bf16_f32 v156, v152, v154
  v_and_b32 v154, 0xffff0000, v156
  v_lshlrev_b32 v152, 16, v156
  v_add_f32 v154, 0x3727c5ac, v154
  v_cvt_pk_bf16_f32 v154, v154, v154
  v_lshlrev_b32 v154, 16, v154
  v_sqrt_f32 v154, v154
  s_nop 0
  v_cvt_pk_bf16_f32 v154, v154, v154
  v_lshlrev_b32 v154, 16, v154
  v_rcp_f32 v154, v154
  s_nop 0
  v_mul_f32 v152, -v152, v154
  v_mov_b32 v153, v152
  v_mov_b32 v155, v154
  s_nop 0
  v_permlane32_swap_b32 v152, v153
  v_permlane32_swap_b32 v154, v155
  v_pk_fma_f32 v[120:121], v[120:121], v[154:155], v[152:153]
  v_pk_fma_f32 v[122:123], v[122:123], v[154:155], v[152:153]
  v_pk_fma_f32 v[124:125], v[124:125], v[154:155], v[152:153]
  v_pk_fma_f32 v[126:127], v[126:127], v[154:155], v[152:153]
  v_pk_fma_f32 v[128:129], v[128:129], v[154:155], v[152:153]
  v_pk_fma_f32 v[130:131], v[130:131], v[154:155], v[152:153]
  v_pk_fma_f32 v[132:133], v[132:133], v[154:155], v[152:153]
  v_pk_fma_f32 v[134:135], v[134:135], v[154:155], v[152:153]
  v_cvt_pk_bf16_f32 v104, v120, v121
  v_cvt_pk_bf16_f32 v105, v122, v123
  ds_write2_b32 v7, v104, v105 offset0:0 offset1:4
  v_cvt_pk_bf16_f32 v106, v124, v125
  v_cvt_pk_bf16_f32 v107, v126, v127
  ds_write2_b32 v7, v106, v107 offset0:8 offset1:12
  v_cvt_pk_bf16_f32 v108, v128, v129
  v_cvt_pk_bf16_f32 v109, v130, v131
  ds_write2_b32 v7, v108, v109 offset0:16 offset1:20
  v_cvt_pk_bf16_f32 v110, v132, v133
  v_cvt_pk_bf16_f32 v111, v134, v135
  ds_write2_b32 v7, v110, v111 offset0:24 offset1:28
  s_mov_b64 exec, 1
  ds_add_u32 v34, v31 offset:672
  s_mov_b64 exec, -1
SP_1:
  ds_read_b32 v10, v34 offset:672
  s_sub_u32 s13, s13, 1
  s_cbranch_scc1 ABORT
  s_waitcnt lgkmcnt(0)
  v_cmp_gt_u32 vcc, 4, v10
  s_cbranch_vccnz SP_1
  ds_read_b128 v[104:107], v8 offset:0
  ds_read_b128 v[108:111], v8 offset:16
  buffer_load_dwordx2 v[152:153], v33, s[40:43], 0 offen sc1
  v_lshlrev_b32 v9, 14, v1
  s_waitcnt lgkmcnt(1)
  buffer_store_dwordx4 v[104:107], v2, s[20:23], s46 offen offset:0 sc1
  s_waitcnt lgkmcnt(0)
  buffer_store_dwordx4 v[108:111], v2, s[20:23], s46 offen offset:1024 sc1
  s_mov_b64 exec, 1
  ds_add_u32 v34, v31 offset:512
  s_mov_b64 exec, -1
  s_waitcnt vmcnt(2)
EP_2:
  v_readfirstlane_b32 s15, v153
  v_readfirstlane_b32 s14, v152
  s_cmp_lg_u32 s15, 0
  s_cbranch_scc1 EPOK_3
  buffer_load_dwordx2 v[152:153], v33, s[40:43], 0 offen sc1
  s_sub_u32 s13, s13, 1
  s_cbranch_scc1 ABORT
  s_waitcnt vmcnt(0)
  s_branch EP_2
EPOK_3:
  s_lshr_b64 s[54:55], s[14:15], 4
  v_mov_b32 v152, s54
  s_waitcnt vmcnt(0)
  s_mov_b64 exec, 0xff
  buffer_store_dword v152, v9, s[24:27], s50 offen sc1
  s_mov_b64 exec, 1
  ds_add_u32 v34, v31 offset:512
  s_mov_b64 exec, -1
SP_4:
  ds_read_b32 v10, v34 offset:0
  s_sub_u32 s13, s13, 1
  s_cbranch_scc1 ABORT
  s_waitcnt lgkmcnt(0)
  v_cmp_gt_u32 vcc, 1, v10
  s_cbranch_vccnz SP_4
  buffer_load_dwordx4 v[136:139], v32, s[20:23], s56 offen offset:0 sc1
  buffer_load_dwordx4 v[140:143], v32, s[20:23], s56 offen offset:1024 sc1
  buffer_load_dwordx4 v[144:147], v32, s[20:23], s56 offen offset:2048 sc1
  buffer_load_dwordx4 v[148:151], v32, s[20:23], s56 offen offset:3072 sc1
  s_add_u32 s45, s56, 4096
  buffer_load_dwordx4 v[152:155], v32, s[20:23], s45 offen offset:0 sc1
  buffer_load_dwordx4 v[156:159], v32, s[20:23], s45 offen offset:1024 sc1
  buffer_load_dwordx4 v[160:163], v32, s[20:23], s45 offen offset:2048 sc1
  buffer_load_dwordx4 v[164:167], v32, s[20:23], s45 offen offset:3072 sc1
SP_5:
  ds_read_b32 v10, v29 offset:0
  s_sub_u32 s13, s13, 1
  s_cbranch_scc1 ABORT
  s_waitcnt lgkmcnt(0)
  v_cmp_gt_u32 vcc, 2, v10
  s_cbranch_vccnz SP_5
  ds_read_b128 v[104:107], v20 offset:0
  ds_read_b128 v[108:111], v20 offset:2048
  ds_read_b128 v[112:115], v20 offset:4096
  ds_read_b128 v[116:119], v20 offset:6144
  s_waitcnt vmcnt(6) lgkmcnt(0)
  v_mfma_f32_16x16x32_bf16 v[40:43], v[136:139], v[104:107], v[40:43]
  ds_read_b128 v[120:123], v21 offset:0
  v_mfma_f32_16x16x32_bf16 v[44:47], v[140:143], v[104:107], v[44:47]
  ds_read_b128 v[124:127], v21 offset:2048
  v_mfma_f32_16x16x32_bf16 v[52:55], v[140:143], v[108:111], v[52:55]
  ds_read_b128 v[128:131], v21 offset:4096
  v_mfma_f32_16x16x32_bf16 v[48:51], v[136:139], v[108:111], v[48:51]
  ds_read_b128 v[132:135], v21 offset:6144
  v_mfma_f32_16x16x32_bf16 v[56:59], v[136:139], v[112:115], v[56:59]
  s_add_u32 s45, s56, 8192
  buffer_load_dwordx4 v[168:171], v32, s[20:23], s45 offen offset:0 sc1
  v_mfma_f32_16x16x32_bf16 v[60:63], v[140:143], v[112:115], v[60:63]
  v_mfma_f32_16x16x32_bf16 v[68:71], v[140:143], v[116:119], v[68:71]
  buffer_load_dwordx4 v[172:175], v32, s[20:23], s45 offen offset:1024 sc1
  v_mfma_f32_16x16x32_bf16 v[64:67], v[136:139], v[116:119], v[64:67]
  s_waitcnt vmcnt(6) lgkmcnt(0)
  v_mfma_f32_16x16x32_bf16 v[40:43], v[144:147], v[120:123], v[40:43]
  ds_read_b128 v[104:107], v20 offset:8192
  v_mfma_f32_16x16x32_bf16 v[44:47], v[148:151], v[120:123], v[44:47]
  ds_read_b128 v[108:111], v20 offset:10240
  v_mfma_f32_16x16x32_bf16 v[52:55], v[148:151], v[124:127], v[52:55]
  ds_read_b128 v[112:115], v20 offset:12288
  v_mfma_f32_16x16x32_bf16 v[48:51], v[144:147], v[124:127], v[48:51]
  ds_read_b128 v[116:119], v20 offset:14336
  v_mfma_f32_16x16x32_bf16 v[56:59], v[144:147], v[128:131], v[56:59]
  buffer_load_dwordx4 v[176:179], v32, s[20:23], s45 offen offset:2048 sc1
  v_mfma_f32_16x16x32_bf16 v[60:63], v[148:151], v[128:131], v[60:63]
  v_mfma_f32_16x16x32_bf16 v[68:71], v[148:151], v[132:135], v[68:71]
  buffer_load_dwordx4 v[180:183], v32, s[20:23], s45 offen offset:3072 sc1
  v_mfma_f32_16x16x32_bf16 v[64:67], v[144:147], v[132:135], v[64:67]
  s_waitcnt vmcnt(6) lgkmcnt(0)
  v_mfma_f32_16x16x32_bf16 v[40:43], v[152:155], v[104:107], v[40:43]
  ds_read_b128 v[120:123], v21 offset:8192
  v_mfma_f32_16x16x32_bf16 v[44:47], v[156:159], v[104:107], v[44:47]
  ds_read_b128 v[124:127], v21 offset:10240
  v_mfma_f32_16x16x32_bf16 v[52:55], v[156:159], v[108:111], v[52:55]
  ds_read_b128 v[128:131], v21 offset:12288
  v_mfma_f32_16x16x32_bf16 v[48:51], v[152:155], v[108:111], v[48:51]
  ds_read_b128 v[132:135], v21 offset:14336
  v_mfma_f32_16x16x32_bf16 v[56:59], v[152:155], v[112:115], v[56:59]
  ds_read_b32 v10, v29
  v_mfma_f32_16x16x32_bf16 v[60:63], v[156:159], v[112:115], v[60:63]
  ds_add_u32 v30, v31
  v_mfma_f32_16x16x32_bf16 v[68:71], v[156:159], v[116:119], v[68:71]
  s_add_u32 s45, s56, 12288
  buffer_load_dwordx4 v[184:187], v32, s[20:23], s45 offen offset:0 sc1
  v_mfma_f32_16x16x32_bf16 v[64:67], v[152:155], v[116:119], v[64:67]
  buffer_load_dwordx4 v[188:191], v32, s[20:23], s45 offen offset:1024 sc1
  s_waitcnt vmcnt(6) lgkmcnt(2)
  v_mfma_f32_16x16x32_bf16 v[40:43], v[160:163], v[120:123], v[40:43]
  s_waitcnt lgkmcnt(1)
  v_cmp_gt_u32 vcc, 3, v10
  s_cbranch_vccnz SLOW_6
JOIN_7:
  ds_read_b128 v[104:107], v20 offset:16384
  v_mfma_f32_16x16x32_bf16 v[44:47], v[164:167], v[120:123], v[44:47]
  ds_read_b128 v[108:111], v20 offset:18432
  v_mfma_f32_16x16x32_bf16 v[52:55], v[164:167], v[124:127], v[52:55]
  ds_read_b128 v[112:115], v20 offset:20480
  v_mfma_f32_16x16x32_bf16 v[48:51], v[160:163], v[124:127], v[48:51]
  ds_read_b128 v[116:119], v20 offset:22528
  v_mfma_f32_16x16x32_bf16 v[56:59], v[160:163], v[128:131], v[56:59]
  buffer_load_dwordx4 v[192:195], v32, s[20:23], s45 offen offset:2048 sc1
  v_mfma_f32_16x16x32_bf16 v[60:63], v[164:167], v[128:131], v[60:63]
  v_mfma_f32_16x16x32_bf16 v[68:71], v[164:167], v[132:135], v[68:71]
  buffer_load_dwordx4 v[196:199], v32, s[20:23], s45 offen offset:3072 sc1
  v_mfma_f32_16x16x32_bf16 v[64:67], v[160:163], v[132:135], v[64:67]
  s_waitcnt lgkmcnt(0)
  v_mfma_f32_16x16x32_bf16 v[72:75], v[136:139], v[104:107], v[72:75]
  ds_read_b128 v[120:123], v21 offset:16384
  v_mfma_f32_16x16x32_bf16 v[76:79], v[140:143], v[104:107], v[76:79]
  ds_read_b128 v[124:127], v21 offset:18432
  v_mfma_f32_16x16x32_bf16 v[84:87], v[140:143], v[108:111], v[84:87]
  ds_read_b128 v[128:131], v21 offset:20480
  v_mfma_f32_16x16x32_bf16 v[80:83], v[136:139], v[108:111], v[80:83]
  ds_read_b128 v[132:135], v21 offset:22528
  v_mfma_f32_16x16x32_bf16 v[88:91], v[136:139], v[112:115], v[88:91]
  buffer_load_dwordx4 v[200:203], v32, s[20:23], s57 offen offset:0 sc1
  v_mfma_f32_16x16x32_bf16 v[92:95], v[140:143], v[112:115], v[92:95]
  v_mfma_f32_16x16x32_bf16 v[100:103], v[140:143], v[116:119], v[100:103]
  buffer_load_dwordx4 v[204:207], v32, s[20:23], s57 offen offset:1024 sc1
  v_mfma_f32_16x16x32_bf16 v[96:99], v[136:139], v[116:119], v[96:99]
  s_waitcnt lgkmcnt(0)
  v_mfma_f32_16x16x32_bf16 v[72:75], v[144:147], v[120:123], v[72:75]
  ds_read_b128 v[104:107], v20 offset:24576
  v_mfma_f32_16x16x32_bf16 v[76:79], v[148:151], v[120:123], v[76:79]
  ds_read_b128 v[108:111], v20 offset:26624
  v_mfma_f32_16x16x32_bf16 v[84:87], v[148:151], v[124:127], v[84:87]
  ds_read_b128 v[112:115], v20 offset:28672
  v_mfma_f32_16x16x32_bf16 v[80:83], v[144:147], v[124:127], v[80:83]
  ds_read_b128 v[116:119], v20 offset:30720
  v_mfma_f32_16x16x32_bf16 v[88:91], v[144:147], v[128:131], v[88:91]
  buffer_load_dwordx4 v[208:211], v32, s[20:23], s57 offen offset:2048 sc1
  v_mfma_f32_16x16x32_bf16 v[92:95], v[148:151], v[128:131], v[92:95]
  v_mfma_f32_16x16x32_bf16 v[100:103], v[148:151], v[132:135], v[100:103]
  buffer_load_dwordx4 v[212:215], v32, s[20:23], s57 offen offset:3072 sc1
  v_mfma_f32_16x16x32_bf16 v[96:99], v[144:147], v[132:135], v[96:99]
  s_waitcnt lgkmcnt(0)
  v_mfma_f32_16x16x32_bf16 v[72:75], v[152:155], v[104:107], v[72:75]
  ds_read_b128 v[120:123], v21 offset:24576
  v_mfma_f32_16x16x32_bf16 v[76:79], v[156:159], v[104:107], v[76:79]
  ds_read_b128 v[124:127], v21 offset:26624
  v_mfma_f32_16x16x32_bf16 v[84:87], v[156:159], v[108:111], v[84:87]
  ds_read_b128 v[128:131], v21 offset:28672
  v_mfma_f32_16x16x32_bf16 v[80:83], v[152:155], v[108:111], v[80:83]
  ds_read_b128 v[132:135], v21 offset:30720
  v_mfma_f32_16x16x32_bf16 v[88:91], v[152:155], v[112:115], v[88:91]
  ds_read_b32 v10, v29
  v_mfma_f32_16x16x32_bf16 v[92:95], v[156:159], v[112:115], v[92:95]
  ds_add_u32 v30, v31
  v_mfma_f32_16x16x32_bf16 v[100:103], v[156:159], v[116:119], v[100:103]
  s_add_u32 s45, s57, 4096
  buffer_load_dwordx4 v[216:219], v32, s[20:23], s45 offen offset:0 sc1
  v_mfma_f32_16x16x32_bf16 v[96:99], v[152:155], v[116:119], v[96:99]
  buffer_load_dwordx4 v[220:223], v32, s[20:23], s45 offen offset:1024 sc1
  s_waitcnt lgkmcnt(2)
  v_mfma_f32_16x16x32_bf16 v[72:75], v[160:163], v[120:123], v[72:75]
  s_waitcnt lgkmcnt(1)
  v_cmp_gt_u32 vcc, 4, v10
  s_cbranch_vccnz SLOW_9
JOIN_10:
  ds_read_b128 v[104:107], v20 offset:32768
  v_mfma_f32_16x16x32_bf16 v[76:79], v[164:167], v[120:123], v[76:79]
  ds_read_b128 v[108:111], v20 offset:34816
  v_mfma_f32_16x16x32_bf16 v[84:87], v[164:167], v[124:127], v[84:87]
  ds_read_b128 v[112:115], v20 offset:36864
  v_mfma_f32_16x16x32_bf16 v[80:83], v[160:163], v[124:127], v[80:83]
  ds_read_b128 v[116:119], v20 offset:38912
  v_mfma_f32_16x16x32_bf16 v[88:91], v[160:163], v[128:131], v[88:91]
  buffer_load_dwordx4 v[224:227], v32, s[20:23], s45 offen offset:2048 sc1
  v_mfma_f32_16x16x32_bf16 v[92:95], v[164:167], v[128:131], v[92:95]
  v_mfma_f32_16x16x32_bf16 v[100:103], v[164:167], v[132:135], v[100:103]
  buffer_load_dwordx4 v[228:231], v32, s[20:23], s45 offen offset:3072 sc1
  v_mfma_f32_16x16x32_bf16 v[96:99], v[160:163], v[132:135], v[96:99]
  s_waitcnt vmcnt(14) lgkmcnt(0)
  v_mfma_f32_16x16x32_bf16 v[40:43], v[168:171], v[104:107], v[40:43]
  ds_read_b128 v[120:123], v21 offset:32768
  v_mfma_f32_16x16x32_bf16 v[44:47], v[172:175], v[104:107], v[44:47]
  ds_read_b128 v[124:127], v21 offset:34816
  v_mfma_f32_16x16x32_bf16 v[52:55], v[172:175], v[108:111], v[52:55]
  ds_read_b128 v[128:131], v21 offset:36864
  v_mfma_f32_16x16x32_bf16 v[48:51], v[168:171], v[108:111], v[48:51]
  ds_read_b128 v[132:135], v21 offset:38912
  v_mfma_f32_16x16x32_bf16 v[56:59], v[168:171], v[112:115], v[56:59]
  s_add_u32 s45, s57, 8192
  buffer_load_dwordx4 v[232:235], v32, s[20:23], s45 offen offset:0 sc1
  v_mfma_f32_16x16x32_bf16 v[60:63], v[172:175], v[112:115], v[60:63]
  v_mfma_f32_16x16x32_bf16 v[68:71], v[172:175], v[116:119], v[68:71]
  buffer_load_dwordx4 v[236:239], v32, s[20:23], s45 offen offset:1024 sc1
  v_mfma_f32_16x16x32_bf16 v[64:67], v[168:171], v[116:119], v[64:67]
  s_waitcnt vmcnt(14) lgkmcnt(0)
  v_mfma_f32_16x16x32_bf16 v[40:43], v[176:179], v[120:123], v[40:43]
  ds_read_b128 v[104:107], v20 offset:40960
  v_mfma_f32_16x16x32_bf16 v[44:47], v[180:183], v[120:123], v[44:47]
  ds_read_b128 v[108:111], v20 offset:43008
  v_mfma_f32_16x16x32_bf16 v[52:55], v[180:183], v[124:127], v[52:55]
  ds_read_b128 v[112:115], v20 offset:45056
  v_mfma_f32_16x16x32_bf16 v[48:51], v[176:179], v[124:127], v[48:51]
  ds_read_b128 v[116:119], v20 offset:47104
  v_mfma_f32_16x16x32_bf16 v[56:59], v[176:179], v[128:131], v[56:59]
  buffer_load_dwordx4 v[240:243], v32, s[20:23], s45 offen offset:2048 sc1
  v_mfma_f32_16x16x32_bf16 v[60:63], v[180:183], v[128:131], v[60:63]
  v_mfma_f32_16x16x32_bf16 v[68:71], v[180:183], v[132:135], v[68:71]
  buffer_load_dwordx4 v[244:247], v32, s[20:23], s45 offen offset:3072 sc1
  v_mfma_f32_16x16x32_bf16 v[64:67], v[176:179], v[132:135], v[64:67]
  s_waitcnt vmcnt(14) lgkmcnt(0)
  v_mfma_f32_16x16x32_bf16 v[40:43], v[184:187], v[104:107], v[40:43]
  ds_read_b128 v[120:123], v21 offset:40960
  v_mfma_f32_16x16x32_bf16 v[44:47], v[188:191], v[104:107], v[44:47]
  ds_read_b128 v[124:127], v21 offset:43008
  v_mfma_f32_16x16x32_bf16 v[52:55], v[188:191], v[108:111], v[52:55]
  ds_read_b128 v[128:131], v21 offset:45056
  v_mfma_f32_16x16x32_bf16 v[48:51], v[184:187], v[108:111], v[48:51]
  ds_read_b128 v[132:135], v21 offset:47104
  v_mfma_f32_16x16x32_bf16 v[56:59], v[184:187], v[112:115], v[56:59]
  ds_read_b32 v10, v29
  v_mfma_f32_16x16x32_bf16 v[60:63], v[188:191], v[112:115], v[60:63]
  ds_add_u32 v30, v31
  v_mfma_f32_16x16x32_bf16 v[68:71], v[188:191], v[116:119], v[68:71]
  s_add_u32 s45, s57, 12288
  buffer_load_dwordx4 v[248:251], v32, s[20:23], s45 offen offset:0 sc1
  v_mfma_f32_16x16x32_bf16 v[64:67], v[184:187], v[116:119], v[64:67]
  buffer_load_dwordx4 v[252:255], v32, s[20:23], s45 offen offset:1024 sc1
  s_waitcnt vmcnt(14) lgkmcnt(2)
  v_mfma_f32_16x16x32_bf16 v[40:43], v[192:195], v[120:123], v[40:43]
  s_waitcnt lgkmcnt(1)
  v_cmp_gt_u32 vcc, 5, v10
  s_cbranch_vccnz SLOW_12
JOIN_13:
  ds_read_b128 v[104:107], v20 offset:49152
  v_mfma_f32_16x16x32_bf16 v[44:47], v[196:199], v[120:123], v[44:47]
  ds_read_b128 v[108:111], v20 offset:51200
  v_mfma_f32_16x16x32_bf16 v[52:55], v[196:199], v[124:127], v[52:55]
  ds_read_b128 v[112:115], v20 offset:53248
  v_mfma_f32_16x16x32_bf16 v[48:51], v[192:195], v[124:127], v[48:51]
  ds_read_b128 v[116:119], v20 offset:55296
  v_mfma_f32_16x16x32_bf16 v[56:59], v[192:195], v[128:131], v[56:59]
  buffer_load_dwordx4 v[136:139], v32, s[20:23], s45 offen offset:2048 sc1
  v_mfma_f32_16x16x32_bf16 v[60:63], v[196:199], v[128:131], v[60:63]
  v_mfma_f32_16x16x32_bf16 v[68:71], v[196:199], v[132:135], v[68:71]
  buffer_load_dwordx4 v[140:143], v32, s[20:23], s45 offen offset:3072 sc1
  v_mfma_f32_16x16x32_bf16 v[64:67], v[192:195], v[132:135], v[64:67]
  s_waitcnt lgkmcnt(0)
  v_mfma_f32_16x16x32_bf16 v[72:75], v[168:171], v[104:107], v[72:75]
  ds_read_b128 v[120:123], v21 offset:49152
  v_mfma_f32_16x16x32_bf16 v[76:79], v[172:175], v[104:107], v[76:79]
  ds_read_b128 v[124:127], v21 offset:51200
  v_mfma_f32_16x16x32_bf16 v[84:87], v[172:175], v[108:111], v[84:87]
  ds_read_b128 v[128:131], v21 offset:53248
  v_mfma_f32_16x16x32_bf16 v[80:83], v[168:171], v[108:111], v[80:83]
  ds_read_b128 v[132:135], v21 offset:55296
  v_mfma_f32_16x16x32_bf16 v[88:91], v[168:171], v[112:115], v[88:91]
  buffer_load_dwordx4 v[144:147], v32, s[20:23], s58 offen offset:0 sc1
  v_mfma_f32_16x16x32_bf16 v[92:95], v[172:175], v[112:115], v[92:95]
  v_mfma_f32_16x16x32_bf16 v[100:103], v[172:175], v[116:119], v[100:103]
  buffer_load_dwordx4 v[148:151], v32, s[20:23], s58 offen offset:1024 sc1
  v_mfma_f32_16x16x32_bf16 v[96:99], v[168:171], v[116:119], v[96:99]
  s_waitcnt lgkmcnt(0)
  v_mfma_f32_16x16x32_bf16 v[72:75], v[176:179], v[120:123], v[72:75]
  ds_read_b128 v[104:107], v20 offset:57344
  v_mfma_f32_16x16x32_bf16 v[76:79], v[180:183], v[120:123], v[76:79]
  ds_read_b128 v[108:111], v20 offset:59392
  v_mfma_f32_16x16x32_bf16 v[84:87], v[180:183], v[124:127], v[84:87]
  ds_read_b128 v[112:115], v20 offset:61440
  v_mfma_f32_16x16x32_bf16 v[80:83], v[176:179], v[124:127], v[80:83]
  ds_read_b128 v[116:119], v20 offset:63488
  v_mfma_f32_16x16x32_bf16 v[88:91], v[176:179], v[128:131], v[88:91]
  buffer_load_dwordx4 v[152:155], v32, s[20:23], s58 offen offset:2048 sc1
  v_mfma_f32_16x16x32_bf16 v[92:95], v[180:183], v[128:131], v[92:95]
  v_mfma_f32_16x16x32_bf16 v[100:103], v[180:183], v[132:135], v[100:103]
  buffer_load_dwordx4 v[156:159], v32, s[20:23], s58 offen offset:3072 sc1
  v_mfma_f32_16x16x32_bf16 v[96:99], v[176:179], v[132:135], v[96:99]
  s_waitcnt lgkmcnt(0)
  v_mfma_f32_16x16x32_bf16 v[72:75], v[184:187], v[104:107], v[72:75]
  ds_read_b128 v[120:123], v21 offset:57344
  v_mfma_f32_16x16x32_bf16 v[76:79], v[188:191], v[104:107], v[76:79]
  ds_read_b128 v[124:127], v21 offset:59392
  v_mfma_f32_16x16x32_bf16 v[84:87], v[188:191], v[108:111], v[84:87]
  ds_read_b128 v[128:131], v21 offset:61440
  v_mfma_f32_16x16x32_bf16 v[80:83], v[184:187], v[108:111], v[80:83]
  ds_read_b128 v[132:135], v21 offset:63488
  v_mfma_f32_16x16x32_bf16 v[88:91], v[184:187], v[112:115], v[88:91]
  ds_read_b32 v10, v29
  v_mfma_f32_16x16x32_bf16 v[92:95], v[188:191], v[112:115], v[92:95]
  ds_add_u32 v30, v31
  v_mfma_f32_16x16x32_bf16 v[100:103], v[188:191], v[116:119], v[100:103]
  s_add_u32 s45, s58, 4096
  buffer_load_dwordx4 v[160:163], v32, s[20:23], s45 offen offset:0 sc1
  v_mfma_f32_16x16x32_bf16 v[96:99], v[184:187], v[116:119], v[96:99]
  buffer_load_dwordx4 v[164:167], v32, s[20:23], s45 offen offset:1024 sc1
  s_waitcnt lgkmcnt(2)
  v_mfma_f32_16x16x32_bf16 v[72:75], v[192:195], v[120:123], v[72:75]
  s_waitcnt lgkmcnt(1)
  v_cmp_gt_u32 vcc, 6, v10
  s_cbranch_vccnz SLOW_15
JOIN_16:
  ds_read_b128 v[104:107], v22 offset:0
  v_mfma_f32_16x16x32_bf16 v[76:79], v[196:199], v[120:123], v[76:79]
  ds_read_b128 v[108:111], v22 offset:2048
  v_mfma_f32_16x16x32_bf16 v[84:87], v[196:199], v[124:127], v[84:87]
  ds_read_b128 v[112:115], v22 offset:4096
  v_mfma_f32_16x16x32_bf16 v[80:83], v[192:195], v[124:127], v[80:83]
  ds_read_b128 v[116:119], v22 offset:6144
  v_mfma_f32_16x16x32_bf16 v[88:91], v[192:195], v[128:131], v[88:91]
  buffer_load_dwordx4 v[168:171], v32, s[20:23], s45 offen offset:2048 sc1
  v_mfma_f32_16x16x32_bf16 v[92:95], v[196:199], v[128:131], v[92:95]
  v_mfma_f32_16x16x32_bf16 v[100:103], v[196:199], v[132:135], v[100:103]
  buffer_load_dwordx4 v[172:175], v32, s[20:23], s45 offen offset:3072 sc1
  v_mfma_f32_16x16x32_bf16 v[96:99], v[192:195], v[132:135], v[96:99]
  s_waitcnt vmcnt(22) lgkmcnt(0)
  v_mfma_f32_16x16x32_bf16 v[40:43], v[200:203], v[104:107], v[40:43]
  ds_read_b128 v[120:123], v23 offset:0
  v_mfma_f32_16x16x32_bf16 v[44:47], v[204:207], v[104:107], v[44:47]
  ds_read_b128 v[124:127], v23 offset:2048
  v_mfma_f32_16x16x32_bf16 v[52:55], v[204:207], v[108:111], v[52:55]
  ds_read_b128 v[128:131], v23 offset:4096
  v_mfma_f32_16x16x32_bf16 v[48:51], v[200:203], v[108:111], v[48:51]
  ds_read_b128 v[132:135], v23 offset:6144
  v_mfma_f32_16x16x32_bf16 v[56:59], v[200:203], v[112:115], v[56:59]
  s_add_u32 s45, s58, 8192
  buffer_load_dwordx4 v[176:179], v32, s[20:23], s45 offen offset:0 sc1
  v_mfma_f32_16x16x32_bf16 v[60:63], v[204:207], v[112:115], v[60:63]
  v_mfma_f32_16x16x32_bf16 v[68:71], v[204:207], v[116:119], v[68:71]
  buffer_load_dwordx4 v[180:183], v32, s[20:23], s45 offen offset:1024 sc1
  v_mfma_f32_16x16x32_bf16 v[64:67], v[200:203], v[116:119], v[64:67]
  s_waitcnt vmcnt(22) lgkmcnt(0)
  v_mfma_f32_16x16x32_bf16 v[40:43], v[208:211], v[120:123], v[40:43]
  ds_read_b128 v[104:107], v22 offset:8192
  v_mfma_f32_16x16x32_bf16 v[44:47], v[212:215], v[120:123], v[44:47]
  ds_read_b128 v[108:111], v22 offset:10240
  v_mfma_f32_16x16x32_bf16 v[52:55], v[212:215], v[124:127], v[52:55]
  ds_read_b128 v[112:115], v22 offset:12288
  v_mfma_f32_16x16x32_bf16 v[48:51], v[208:211], v[124:127], v[48:51]
  ds_read_b128 v[116:119], v22 offset:14336
  v_mfma_f32_16x16x32_bf16 v[56:59], v[208:211], v[128:131], v[56:59]
  buffer_load_dwordx4 v[184:187], v32, s[20:23], s45 offen offset:2048 sc1
  v_mfma_f32_16x16x32_bf16 v[60:63], v[212:215], v[128:131], v[60:63]
  v_mfma_f32_16x16x32_bf16 v[68:71], v[212:215], v[132:135], v[68:71]
  buffer_load_dwordx4 v[188:191], v32, s[20:23], s45 offen offset:3072 sc1
  v_mfma_f32_16x16x32_bf16 v[64:67], v[208:211], v[132:135], v[64:67]
  s_waitcnt vmcnt(22) lgkmcnt(0)
  v_mfma_f32_16x16x32_bf16 v[40:43], v[216:219], v[104:107], v[40:43]
  ds_read_b128 v[120:123], v23 offset:8192
  v_mfma_f32_16x16x32_bf16 v[44:47], v[220:223], v[104:107], v[44:47]
  ds_read_b128 v[124:127], v23 offset:10240
  v_mfma_f32_16x16x32_bf16 v[52:55], v[220:223], v[108:111], v[52:55]
  ds_read_b128 v[128:131], v23 offset:12288
  v_mfma_f32_16x16x32_bf16 v[48:51], v[216:219], v[108:111], v[48:51]
  ds_read_b128 v[132:135], v23 offset:14336
  v_mfma_f32_16x16x32_bf16 v[56:59], v[216:219], v[112:115], v[56:59]
  ds_read_b32 v10, v29
  v_mfma_f32_16x16x32_bf16 v[60:63], v[220:223], v[112:115], v[60:63]
  ds_add_u32 v30, v31
  v_mfma_f32_16x16x32_bf16 v[68:71], v[220:223], v[116:119], v[68:71]
  s_add_u32 s45, s58, 12288
  buffer_load_dwordx4 v[192:195], v32, s[20:23], s45 offen offset:0 sc1
  v_mfma_f32_16x16x32_bf16 v[64:67], v[216:219], v[116:119], v[64:67]
  buffer_load_dwordx4 v[196:199], v32, s[20:23], s45 offen offset:1024 sc1
  s_waitcnt vmcnt(22) lgkmcnt(2)
  v_mfma_f32_16x16x32_bf16 v[40:43], v[224:227], v[120:123], v[40:43]
  s_waitcnt lgkmcnt(1)
  v_cmp_gt_u32 vcc, 7, v10
  s_cbranch_vccnz SLOW_18
JOIN_19:
  ds_read_b128 v[104:107], v22 offset:16384
  v_mfma_f32_16x16x32_bf16 v[44:47], v[228:231], v[120:123], v[44:47]
  ds_read_b128 v[108:111], v22 offset:18432
  v_mfma_f32_16x16x32_bf16 v[52:55], v[228:231], v[124:127], v[52:55]
  ds_read_b128 v[112:115], v22 offset:20480
  v_mfma_f32_16x16x32_bf16 v[48:51], v[224:227], v[124:127], v[48:51]
  ds_read_b128 v[116:119], v22 offset:22528
  v_mfma_f32_16x16x32_bf16 v[56:59], v[224:227], v[128:131], v[56:59]
  v_mfma_f32_16x16x32_bf16 v[60:63], v[228:231], v[128:131], v[60:63]
  v_mfma_f32_16x16x32_bf16 v[68:71], v[228:231], v[132:135], v[68:71]
  v_mfma_f32_16x16x32_bf16 v[64:67], v[224:227], v[132:135], v[64:67]
  s_waitcnt lgkmcnt(0)
  v_mfma_f32_16x16x32_bf16 v[72:75], v[200:203], v[104:107], v[72:75]
  ds_read_b128 v[120:123], v23 offset:16384
  v_mfma_f32_16x16x32_bf16 v[76:79], v[204:207], v[104:107], v[76:79]
  ds_read_b128 v[124:127], v23 offset:18432
  v_mfma_f32_16x16x32_bf16 v[84:87], v[204:207], v[108:111], v[84:87]
  ds_read_b128 v[128:131], v23 offset:20480
  v_mfma_f32_16x16x32_bf16 v[80:83], v[200:203], v[108:111], v[80:83]
  ds_read_b128 v[132:135], v23 offset:22528
  v_mfma_f32_16x16x32_bf16 v[88:91], v[200:203], v[112:115], v[88:91]
  v_mfma_f32_16x16x32_bf16 v[92:95], v[204:207], v[112:115], v[92:95]
  v_mfma_f32_16x16x32_bf16 v[100:103], v[204:207], v[116:119], v[100:103]
  v_mfma_f32_16x16x32_bf16 v[96:99], v[200:203], v[116:119], v[96:99]
  s_waitcnt lgkmcnt(0)
  v_mfma_f32_16x16x32_bf16 v[72:75], v[208:211], v[120:123], v[72:75]
  ds_read_b128 v[104:107], v22 offset:24576
  v_mfma_f32_16x16x32_bf16 v[76:79], v[212:215], v[120:123], v[76:79]
  ds_read_b128 v[108:111], v22 offset:26624
  v_mfma_f32_16x16x32_bf16 v[84:87], v[212:215], v[124:127], v[84:87]
  ds_read_b128 v[112:115], v22 offset:28672
  v_mfma_f32_16x16x32_bf16 v[80:83], v[208:211], v[124:127], v[80:83]
  ds_read_b128 v[116:119], v22 offset:30720
  v_mfma_f32_16x16x32_bf16 v[88:91], v[208:211], v[128:131], v[88:91]
  buffer_load_dwordx4 v[200:203], v32, s[20:23], s45 offen offset:2048 sc1
  v_mfma_f32_16x16x32_bf16 v[92:95], v[212:215], v[128:131], v[92:95]
  v_mfma_f32_16x16x32_bf16 v[100:103], v[212:215], v[132:135], v[100:103]
  buffer_load_dwordx4 v[204:207], v32, s[20:23], s45 offen offset:3072 sc1
  v_mfma_f32_16x16x32_bf16 v[96:99], v[208:211], v[132:135], v[96:99]
  s_waitcnt lgkmcnt(0)
  v_mfma_f32_16x16x32_bf16 v[72:75], v[216:219], v[104:107], v[72:75]
  ds_read_b128 v[120:123], v23 offset:24576
  v_mfma_f32_16x16x32_bf16 v[76:79], v[220:223], v[104:107], v[76:79]
  ds_read_b128 v[124:127], v23 offset:26624
  v_mfma_f32_16x16x32_bf16 v[84:87], v[220:223], v[108:111], v[84:87]
  ds_read_b128 v[128:131], v23 offset:28672
  v_mfma_f32_16x16x32_bf16 v[80:83], v[216:219], v[108:111], v[80:83]
  ds_read_b128 v[132:135], v23 offset:30720
  v_mfma_f32_16x16x32_bf16 v[88:91], v[216:219], v[112:115], v[88:91]
  ds_read_b32 v10, v29
  v_mfma_f32_16x16x32_bf16 v[92:95], v[220:223], v[112:115], v[92:95]
  ds_add_u32 v30, v31
  v_mfma_f32_16x16x32_bf16 v[100:103], v[220:223], v[116:119], v[100:103]
  buffer_load_dwordx4 v[208:211], v32, s[20:23], s59 offen offset:0 sc1
  v_mfma_f32_16x16x32_bf16 v[96:99], v[216:219], v[116:119], v[96:99]
  buffer_load_dwordx4 v[212:215], v32, s[20:23], s59 offen offset:1024 sc1
  s_waitcnt lgkmcnt(2)
  v_mfma_f32_16x16x32_bf16 v[72:75], v[224:227], v[120:123], v[72:75]
  s_waitcnt lgkmcnt(1)
  v_cmp_gt_u32 vcc, 8, v10
  s_cbranch_vccnz SLOW_21
JOIN_22:
  ds_read_b128 v[104:107], v22 offset:32768
  v_mfma_f32_16x16x32_bf16 v[76:79], v[228:231], v[120:123], v[76:79]
  ds_read_b128 v[108:111], v22 offset:34816
  v_mfma_f32_16x16x32_bf16 v[84:87], v[228:231], v[124:127], v[84:87]
  ds_read_b128 v[112:115], v22 offset:36864
  v_mfma_f32_16x16x32_bf16 v[80:83], v[224:227], v[124:127], v[80:83]
  ds_read_b128 v[116:119], v22 offset:38912
  v_mfma_f32_16x16x32_bf16 v[88:91], v[224:227], v[128:131], v[88:91]
  buffer_load_dwordx4 v[216:219], v32, s[20:23], s59 offen offset:2048 sc1
  v_mfma_f32_16x16x32_bf16 v[92:95], v[228:231], v[128:131], v[92:95]
  v_mfma_f32_16x16x32_bf16 v[100:103], v[228:231], v[132:135], v[100:103]
  buffer_load_dwordx4 v[220:223], v32, s[20:23], s59 offen offset:3072 sc1
  v_mfma_f32_16x16x32_bf16 v[96:99], v[224:227], v[132:135], v[96:99]
  s_waitcnt vmcnt(26) lgkmcnt(0)
  v_mfma_f32_16x16x32_bf16 v[40:43], v[232:235], v[104:107], v[40:43]
  ds_read_b128 v[120:123], v23 offset:32768
  v_mfma_f32_16x16x32_bf16 v[44:47], v[236:239], v[104:107], v[44:47]
  ds_read_b128 v[124:127], v23 offset:34816
  v_mfma_f32_16x16x32_bf16 v[52:55], v[236:239], v[108:111], v[52:55]
  ds_read_b128 v[128:131], v23 offset:36864
  v_mfma_f32_16x16x32_bf16 v[48:51], v[232:235], v[108:111], v[48:51]
  ds_read_b128 v[132:135], v23 offset:38912
  v_mfma_f32_16x16x32_bf16 v[56:59], v[232:235], v[112:115], v[56:59]
  s_add_u32 s45, s59, 4096
  buffer_load_dwordx4 v[224:227], v32, s[20:23], s45 offen offset:0 sc1
  v_mfma_f32_16x16x32_bf16 v[60:63], v[236:239], v[112:115], v[60:63]
  v_mfma_f32_16x16x32_bf16 v[68:71], v[236:239], v[116:119], v[68:71]
  buffer_load_dwordx4 v[228:231], v32, s[20:23], s45 offen offset:1024 sc1
  v_mfma_f32_16x16x32_bf16 v[64:67], v[232:235], v[116:119], v[64:67]
  s_waitcnt vmcnt(26) lgkmcnt(0)
  v_mfma_f32_16x16x32_bf16 v[40:43], v[240:243], v[120:123], v[40:43]
  ds_read_b128 v[104:107], v22 offset:40960
  v_mfma_f32_16x16x32_bf16 v[44:47], v[244:247], v[120:123], v[44:47]
  ds_read_b128 v[108:111], v22 offset:43008
  v_mfma_f32_16x16x32_bf16 v[52:55], v[244:247], v[124:127], v[52:55]
  ds_read_b128 v[112:115], v22 offset:45056
  v_mfma_f32_16x16x32_bf16 v[48:51], v[240:243], v[124:127], v[48:51]
  ds_read_b128 v[116:119], v22 offset:47104
  v_mfma_f32_16x16x32_bf16 v[56:59], v[240:243], v[128:131], v[56:59]
  v_mfma_f32_16x16x32_bf16 v[60:63], v[244:247], v[128:131], v[60:63]
  v_mfma_f32_16x16x32_bf16 v[68:71], v[244:247], v[132:135], v[68:71]
  v_mfma_f32_16x16x32_bf16 v[64:67], v[240:243], v[132:135], v[64:67]
  s_waitcnt vmcnt(24) lgkmcnt(0)
  v_mfma_f32_16x16x32_bf16 v[40:43], v[248:251], v[104:107], v[40:43]
  ds_read_b128 v[120:123], v23 offset:40960
  v_mfma_f32_16x16x32_bf16 v[44:47], v[252:255], v[104:107], v[44:47]
  ds_read_b128 v[124:127], v23 offset:43008
  v_mfma_f32_16x16x32_bf16 v[52:55], v[252:255], v[108:111], v[52:55]
  ds_read_b128 v[128:131], v23 offset:45056
  v_mfma_f32_16x16x32_bf16 v[48:51], v[248:251], v[108:111], v[48:51]
  ds_read_b128 v[132:135], v23 offset:47104
  v_mfma_f32_16x16x32_bf16 v[56:59], v[248:251], v[112:115], v[56:59]
  ds_read_b32 v10, v29
  v_mfma_f32_16x16x32_bf16 v[60:63], v[252:255], v[112:115], v[60:63]
  v_mfma_f32_16x16x32_bf16 v[68:71], v[252:255], v[116:119], v[68:71]
  ds_add_u32 v30, v31
  v_mfma_f32_16x16x32_bf16 v[64:67], v[248:251], v[116:119], v[64:67]
  s_waitcnt vmcnt(22) lgkmcnt(2)
  v_mfma_f32_16x16x32_bf16 v[40:43], v[136:139], v[120:123], v[40:43]
  s_waitcnt lgkmcnt(1)
  v_cmp_gt_u32 vcc, 9, v10
  s_cbranch_vccnz SLOW_24
JOIN_25:
  ds_read_b128 v[104:107], v22 offset:49152
  v_mfma_f32_16x16x32_bf16 v[44:47], v[140:143], v[120:123], v[44:47]
  ds_read_b128 v[108:111], v22 offset:51200
  v_mfma_f32_16x16x32_bf16 v[52:55], v[140:143], v[124:127], v[52:55]
  ds_read_b128 v[112:115], v22 offset:53248
  v_mfma_f32_16x16x32_bf16 v[48:51], v[136:139], v[124:127], v[48:51]
  ds_read_b128 v[116:119], v22 offset:55296
  v_mfma_f32_16x16x32_bf16 v[56:59], v[136:139], v[128:131], v[56:59]
  v_mfma_f32_16x16x32_bf16 v[60:63], v[140:143], v[128:131], v[60:63]
  v_mfma_f32_16x16x32_bf16 v[68:71], v[140:143], v[132:135], v[68:71]
  v_mfma_f32_16x16x32_bf16 v[64:67], v[136:139], v[132:135], v[64:67]
  s_waitcnt lgkmcnt(0)
  v_mfma_f32_16x16x32_bf16 v[72:75], v[232:235], v[104:107], v[72:75]
  ds_read_b128 v[120:123], v23 offset:49152
  v_mfma_f32_16x16x32_bf16 v[76:79], v[236:239], v[104:107], v[76:79]
  ds_read_b128 v[124:127], v23 offset:51200
  v_mfma_f32_16x16x32_bf16 v[84:87], v[236:239], v[108:111], v[84:87]
  ds_read_b128 v[128:131], v23 offset:53248
  v_mfma_f32_16x16x32_bf16 v[80:83], v[232:235], v[108:111], v[80:83]
  ds_read_b128 v[132:135], v23 offset:55296
  v_mfma_f32_16x16x32_bf16 v[88:91], v[232:235], v[112:115], v[88:91]
  v_mfma_f32_16x16x32_bf16 v[92:95], v[236:239], v[112:115], v[92:95]
  v_mfma_f32_16x16x32_bf16 v[100:103], v[236:239], v[116:119], v[100:103]
  v_mfma_f32_16x16x32_bf16 v[96:99], v[232:235], v[116:119], v[96:99]
  s_waitcnt lgkmcnt(0)
  v_mfma_f32_16x16x32_bf16 v[72:75], v[240:243], v[120:123], v[72:75]
  ds_read_b128 v[104:107], v22 offset:57344
  v_mfma_f32_16x16x32_bf16 v[76:79], v[244:247], v[120:123], v[76:79]
  ds_read_b128 v[108:111], v22 offset:59392
  v_mfma_f32_16x16x32_bf16 v[84:87], v[244:247], v[124:127], v[84:87]
  ds_read_b128 v[112:115], v22 offset:61440
  v_mfma_f32_16x16x32_bf16 v[80:83], v[240:243], v[124:127], v[80:83]
  ds_read_b128 v[116:119], v22 offset:63488
  v_mfma_f32_16x16x32_bf16 v[88:91], v[240:243], v[128:131], v[88:91]
  buffer_load_dwordx4 v[232:235], v32, s[20:23], s45 offen offset:2048 sc1
  v_mfma_f32_16x16x32_bf16 v[92:95], v[244:247], v[128:131], v[92:95]
  v_mfma_f32_16x16x32_bf16 v[100:103], v[244:247], v[132:135], v[100:103]
  buffer_load_dwordx4 v[236:239], v32, s[20:23], s45 offen offset:3072 sc1
  v_mfma_f32_16x16x32_bf16 v[96:99], v[240:243], v[132:135], v[96:99]
  s_waitcnt lgkmcnt(0)
  v_mfma_f32_16x16x32_bf16 v[72:75], v[248:251], v[104:107], v[72:75]
  ds_read_b128 v[120:123], v23 offset:57344
  v_mfma_f32_16x16x32_bf16 v[76:79], v[252:255], v[104:107], v[76:79]
  ds_read_b128 v[124:127], v23 offset:59392
  v_mfma_f32_16x16x32_bf16 v[84:87], v[252:255], v[108:111], v[84:87]
  ds_read_b128 v[128:131], v23 offset:61440
  v_mfma_f32_16x16x32_bf16 v[80:83], v[248:251], v[108:111], v[80:83]
  ds_read_b128 v[132:135], v23 offset:63488
  v_mfma_f32_16x16x32_bf16 v[88:91], v[248:251], v[112:115], v[88:91]
  ds_read_b32 v10, v29
  v_mfma_f32_16x16x32_bf16 v[92:95], v[252:255], v[112:115], v[92:95]
  ds_add_u32 v30, v31
  v_mfma_f32_16x16x32_bf16 v[100:103], v[252:255], v[116:119], v[100:103]
  s_add_u32 s45, s59, 8192
  buffer_load_dwordx4 v[240:243], v32, s[20:23], s45 offen offset:0 sc1
  v_mfma_f32_16x16x32_bf16 v[96:99], v[248:251], v[116:119], v[96:99]
  buffer_load_dwordx4 v[244:247], v32, s[20:23], s45 offen offset:1024 sc1
  s_waitcnt lgkmcnt(2)
  v_mfma_f32_16x16x32_bf16 v[72:75], v[136:139], v[120:123], v[72:75]
  s_waitcnt lgkmcnt(1)
  v_cmp_gt_u32 vcc, 10, v10
  s_cbranch_vccnz SLOW_27
JOIN_28:
  ds_read_b128 v[104:107], v24 offset:0
  v_mfma_f32_16x16x32_bf16 v[76:79], v[140:143], v[120:123], v[76:79]
  ds_read_b128 v[108:111], v24 offset:2048
  v_mfma_f32_16x16x32_bf16 v[84:87], v[140:143], v[124:127], v[84:87]
  ds_read_b128 v[112:115], v24 offset:4096
  v_mfma_f32_16x16x32_bf16 v[80:83], v[136:139], v[124:127], v[80:83]
  ds_read_b128 v[116:119], v24 offset:6144
  v_mfma_f32_16x16x32_bf16 v[88:91], v[136:139], v[128:131], v[88:91]
  buffer_load_dwordx4 v[248:251], v32, s[20:23], s45 offen offset:2048 sc1
  v_mfma_f32_16x16x32_bf16 v[92:95], v[140:143], v[128:131], v[92:95]
  v_mfma_f32_16x16x32_bf16 v[100:103], v[140:143], v[132:135], v[100:103]
  buffer_load_dwordx4 v[252:255], v32, s[20:23], s45 offen offset:3072 sc1
  v_mfma_f32_16x16x32_bf16 v[96:99], v[136:139], v[132:135], v[96:99]
  s_waitcnt vmcnt(26) lgkmcnt(0)
  v_mfma_f32_16x16x32_bf16 v[40:43], v[144:147], v[104:107], v[40:43]
  ds_read_b128 v[120:123], v25 offset:0
  v_mfma_f32_16x16x32_bf16 v[44:47], v[148:151], v[104:107], v[44:47]
  ds_read_b128 v[124:127], v25 offset:2048
  v_mfma_f32_16x16x32_bf16 v[52:55], v[148:151], v[108:111], v[52:55]
  ds_read_b128 v[128:131], v25 offset:4096
  v_mfma_f32_16x16x32_bf16 v[48:51], v[144:147], v[108:111], v[48:51]
  ds_read_b128 v[132:135], v25 offset:6144
  v_mfma_f32_16x16x32_bf16 v[56:59], v[144:147], v[112:115], v[56:59]
  s_add_u32 s45, s59, 12288
  buffer_load_dwordx4 v[136:139], v32, s[20:23], s45 offen offset:0 sc1
  v_mfma_f32_16x16x32_bf16 v[60:63], v[148:151], v[112:115], v[60:63]
  v_mfma_f32_16x16x32_bf16 v[68:71], v[148:151], v[116:119], v[68:71]
  buffer_load_dwordx4 v[140:143], v32, s[20:23], s45 offen offset:1024 sc1
  v_mfma_f32_16x16x32_bf16 v[64:67], v[144:147], v[116:119], v[64:67]
  s_waitcnt vmcnt(26) lgkmcnt(0)
  v_mfma_f32_16x16x32_bf16 v[40:43], v[152:155], v[120:123], v[40:43]
  ds_read_b128 v[104:107], v24 offset:8192
  v_mfma_f32_16x16x32_bf16 v[44:47], v[156:159], v[120:123], v[44:47]
  ds_read_b128 v[108:111], v24 offset:10240
  v_mfma_f32_16x16x32_bf16 v[52:55], v[156:159], v[124:127], v[52:55]
  ds_read_b128 v[112:115], v24 offset:12288
  v_mfma_f32_16x16x32_bf16 v[48:51], v[152:155], v[124:127], v[48:51]
  ds_read_b128 v[116:119], v24 offset:14336
  v_mfma_f32_16x16x32_bf16 v[56:59], v[152:155], v[128:131], v[56:59]
  v_mfma_f32_16x16x32_bf16 v[60:63], v[156:159], v[128:131], v[60:63]
  v_mfma_f32_16x16x32_bf16 v[68:71], v[156:159], v[132:135], v[68:71]
  v_mfma_f32_16x16x32_bf16 v[64:67], v[152:155], v[132:135], v[64:67]
  s_waitcnt vmcnt(24) lgkmcnt(0)
  v_mfma_f32_16x16x32_bf16 v[40:43], v[160:163], v[104:107], v[40:43]
  ds_read_b128 v[120:123], v25 offset:8192
  v_mfma_f32_16x16x32_bf16 v[44:47], v[164:167], v[104:107], v[44:47]
  ds_read_b128 v[124:127], v25 offset:10240
  v_mfma_f32_16x16x32_bf16 v[52:55], v[164:167], v[108:111], v[52:55]
  ds_read_b128 v[128:131], v25 offset:12288
  v_mfma_f32_16x16x32_bf16 v[48:51], v[160:163], v[108:111], v[48:51]
  ds_read_b128 v[132:135], v25 offset:14336
  v_mfma_f32_16x16x32_bf16 v[56:59], v[160:163], v[112:115], v[56:59]
  ds_read_b32 v10, v29
  v_mfma_f32_16x16x32_bf16 v[60:63], v[164:167], v[112:115], v[60:63]
  v_mfma_f32_16x16x32_bf16 v[68:71], v[164:167], v[116:119], v[68:71]
  ds_add_u32 v30, v31
  v_mfma_f32_16x16x32_bf16 v[64:67], v[160:163], v[116:119], v[64:67]
  s_waitcnt vmcnt(22) lgkmcnt(2)
  v_mfma_f32_16x16x32_bf16 v[40:43], v[168:171], v[120:123], v[40:43]
  s_waitcnt lgkmcnt(1)
  v_cmp_gt_u32 vcc, 11, v10
  s_cbranch_vccnz SLOW_30
JOIN_31:
  ds_read_b128 v[104:107], v24 offset:16384
  v_mfma_f32_16x16x32_bf16 v[44:47], v[172:175], v[120:123], v[44:47]
  ds_read_b128 v[108:111], v24 offset:18432
  v_mfma_f32_16x16x32_bf16 v[52:55], v[172:175], v[124:127], v[52:55]
  ds_read_b128 v[112:115], v24 offset:20480
  v_mfma_f32_16x16x32_bf16 v[48:51], v[168:171], v[124:127], v[48:51]
  ds_read_b128 v[116:119], v24 offset:22528
  v_mfma_f32_16x16x32_bf16 v[56:59], v[168:171], v[128:131], v[56:59]
  v_mfma_f32_16x16x32_bf16 v[60:63], v[172:175], v[128:131], v[60:63]
  v_mfma_f32_16x16x32_bf16 v[68:71], v[172:175], v[132:135], v[68:71]
  v_mfma_f32_16x16x32_bf16 v[64:67], v[168:171], v[132:135], v[64:67]
  s_waitcnt lgkmcnt(0)
  v_mfma_f32_16x16x32_bf16 v[72:75], v[144:147], v[104:107], v[72:75]
  ds_read_b128 v[120:123], v25 offset:16384
  v_mfma_f32_16x16x32_bf16 v[76:79], v[148:151], v[104:107], v[76:79]
  ds_read_b128 v[124:127], v25 offset:18432
  v_mfma_f32_16x16x32_bf16 v[84:87], v[148:151], v[108:111], v[84:87]
  ds_read_b128 v[128:131], v25 offset:20480
  v_mfma_f32_16x16x32_bf16 v[80:83], v[144:147], v[108:111], v[80:83]
  ds_read_b128 v[132:135], v25 offset:22528
  v_mfma_f32_16x16x32_bf16 v[88:91], v[144:147], v[112:115], v[88:91]
  v_mfma_f32_16x16x32_bf16 v[92:95], v[148:151], v[112:115], v[92:95]
  v_mfma_f32_16x16x32_bf16 v[100:103], v[148:151], v[116:119], v[100:103]
  v_mfma_f32_16x16x32_bf16 v[96:99], v[144:147], v[116:119], v[96:99]
  s_waitcnt lgkmcnt(0)
  v_mfma_f32_16x16x32_bf16 v[72:75], v[152:155], v[120:123], v[72:75]
  ds_read_b128 v[104:107], v20 offset:0
  v_mfma_f32_16x16x32_bf16 v[76:79], v[156:159], v[120:123], v[76:79]
  ds_read_b128 v[108:111], v20 offset:2048
  v_mfma_f32_16x16x32_bf16 v[84:87], v[156:159], v[124:127], v[84:87]
  ds_read_b128 v[112:115], v20 offset:4096
  v_mfma_f32_16x16x32_bf16 v[80:83], v[152:155], v[124:127], v[80:83]
  ds_read_b128 v[116:119], v20 offset:6144
  v_mfma_f32_16x16x32_bf16 v[88:91], v[152:155], v[128:131], v[88:91]
  buffer_load_dwordx4 v[144:147], v32, s[20:23], s45 offen offset:2048 sc1
  v_mfma_f32_16x16x32_bf16 v[92:95], v[156:159], v[128:131], v[92:95]
  v_mfma_f32_16x16x32_bf16 v[100:103], v[156:159], v[132:135], v[100:103]
  buffer_load_dwordx4 v[148:151], v32, s[20:23], s45 offen offset:3072 sc1
  v_mfma_f32_16x16x32_bf16 v[96:99], v[152:155], v[132:135], v[96:99]
  s_waitcnt lgkmcnt(0)
  v_mfma_f32_16x16x32_bf16 v[72:75], v[160:163], v[104:107], v[72:75]
  ds_read_b128 v[120:123], v21 offset:0
  v_mfma_f32_16x16x32_bf16 v[76:79], v[164:167], v[104:107], v[76:79]
  ds_read_b128 v[124:127], v21 offset:2048
  v_mfma_f32_16x16x32_bf16 v[84:87], v[164:167], v[108:111], v[84:87]
  ds_read_b128 v[128:131], v21 offset:4096
  v_mfma_f32_16x16x32_bf16 v[80:83], v[160:163], v[108:111], v[80:83]
  ds_read_b128 v[132:135], v21 offset:6144
  v_mfma_f32_16x16x32_bf16 v[88:91], v[160:163], v[112:115], v[88:91]
  ds_read_b32 v10, v29
  v_mfma_f32_16x16x32_bf16 v[92:95], v[164:167], v[112:115], v[92:95]
  v_mfma_f32_16x16x32_bf16 v[100:103], v[164:167], v[116:119], v[100:103]
  ds_add_u32 v30, v31
  v_mfma_f32_16x16x32_bf16 v[96:99], v[160:163], v[116:119], v[96:99]
  s_waitcnt lgkmcnt(2)
  v_mfma_f32_16x16x32_bf16 v[72:75], v[168:171], v[120:123], v[72:75]
  s_waitcnt lgkmcnt(1)
  v_cmp_gt_u32 vcc, 12, v10
  s_cbranch_vccnz SLOW_33
JOIN_34:
  ds_read_b128 v[104:107], v20 offset:8192
  v_mfma_f32_16x16x32_bf16 v[76:79], v[172:175], v[120:123], v[76:79]
  ds_read_b128 v[108:111], v20 offset:10240
  v_mfma_f32_16x16x32_bf16 v[84:87], v[172:175], v[124:127], v[84:87]
  ds_read_b128 v[112:115], v20 offset:12288
  v_mfma_f32_16x16x32_bf16 v[80:83], v[168:171], v[124:127], v[80:83]
  ds_read_b128 v[116:119], v20 offset:14336
  v_mfma_f32_16x16x32_bf16 v[88:91], v[168:171], v[128:131], v[88:91]
  v_mfma_f32_16x16x32_bf16 v[92:95], v[172:175], v[128:131], v[92:95]
  v_mfma_f32_16x16x32_bf16 v[100:103], v[172:175], v[132:135], v[100:103]
  v_mfma_f32_16x16x32_bf16 v[96:99], v[168:171], v[132:135], v[96:99]
  s_waitcnt vmcnt(22) lgkmcnt(0)
  v_mfma_f32_16x16x32_bf16 v[40:43], v[176:179], v[104:107], v[40:43]
  ds_read_b128 v[120:123], v21 offset:8192
  v_mfma_f32_16x16x32_bf16 v[44:47], v[180:183], v[104:107], v[44:47]
  ds_read_b128 v[124:127], v21 offset:10240
  v_mfma_f32_16x16x32_bf16 v[52:55], v[180:183], v[108:111], v[52:55]
  ds_read_b128 v[128:131], v21 offset:12288
  v_mfma_f32_16x16x32_bf16 v[48:51], v[176:179], v[108:111], v[48:51]
  ds_read_b128 v[132:135], v21 offset:14336
  v_mfma_f32_16x16x32_bf16 v[56:59], v[176:179], v[112:115], v[56:59]
  v_mfma_f32_16x16x32_bf16 v[60:63], v[180:183], v[112:115], v[60:63]
  v_mfma_f32_16x16x32_bf16 v[68:71], v[180:183], v[116:119], v[68:71]
  v_mfma_f32_16x16x32_bf16 v[64:67], v[176:179], v[116:119], v[64:67]
  s_waitcnt vmcnt(20) lgkmcnt(0)
  v_mfma_f32_16x16x32_bf16 v[40:43], v[184:187], v[120:123], v[40:43]
  ds_read_b128 v[104:107], v20 offset:16384
  v_mfma_f32_16x16x32_bf16 v[44:47], v[188:191], v[120:123], v[44:47]
  ds_read_b128 v[108:111], v20 offset:18432
  v_mfma_f32_16x16x32_bf16 v[52:55], v[188:191], v[124:127], v[52:55]
  ds_read_b128 v[112:115], v20 offset:20480
  v_mfma_f32_16x16x32_bf16 v[48:51], v[184:187], v[124:127], v[48:51]
  ds_read_b128 v[116:119], v20 offset:22528
  v_mfma_f32_16x16x32_bf16 v[56:59], v[184:187], v[128:131], v[56:59]
  v_mfma_f32_16x16x32_bf16 v[60:63], v[188:191], v[128:131], v[60:63]
  v_mfma_f32_16x16x32_bf16 v[68:71], v[188:191], v[132:135], v[68:71]
  v_mfma_f32_16x16x32_bf16 v[64:67], v[184:187], v[132:135], v[64:67]
  s_waitcnt vmcnt(18) lgkmcnt(0)
  v_mfma_f32_16x16x32_bf16 v[40:43], v[192:195], v[104:107], v[40:43]
  ds_read_b128 v[120:123], v21 offset:16384
  v_mfma_f32_16x16x32_bf16 v[44:47], v[196:199], v[104:107], v[44:47]
  ds_read_b128 v[124:127], v21 offset:18432
  v_mfma_f32_16x16x32_bf16 v[52:55], v[196:199], v[108:111], v[52:55]
  ds_read_b128 v[128:131], v21 offset:20480
  v_mfma_f32_16x16x32_bf16 v[48:51], v[192:195], v[108:111], v[48:51]
  ds_read_b128 v[132:135], v21 offset:22528
  v_mfma_f32_16x16x32_bf16 v[56:59], v[192:195], v[112:115], v[56:59]
  ds_read_b32 v10, v29
  v_mfma_f32_16x16x32_bf16 v[60:63], v[196:199], v[112:115], v[60:63]
  v_mfma_f32_16x16x32_bf16 v[68:71], v[196:199], v[116:119], v[68:71]
  ds_add_u32 v30, v31
  v_mfma_f32_16x16x32_bf16 v[64:67], v[192:195], v[116:119], v[64:67]
  s_waitcnt vmcnt(16) lgkmcnt(2)
  v_mfma_f32_16x16x32_bf16 v[40:43], v[200:203], v[120:123], v[40:43]
  s_waitcnt lgkmcnt(1)
  v_cmp_gt_u32 vcc, 13, v10
  s_cbranch_vccnz SLOW_36
JOIN_37:
  ds_read_b128 v[104:107], v20 offset:24576
  v_mfma_f32_16x16x32_bf16 v[44:47], v[204:207], v[120:123], v[44:47]
  ds_read_b128 v[108:111], v20 offset:26624
  v_mfma_f32_16x16x32_bf16 v[52:55], v[204:207], v[124:127], v[52:55]
  ds_read_b128 v[112:115], v20 offset:28672
  v_mfma_f32_16x16x32_bf16 v[48:51], v[200:203], v[124:127], v[48:51]
  ds_read_b128 v[116:119], v20 offset:30720
  v_mfma_f32_16x16x32_bf16 v[56:59], v[200:203], v[128:131], v[56:59]
  v_mfma_f32_16x16x32_bf16 v[60:63], v[204:207], v[128:131], v[60:63]
  v_mfma_f32_16x16x32_bf16 v[68:71], v[204:207], v[132:135], v[68:71]
  v_mfma_f32_16x16x32_bf16 v[64:67], v[200:203], v[132:135], v[64:67]
  s_waitcnt vmcnt(14) lgkmcnt(0)
  v_mfma_f32_16x16x32_bf16 v[40:43], v[208:211], v[104:107], v[40:43]
  ds_read_b128 v[120:123], v21 offset:24576
  v_mfma_f32_16x16x32_bf16 v[44:47], v[212:215], v[104:107], v[44:47]
  ds_read_b128 v[124:127], v21 offset:26624
  v_mfma_f32_16x16x32_bf16 v[52:55], v[212:215], v[108:111], v[52:55]
  ds_read_b128 v[128:131], v21 offset:28672
  v_mfma_f32_16x16x32_bf16 v[48:51], v[208:211], v[108:111], v[48:51]
  ds_read_b128 v[132:135], v21 offset:30720
  v_mfma_f32_16x16x32_bf16 v[56:59], v[208:211], v[112:115], v[56:59]
  v_mfma_f32_16x16x32_bf16 v[60:63], v[212:215], v[112:115], v[60:63]
  v_mfma_f32_16x16x32_bf16 v[68:71], v[212:215], v[116:119], v[68:71]
  v_mfma_f32_16x16x32_bf16 v[64:67], v[208:211], v[116:119], v[64:67]
  s_waitcnt vmcnt(12) lgkmcnt(0)
  v_mfma_f32_16x16x32_bf16 v[40:43], v[216:219], v[120:123], v[40:43]
  ds_read_b128 v[104:107], v20 offset:32768
  v_mfma_f32_16x16x32_bf16 v[44:47], v[220:223], v[120:123], v[44:47]
  ds_read_b128 v[108:111], v20 offset:34816
  v_mfma_f32_16x16x32_bf16 v[52:55], v[220:223], v[124:127], v[52:55]
  ds_read_b128 v[112:115], v20 offset:36864
  v_mfma_f32_16x16x32_bf16 v[48:51], v[216:219], v[124:127], v[48:51]
  ds_read_b128 v[116:119], v20 offset:38912
  v_mfma_f32_16x16x32_bf16 v[56:59], v[216:219], v[128:131], v[56:59]
  v_mfma_f32_16x16x32_bf16 v[60:63], v[220:223], v[128:131], v[60:63]
  v_mfma_f32_16x16x32_bf16 v[68:71], v[220:223], v[132:135], v[68:71]
  v_mfma_f32_16x16x32_bf16 v[64:67], v[216:219], v[132:135], v[64:67]
  s_waitcnt vmcnt(10) lgkmcnt(0)
  v_mfma_f32_16x16x32_bf16 v[40:43], v[224:227], v[104:107], v[40:43]
  ds_read_b128 v[120:123], v21 offset:32768
  v_mfma_f32_16x16x32_bf16 v[44:47], v[228:231], v[104:107], v[44:47]
  ds_read_b128 v[124:127], v21 offset:34816
  v_mfma_f32_16x16x32_bf16 v[52:55], v[228:231], v[108:111], v[52:55]
  ds_read_b128 v[128:131], v21 offset:36864
  v_mfma_f32_16x16x32_bf16 v[48:51], v[224:227], v[108:111], v[48:51]
  ds_read_b128 v[132:135], v21 offset:38912
  v_mfma_f32_16x16x32_bf16 v[56:59], v[224:227], v[112:115], v[56:59]
  ds_read_b32 v10, v29
  v_mfma_f32_16x16x32_bf16 v[60:63], v[228:231], v[112:115], v[60:63]
  v_mfma_f32_16x16x32_bf16 v[68:71], v[228:231], v[116:119], v[68:71]
  ds_add_u32 v30, v31
  v_mfma_f32_16x16x32_bf16 v[64:67], v[224:227], v[116:119], v[64:67]
  s_waitcnt vmcnt(8) lgkmcnt(2)
  v_mfma_f32_16x16x32_bf16 v[40:43], v[232:235], v[120:123], v[40:43]
  s_waitcnt lgkmcnt(1)
  v_cmp_gt_u32 vcc, 14, v10
  s_cbranch_vccnz SLOW_39
JOIN_40:
  ds_read_b128 v[104:107], v20 offset:40960
  v_mfma_f32_16x16x32_bf16 v[44:47], v[236:239], v[120:123], v[44:47]
  ds_read_b128 v[108:111], v20 offset:43008
  v_mfma_f32_16x16x32_bf16 v[52:55], v[236:239], v[124:127], v[52:55]
  ds_read_b128 v[112:115], v20 offset:45056
  v_mfma_f32_16x16x32_bf16 v[48:51], v[232:235], v[124:127], v[48:51]
  ds_read_b128 v[116:119], v20 offset:47104
  v_mfma_f32_16x16x32_bf16 v[56:59], v[232:235], v[128:131], v[56:59]
  v_mfma_f32_16x16x32_bf16 v[60:63], v[236:239], v[128:131], v[60:63]
  v_mfma_f32_16x16x32_bf16 v[68:71], v[236:239], v[132:135], v[68:71]
  v_mfma_f32_16x16x32_bf16 v[64:67], v[232:235], v[132:135], v[64:67]
  s_waitcnt vmcnt(6) lgkmcnt(0)
  v_mfma_f32_16x16x32_bf16 v[40:43], v[240:243], v[104:107], v[40:43]
  ds_read_b128 v[120:123], v21 offset:40960
  v_mfma_f32_16x16x32_bf16 v[44:47], v[244:247], v[104:107], v[44:47]
  ds_read_b128 v[124:127], v21 offset:43008
  v_mfma_f32_16x16x32_bf16 v[52:55], v[244:247], v[108:111], v[52:55]
  ds_read_b128 v[128:131], v21 offset:45056
  v_mfma_f32_16x16x32_bf16 v[48:51], v[240:243], v[108:111], v[48:51]
  ds_read_b128 v[132:135], v21 offset:47104
  v_mfma_f32_16x16x32_bf16 v[56:59], v[240:243], v[112:115], v[56:59]
  v_mfma_f32_16x16x32_bf16 v[60:63], v[244:247], v[112:115], v[60:63]
  v_mfma_f32_16x16x32_bf16 v[68:71], v[244:247], v[116:119], v[68:71]
  v_mfma_f32_16x16x32_bf16 v[64:67], v[240:243], v[116:119], v[64:67]
  s_waitcnt vmcnt(4) lgkmcnt(0)
  v_mfma_f32_16x16x32_bf16 v[40:43], v[248:251], v[120:123], v[40:43]
  ds_read_b128 v[104:107], v20 offset:49152
  v_mfma_f32_16x16x32_bf16 v[44:47], v[252:255], v[120:123], v[44:47]
  ds_read_b128 v[108:111], v20 offset:51200
  v_mfma_f32_16x16x32_bf16 v[52:55], v[252:255], v[124:127], v[52:55]
  ds_read_b128 v[112:115], v20 offset:53248
  v_mfma_f32_16x16x32_bf16 v[48:51], v[248:251], v[124:127], v[48:51]
  ds_read_b128 v[116:119], v20 offset:55296
  v_mfma_f32_16x16x32_bf16 v[56:59], v[248:251], v[128:131], v[56:59]
  v_mfma_f32_16x16x32_bf16 v[60:63], v[252:255], v[128:131], v[60:63]
  v_mfma_f32_16x16x32_bf16 v[68:71], v[252:255], v[132:135], v[68:71]
  v_mfma_f32_16x16x32_bf16 v[64:67], v[248:251], v[132:135], v[64:67]
  s_waitcnt vmcnt(2) lgkmcnt(0)
  v_mfma_f32_16x16x32_bf16 v[40:43], v[136:139], v[104:107], v[40:43]
  ds_read_b128 v[120:123], v21 offset:49152
  v_mfma_f32_16x16x32_bf16 v[44:47], v[140:143], v[104:107], v[44:47]
  ds_read_b128 v[124:127], v21 offset:51200
  v_mfma_f32_16x16x32_bf16 v[52:55], v[140:143], v[108:111], v[52:55]
  ds_read_b128 v[128:131], v21 offset:53248
  v_mfma_f32_16x16x32_bf16 v[48:51], v[136:139], v[108:111], v[48:51]
  ds_read_b128 v[132:135], v21 offset:55296
  v_mfma_f32_16x16x32_bf16 v[56:59], v[136:139], v[112:115], v[56:59]
  ds_read_b32 v10, v29
  v_mfma_f32_16x16x32_bf16 v[60:63], v[140:143], v[112:115], v[60:63]
  ds_add_u32 v30, v31
  v_mfma_f32_16x16x32_bf16 v[68:71], v[140:143], v[116:119], v[68:71]
SP_42:
  ds_read_b32 v10, v34 offset:256
  s_sub_u32 s13, s13, 1
  s_cbranch_scc1 ABORT
  s_waitcnt lgkmcnt(0)
  v_cmp_gt_u32 vcc, 2, v10
  s_cbranch_vccnz SP_42
  ds_read_b32 v8, v34 offset:640
  s_lshl_b32 s51, s3, 7
  v_lshl_add_u32 v9, v35, 1, s51
  v_subrev_u32 v9, 157696, v9
  ds_read_b32 v4, v36 offset:3584
  ds_read_b32 v5, v36 offset:3648
  ds_read_b32 v6, v36 offset:3712
  ds_read_b32 v7, v36 offset:3776
  ds_read_b32 v168, v36 offset:4608
  ds_read_b32 v169, v36 offset:4672
  ds_read_b32 v170, v36 offset:4736
  ds_read_b32 v171, v36 offset:4800
  ds_read_b128 v[160:163], v9 offset:3072
  ds_read_b128 v[152:155], v9 offset:2560
  ds_read_b128 v[164:167], v9 offset:3088
  ds_read_b128 v[156:159], v9 offset:2576
  v_mfma_f32_16x16x32_bf16 v[64:67], v[136:139], v[116:119], v[64:67]
  s_waitcnt vmcnt(0)
  v_mfma_f32_16x16x32_bf16 v[40:43], v[144:147], v[120:123], v[40:43]
  v_cmp_gt_u32 vcc, 15, v10
  s_cbranch_vccnz SLOW_43
JOIN_44:
  ds_read_b128 v[104:107], v20 offset:57344
  v_mfma_f32_16x16x32_bf16 v[44:47], v[148:151], v[120:123], v[44:47]
  ds_read_b128 v[108:111], v20 offset:59392
  v_mfma_f32_16x16x32_bf16 v[52:55], v[148:151], v[124:127], v[52:55]
  ds_read_b128 v[112:115], v20 offset:61440
  v_mfma_f32_16x16x32_bf16 v[48:51], v[144:147], v[124:127], v[48:51]
  ds_read_b128 v[116:119], v20 offset:63488
  v_mfma_f32_16x16x32_bf16 v[56:59], v[144:147], v[128:131], v[56:59]
  s_lshl_b32 s46, s9, 18
  s_lshl_b32 s44, s8, 13
  s_add_u32 s46, s46, s44
  s_lshl_b32 s44, s3, 11
  s_add_u32 s46, s46, s44
  s_lshl_b32 s44, s7, 10
  s_add_u32 s46, s46, s44
  s_add_u32 s46, s46, 0x400000
  s_add_u32 s47, s46, 65536
  s_add_u32 s48, s46, 131072
  s_add_u32 s49, s46, 196608
  s_lshl_b32 s51, s9, 9
  s_lshl_b32 s44, s8, 6
  s_add_u32 s51, s51, s44
  s_lshl_b32 s44, s7, 5
  s_add_u32 s51, s51, s44
  s_lshl_b32 s44, s3, 3
  s_add_u32 s51, s51, s44
  s_add_u32 s51, s51, 0x5c000
  s_add_u32 s52, s51, 256
  s_waitcnt lgkmcnt(4)
  v_readfirstlane_b32 s17, v8
  v_add_u32 v9, 0x8000, v32
  v_mfma_f32_16x16x32_bf16 v[60:63], v[148:151], v[128:131], v[60:63]
  v_mfma_f32_16x16x32_bf16 v[68:71], v[148:151], v[132:135], v[68:71]
  v_mfma_f32_16x16x32_bf16 v[64:67], v[144:147], v[132:135], v[64:67]
  s_waitcnt lgkmcnt(0)
  v_mfma_f32_16x16x32_bf16 v[72:75], v[176:179], v[104:107], v[72:75]
  ds_read_b128 v[120:123], v21 offset:57344
  v_mfma_f32_16x16x32_bf16 v[76:79], v[180:183], v[104:107], v[76:79]
  ds_read_b128 v[124:127], v21 offset:59392
  v_mfma_f32_16x16x32_bf16 v[84:87], v[180:183], v[108:111], v[84:87]
  ds_read_b128 v[128:131], v21 offset:61440
  v_mfma_f32_16x16x32_bf16 v[80:83], v[176:179], v[108:111], v[80:83]
  ds_read_b128 v[132:135], v21 offset:63488
  v_mfma_f32_16x16x32_bf16 v[88:91], v[176:179], v[112:115], v[88:91]
  v_mul_f32 v12, v160, v4
  v_mul_f32 v13, v161, v4
  v_mul_f32 v14, v162, v4
  v_mul_f32 v15, v163, v4
  v_mfma_f32_16x16x32_bf16 v[92:95], v[180:183], v[112:115], v[92:95]
  v_mul_f32 v16, v164, v4
  v_mul_f32 v17, v165, v4
  v_mul_f32 v18, v166, v4
  v_mul_f32 v19, v167, v4
  v_mfma_f32_16x16x32_bf16 v[100:103], v[180:183], v[116:119], v[100:103]
  v_pk_fma_f32 v[40:41], v[40:41], v[152:153], v[12:13]
  v_pk_fma_f32 v[42:43], v[42:43], v[154:155], v[14:15]
  v_pk_fma_f32 v[44:45], v[44:45], v[156:157], v[16:17]
  v_pk_fma_f32 v[46:47], v[46:47], v[158:159], v[18:19]
  v_mfma_f32_16x16x32_bf16 v[96:99], v[176:179], v[116:119], v[96:99]
  v_cvt_pk_bf16_f32 v40, v40, v44
  v_cvt_pk_bf16_f32 v41, v41, v45
  v_cvt_pk_bf16_f32 v42, v42, v46
  v_cvt_pk_bf16_f32 v43, v43, v47
  buffer_store_dwordx4 v[40:43], v32, s[20:23], s46 offen sc1
  s_waitcnt lgkmcnt(0)
  v_mfma_f32_16x16x32_bf16 v[72:75], v[184:187], v[120:123], v[72:75]
  ds_read_b128 v[104:107], v22 offset:0
  v_mfma_f32_16x16x32_bf16 v[76:79], v[188:191], v[120:123], v[76:79]
  ds_read_b128 v[108:111], v22 offset:2048
  v_mfma_f32_16x16x32_bf16 v[84:87], v[188:191], v[124:127], v[84:87]
  ds_read_b128 v[112:115], v22 offset:4096
  v_mfma_f32_16x16x32_bf16 v[80:83], v[184:187], v[124:127], v[80:83]
  ds_read_b128 v[116:119], v22 offset:6144
  v_mfma_f32_16x16x32_bf16 v[88:91], v[184:187], v[128:131], v[88:91]
  v_mul_f32 v12, v160, v5
  v_mul_f32 v13, v161, v5
  v_mul_f32 v14, v162, v5
  v_mul_f32 v15, v163, v5
  v_mfma_f32_16x16x32_bf16 v[92:95], v[188:191], v[128:131], v[92:95]
  v_mul_f32 v16, v164, v5
  v_mul_f32 v17, v165, v5
  v_mul_f32 v18, v166, v5
  v_mul_f32 v19, v167, v5
  v_mfma_f32_16x16x32_bf16 v[100:103], v[188:191], v[132:135], v[100:103]
  v_pk_fma_f32 v[48:49], v[48:49], v[152:153], v[12:13]
  v_pk_fma_f32 v[50:51], v[50:51], v[154:155], v[14:15]
  v_pk_fma_f32 v[52:53], v[52:53], v[156:157], v[16:17]
  v_pk_fma_f32 v[54:55], v[54:55], v[158:159], v[18:19]
  v_mfma_f32_16x16x32_bf16 v[96:99], v[184:187], v[132:135], v[96:99]
  v_cvt_pk_bf16_f32 v48, v48, v52
  v_cvt_pk_bf16_f32 v49, v49, v53
  v_cvt_pk_bf16_f32 v50, v50, v54
  v_cvt_pk_bf16_f32 v51, v51, v55
  buffer_store_dwordx4 v[48:51], v32, s[20:23], s47 offen sc1
  s_waitcnt lgkmcnt(0)
  v_mfma_f32_16x16x32_bf16 v[72:75], v[192:195], v[104:107], v[72:75]
  ds_read_b128 v[120:123], v23 offset:0
  v_mfma_f32_16x16x32_bf16 v[76:79], v[196:199], v[104:107], v[76:79]
  ds_read_b128 v[124:127], v23 offset:2048
  v_mfma_f32_16x16x32_bf16 v[84:87], v[196:199], v[108:111], v[84:87]
  ds_read_b128 v[128:131], v23 offset:4096
  v_mfma_f32_16x16x32_bf16 v[80:83], v[192:195], v[108:111], v[80:83]
  ds_read_b128 v[132:135], v23 offset:6144
  v_mfma_f32_16x16x32_bf16 v[88:91], v[192:195], v[112:115], v[88:91]
  ds_read_b32 v10, v29
  ds_add_u32 v30, v31
  v_mfma_f32_16x16x32_bf16 v[92:95], v[196:199], v[112:115], v[92:95]
  v_mul_f32 v12, v160, v6
  v_mul_f32 v13, v161, v6
  v_mul_f32 v14, v162, v6
  v_mul_f32 v15, v163, v6
  v_mfma_f32_16x16x32_bf16 v[100:103], v[196:199], v[116:119], v[100:103]
  v_mul_f32 v16, v164, v6
  v_mul_f32 v17, v165, v6
  v_mul_f32 v18, v166, v6
  v_mul_f32 v19, v167, v6
  v_pk_fma_f32 v[56:57], v[56:57], v[152:153], v[12:13]
  v_pk_fma_f32 v[58:59], v[58:59], v[154:155], v[14:15]
  v_pk_fma_f32 v[60:61], v[60:61], v[156:157], v[16:17]
  v_pk_fma_f32 v[62:63], v[62:63], v[158:159], v[18:19]
  v_mfma_f32_16x16x32_bf16 v[96:99], v[192:195], v[116:119], v[96:99]
  v_cvt_pk_bf16_f32 v56, v56, v60
  v_cvt_pk_bf16_f32 v57, v57, v61
  v_cvt_pk_bf16_f32 v58, v58, v62
  v_cvt_pk_bf16_f32 v59, v59, v63
  buffer_store_dwordx4 v[56:59], v32, s[20:23], s48 offen sc1
  s_waitcnt lgkmcnt(2)
  v_mfma_f32_16x16x32_bf16 v[72:75], v[200:203], v[120:123], v[72:75]
  s_waitcnt lgkmcnt(1)
  v_cmp_gt_u32 vcc, 16, v10
  s_cbranch_vccnz SLOW_46
JOIN_47:
  ds_read_b128 v[104:107], v22 offset:8192
  v_mfma_f32_16x16x32_bf16 v[76:79], v[204:207], v[120:123], v[76:79]
  ds_read_b128 v[108:111], v22 offset:10240
  v_mfma_f32_16x16x32_bf16 v[84:87], v[204:207], v[124:127], v[84:87]
  ds_read_b128 v[112:115], v22 offset:12288
  v_mfma_f32_16x16x32_bf16 v[80:83], v[200:203], v[124:127], v[80:83]
  ds_read_b128 v[116:119], v22 offset:14336
  v_mfma_f32_16x16x32_bf16 v[88:91], v[200:203], v[128:131], v[88:91]
  v_mul_f32 v12, v160, v7
  v_mul_f32 v13, v161, v7
  v_mul_f32 v14, v162, v7
  v_mul_f32 v15, v163, v7
  v_mfma_f32_16x16x32_bf16 v[92:95], v[204:207], v[128:131], v[92:95]
  v_mul_f32 v16, v164, v7
  v_mul_f32 v17, v165, v7
  v_mul_f32 v18, v166, v7
  v_mul_f32 v19, v167, v7
  v_mfma_f32_16x16x32_bf16 v[100:103], v[204:207], v[132:135], v[100:103]
  v_pk_fma_f32 v[64:65], v[64:65], v[152:153], v[12:13]
  v_pk_fma_f32 v[66:67], v[66:67], v[154:155], v[14:15]
  v_pk_fma_f32 v[68:69], v[68:69], v[156:157], v[16:17]
  v_pk_fma_f32 v[70:71], v[70:71], v[158:159], v[18:19]
  v_mfma_f32_16x16x32_bf16 v[96:99], v[200:203], v[132:135], v[96:99]
  v_cvt_pk_bf16_f32 v64, v64, v68
  v_cvt_pk_bf16_f32 v65, v65, v69
  v_cvt_pk_bf16_f32 v66, v66, v70
  v_cvt_pk_bf16_f32 v67, v67, v71
  buffer_store_dwordx4 v[64:67], v32, s[20:23], s49 offen sc1
  s_waitcnt lgkmcnt(0)
  v_mfma_f32_16x16x32_bf16 v[72:75], v[208:211], v[104:107], v[72:75]
  ds_read_b128 v[120:123], v23 offset:8192
  v_mfma_f32_16x16x32_bf16 v[76:79], v[212:215], v[104:107], v[76:79]
  ds_read_b128 v[124:127], v23 offset:10240
  v_mfma_f32_16x16x32_bf16 v[84:87], v[212:215], v[108:111], v[84:87]
  ds_read_b128 v[128:131], v23 offset:12288
  v_mfma_f32_16x16x32_bf16 v[80:83], v[208:211], v[108:111], v[80:83]
  ds_read_b128 v[132:135], v23 offset:14336
  v_mfma_f32_16x16x32_bf16 v[88:91], v[208:211], v[112:115], v[88:91]
  v_mfma_f32_16x16x32_bf16 v[92:95], v[212:215], v[112:115], v[92:95]
  v_mfma_f32_16x16x32_bf16 v[100:103], v[212:215], v[116:119], v[100:103]
  v_mfma_f32_16x16x32_bf16 v[96:99], v[208:211], v[116:119], v[96:99]
  s_waitcnt lgkmcnt(0)
  v_mfma_f32_16x16x32_bf16 v[72:75], v[216:219], v[120:123], v[72:75]
  ds_read_b128 v[104:107], v22 offset:16384
  v_mfma_f32_16x16x32_bf16 v[76:79], v[220:223], v[120:123], v[76:79]
  ds_read_b128 v[108:111], v22 offset:18432
  v_mfma_f32_16x16x32_bf16 v[84:87], v[220:223], v[124:127], v[84:87]
  ds_read_b128 v[112:115], v22 offset:20480
  v_mfma_f32_16x16x32_bf16 v[80:83], v[216:219], v[124:127], v[80:83]
  ds_read_b128 v[116:119], v22 offset:22528
  v_mfma_f32_16x16x32_bf16 v[88:91], v[216:219], v[128:131], v[88:91]
  v_mfma_f32_16x16x32_bf16 v[92:95], v[220:223], v[128:131], v[92:95]
  v_mfma_f32_16x16x32_bf16 v[100:103], v[220:223], v[132:135], v[100:103]
  v_mfma_f32_16x16x32_bf16 v[96:99], v[216:219], v[132:135], v[96:99]
  s_waitcnt lgkmcnt(0)
  v_mfma_f32_16x16x32_bf16 v[72:75], v[224:227], v[104:107], v[72:75]
  ds_read_b128 v[120:123], v23 offset:16384
  v_mfma_f32_16x16x32_bf16 v[76:79], v[228:231], v[104:107], v[76:79]
  ds_read_b128 v[124:127], v23 offset:18432
  v_mfma_f32_16x16x32_bf16 v[84:87], v[228:231], v[108:111], v[84:87]
  ds_read_b128 v[128:131], v23 offset:20480
  v_mfma_f32_16x16x32_bf16 v[80:83], v[224:227], v[108:111], v[80:83]
  ds_read_b128 v[132:135], v23 offset:22528
  v_mfma_f32_16x16x32_bf16 v[88:91], v[224:227], v[112:115], v[88:91]
  ds_read_b32 v10, v29
  v_mfma_f32_16x16x32_bf16 v[92:95], v[228:231], v[112:115], v[92:95]
  v_mfma_f32_16x16x32_bf16 v[100:103], v[228:231], v[116:119], v[100:103]
  ds_add_u32 v30, v31
  v_mfma_f32_16x16x32_bf16 v[96:99], v[224:227], v[116:119], v[96:99]
  s_waitcnt lgkmcnt(2)
  v_mfma_f32_16x16x32_bf16 v[72:75], v[232:235], v[120:123], v[72:75]
  s_waitcnt lgkmcnt(1)
  v_cmp_gt_u32 vcc, 17, v10
  s_cbranch_vccnz SLOW_49
JOIN_50:
  ds_read_b128 v[104:107], v22 offset:24576
  v_mfma_f32_16x16x32_bf16 v[76:79], v[236:239], v[120:123], v[76:79]
  ds_read_b128 v[108:111], v22 offset:26624
  v_mfma_f32_16x16x32_bf16 v[84:87], v[236:239], v[124:127], v[84:87]
  ds_read_b128 v[112:115], v22 offset:28672
  v_mfma_f32_16x16x32_bf16 v[80:83], v[232:235], v[124:127], v[80:83]
  ds_read_b128 v[116:119], v22 offset:30720
  v_mfma_f32_16x16x32_bf16 v[88:91], v[232:235], v[128:131], v[88:91]
  v_mfma_f32_16x16x32_bf16 v[92:95], v[236:239], v[128:131], v[92:95]
  v_mfma_f32_16x16x32_bf16 v[100:103], v[236:239], v[132:135], v[100:103]
  v_mfma_f32_16x16x32_bf16 v[96:99], v[232:235], v[132:135], v[96:99]
  s_waitcnt lgkmcnt(0)
  v_mfma_f32_16x16x32_bf16 v[72:75], v[240:243], v[104:107], v[72:75]
  ds_read_b128 v[120:123], v23 offset:24576
  v_mfma_f32_16x16x32_bf16 v[76:79], v[244:247], v[104:107], v[76:79]
  ds_read_b128 v[124:127], v23 offset:26624
  v_mfma_f32_16x16x32_bf16 v[84:87], v[244:247], v[108:111], v[84:87]
  ds_read_b128 v[128:131], v23 offset:28672
  v_mfma_f32_16x16x32_bf16 v[80:83], v[240:243], v[108:111], v[80:83]
  ds_read_b128 v[132:135], v23 offset:30720
  v_mfma_f32_16x16x32_bf16 v[88:91], v[240:243], v[112:115], v[88:91]
  s_waitcnt vmcnt(0)
  s_cmp_lg_u32 s17, 1
  s_cbranch_scc1 MS_52
  v_mov_b32 v2, s14
  v_mov_b32 v3, s15
  s_mov_b64 exec, 1
  buffer_store_dwordx2 v[2:3], v33, s[24:27], s51 offen
  s_mov_b64 exec, -1
MJ_53:
  v_mfma_f32_16x16x32_bf16 v[92:95], v[244:247], v[112:115], v[92:95]
  v_mfma_f32_16x16x32_bf16 v[100:103], v[244:247], v[116:119], v[100:103]
  v_mfma_f32_16x16x32_bf16 v[96:99], v[240:243], v[116:119], v[96:99]
  s_waitcnt lgkmcnt(0)
  v_mfma_f32_16x16x32_bf16 v[72:75], v[248:251], v[120:123], v[72:75]
  ds_read_b128 v[104:107], v22 offset:32768
  v_mfma_f32_16x16x32_bf16 v[76:79], v[252:255], v[120:123], v[76:79]
  ds_read_b128 v[108:111], v22 offset:34816
  v_mfma_f32_16x16x32_bf16 v[84:87], v[252:255], v[124:127], v[84:87]
  ds_read_b128 v[112:115], v22 offset:36864
  v_mfma_f32_16x16x32_bf16 v[80:83], v[248:251], v[124:127], v[80:83]
  ds_read_b128 v[116:119], v22 offset:38912
  v_mfma_f32_16x16x32_bf16 v[88:91], v[248:251], v[128:131], v[88:91]
  v_mfma_f32_16x16x32_bf16 v[92:95], v[252:255], v[128:131], v[92:95]
  v_mfma_f32_16x16x32_bf16 v[100:103], v[252:255], v[132:135], v[100:103]
  v_mfma_f32_16x16x32_bf16 v[96:99], v[248:251], v[132:135], v[96:99]
  s_waitcnt lgkmcnt(0)
  v_mfma_f32_16x16x32_bf16 v[72:75], v[136:139], v[104:107], v[72:75]
  ds_read_b128 v[120:123], v23 offset:32768
  v_mfma_f32_16x16x32_bf16 v[76:79], v[140:143], v[104:107], v[76:79]
  ds_read_b128 v[124:127], v23 offset:34816
  v_mfma_f32_16x16x32_bf16 v[84:87], v[140:143], v[108:111], v[84:87]
  ds_read_b128 v[128:131], v23 offset:36864
  v_mfma_f32_16x16x32_bf16 v[80:83], v[136:139], v[108:111], v[80:83]
  ds_read_b128 v[132:135], v23 offset:38912
  v_mfma_f32_16x16x32_bf16 v[88:91], v[136:139], v[112:115], v[88:91]
  ds_add_u32 v30, v31
  v_mfma_f32_16x16x32_bf16 v[92:95], v[140:143], v[112:115], v[92:95]
  v_mfma_f32_16x16x32_bf16 v[100:103], v[140:143], v[116:119], v[100:103]
  v_mfma_f32_16x16x32_bf16 v[96:99], v[136:139], v[116:119], v[96:99]
  s_waitcnt lgkmcnt(1)
  v_mfma_f32_16x16x32_bf16 v[72:75], v[144:147], v[120:123], v[72:75]
  v_mfma_f32_16x16x32_bf16 v[76:79], v[148:151], v[120:123], v[76:79]
  v_mfma_f32_16x16x32_bf16 v[84:87], v[148:151], v[124:127], v[84:87]
  v_mfma_f32_16x16x32_bf16 v[80:83], v[144:147], v[124:127], v[80:83]
  v_mfma_f32_16x16x32_bf16 v[88:91], v[144:147], v[128:131], v[88:91]
  v_mfma_f32_16x16x32_bf16 v[92:95], v[148:151], v[128:131], v[92:95]
  v_mfma_f32_16x16x32_bf16 v[100:103], v[148:151], v[132:135], v[100:103]
  v_mfma_f32_16x16x32_bf16 v[96:99], v[144:147], v[132:135], v[96:99]
  v_mul_f32 v12, v160, v168
  v_mul_f32 v13, v161, v168
  v_mul_f32 v14, v162, v168
  v_mul_f32 v15, v163, v168
  v_mul_f32 v16, v164, v168
  v_mul_f32 v17, v165, v168
  v_mul_f32 v18, v166, v168
  v_mul_f32 v19, v167, v168
  v_pk_fma_f32 v[72:73], v[72:73], v[152:153], v[12:13] neg_lo:[1,0,1] neg_hi:[1,0,1]
  v_pk_fma_f32 v[74:75], v[74:75], v[154:155], v[14:15] neg_lo:[1,0,1] neg_hi:[1,0,1]
  v_pk_fma_f32 v[76:77], v[76:77], v[156:157], v[16:17] neg_lo:[1,0,1] neg_hi:[1,0,1]
  v_pk_fma_f32 v[78:79], v[78:79], v[158:159], v[18:19] neg_lo:[1,0,1] neg_hi:[1,0,1]
  v_cvt_pk_bf16_f32 v72, v72, v76
  v_cvt_pk_bf16_f32 v73, v73, v77
  v_cvt_pk_bf16_f32 v74, v74, v78
  v_cvt_pk_bf16_f32 v75, v75, v79
  buffer_store_dwordx4 v[72:75], v9, s[20:23], s46 offen sc1
  v_mul_f32 v12, v160, v169
  v_mul_f32 v13, v161, v169
  v_mul_f32 v14, v162, v169
  v_mul_f32 v15, v163, v169
  v_mul_f32 v16, v164, v169
  v_mul_f32 v17, v165, v169
  v_mul_f32 v18, v166, v169
  v_mul_f32 v19, v167, v169
  v_pk_fma_f32 v[80:81], v[80:81], v[152:153], v[12:13] neg_lo:[1,0,1] neg_hi:[1,0,1]
  v_pk_fma_f32 v[82:83], v[82:83], v[154:155], v[14:15] neg_lo:[1,0,1] neg_hi:[1,0,1]
  v_pk_fma_f32 v[84:85], v[84:85], v[156:157], v[16:17] neg_lo:[1,0,1] neg_hi:[1,0,1]
  v_pk_fma_f32 v[86:87], v[86:87], v[158:159], v[18:19] neg_lo:[1,0,1] neg_hi:[1,0,1]
  v_cvt_pk_bf16_f32 v80, v80, v84
  v_cvt_pk_bf16_f32 v81, v81, v85
  v_cvt_pk_bf16_f32 v82, v82, v86
  v_cvt_pk_bf16_f32 v83, v83, v87
  buffer_store_dwordx4 v[80:83], v9, s[20:23], s47 offen sc1
  v_mul_f32 v12, v160, v170
  v_mul_f32 v13, v161, v170
  v_mul_f32 v14, v162, v170
  v_mul_f32 v15, v163, v170
  v_mul_f32 v16, v164, v170
  v_mul_f32 v17, v165, v170
  v_mul_f32 v18, v166, v170
  v_mul_f32 v19, v167, v170
  v_pk_fma_f32 v[88:89], v[88:89], v[152:153], v[12:13] neg_lo:[1,0,1] neg_hi:[1,0,1]
  v_pk_fma_f32 v[90:91], v[90:91], v[154:155], v[14:15] neg_lo:[1,0,1] neg_hi:[1,0,1]
  v_pk_fma_f32 v[92:93], v[92:93], v[156:157], v[16:17] neg_lo:[1,0,1] neg_hi:[1,0,1]
  v_pk_fma_f32 v[94:95], v[94:95], v[158:159], v[18:19] neg_lo:[1,0,1] neg_hi:[1,0,1]
  v_cvt_pk_bf16_f32 v88, v88, v92
  v_cvt_pk_bf16_f32 v89, v89, v93
  v_cvt_pk_bf16_f32 v90, v90, v94
  v_cvt_pk_bf16_f32 v91, v91, v95
  buffer_store_dwordx4 v[88:91], v9, s[20:23], s48 offen sc1
  v_mul_f32 v12, v160, v171
  v_mul_f32 v13, v161, v171
  v_mul_f32 v14, v162, v171
  v_mul_f32 v15, v163, v171
  v_mul_f32 v16, v164, v171
  v_mul_f32 v17, v165, v171
  v_mul_f32 v18, v166, v171
  v_mul_f32 v19, v167, v171
  v_pk_fma_f32 v[96:97], v[96:97], v[152:153], v[12:13] neg_lo:[1,0,1] neg_hi:[1,0,1]
  v_pk_fma_f32 v[98:99], v[98:99], v[154:155], v[14:15] neg_lo:[1,0,1] neg_hi:[1,0,1]
  v_pk_fma_f32 v[100:101], v[100:101], v[156:157], v[16:17] neg_lo:[1,0,1] neg_hi:[1,0,1]
  v_pk_fma_f32 v[102:103], v[102:103], v[158:159], v[18:19] neg_lo:[1,0,1] neg_hi:[1,0,1]
  v_cvt_pk_bf16_f32 v96, v96, v100
  v_cvt_pk_bf16_f32 v97, v97, v101
  v_cvt_pk_bf16_f32 v98, v98, v102
  v_cvt_pk_bf16_f32 v99, v99, v103
  buffer_store_dwordx4 v[96:99], v9, s[20:23], s49 offen sc1
  v_and_b32 v4, 15, v1
  v_lshrrev_b32 v5, 4, v1
  v_and_b32 v6, 1, v5
  v_lshrrev_b32 v7, 1, v5
  v_lshl_add_u32 v6, v6, 1, v7
  v_lshlrev_b32 v6, 4, v6
  v_lshl_add_u32 v37, v4, 10, v6
  s_lshl_b32 s57, s9, 16
  s_lshl_b32 s44, s3, 14
  s_add_u32 s57, s57, s44
  s_lshl_b32 s44, s10, 7
  s_add_u32 s57, s57, s44
  buffer_load_dwordx4 v[12:15], v37, s[28:31], s57 offen offset:0
  buffer_load_dwordx4 v[16:19], v37, s[28:31], s57 offen offset:64
  v_mov_b32 v40, 0
  v_mov_b32 v41, 0
  v_mov_b32 v42, 0
  v_mov_b32 v43, 0
  v_mov_b32 v44, 0
  v_mov_b32 v45, 0
  v_mov_b32 v46, 0
  v_mov_b32 v47, 0
  v_mov_b32 v48, 0
  v_mov_b32 v49, 0
  v_mov_b32 v50, 0
  v_mov_b32 v51, 0
  v_mov_b32 v52, 0
  v_mov_b32 v53, 0
  v_mov_b32 v54, 0
  v_mov_b32 v55, 0
  s_lshl_b32 s56, s9, 18
  s_lshl_b32 s44, s3, 16
  s_add_u32 s56, s56, s44
  s_add_u32 s56, s56, 0x400000
  s_lshl_b32 s46, s9, 16
  s_lshl_b32 s44, s3, 14
  s_add_u32 s46, s46, s44
  s_lshl_b32 s44, s10, 11
  s_add_u32 s46, s46, s44
  s_add_u32 s46, s46, 0xc00000
  s_lshl_b32 s47, s9, 12
  s_lshl_b32 s44, s3, 10
  s_add_u32 s47, s47, s44
  s_lshl_b32 s44, s10, 3
  s_add_u32 s47, s47, s44
  s_add_u32 s47, s47, 0x10000
  s_and_b32 s45, s9, 1
  s_lshl_b32 s50, s11, 9
  s_lshl_b32 s44, s10, 6
  s_add_u32 s50, s50, s44
  s_lshl_b32 s44, s45, 5
  s_add_u32 s50, s50, s44
  s_lshl_b32 s44, s3, 3
  s_add_u32 s50, s50, s44
  s_add_u32 s50, s50, 0x56000
  v_lshlrev_b32 v7, 2, v7
  v_lshl_add_u32 v7, v4, 6, v7
  v_mov_b32 v8, 0x3f803f80
  s_add_u32 s44, s10, 0
  s_and_b32 s44, s44, 3
  s_lshl_b32 s44, s44, 13
  s_add_u32 s58, s56, s44
  s_add_u32 s44, s10, 1
  s_and_b32 s44, s44, 3
  s_lshl_b32 s44, s44, 13
  s_add_u32 s59, s56, s44
  s_add_u32 s44, s10, 2
  s_and_b32 s44, s44, 3
  s_lshl_b32 s44, s44, 13
  s_add_u32 s60, s56, s44
  s_add_u32 s44, s10, 3
  s_and_b32 s44, s44, 3
  s_lshl_b32 s44, s44, 13
  s_add_u32 s61, s56, s44
SP_54:
  ds_read_b32 v10, v34 offset:0
  s_sub_u32 s13, s13, 1
  s_cbranch_scc1 ABORT
  s_waitcnt lgkmcnt(0)
  v_cmp_gt_u32 vcc, 18, v10
  s_cbranch_vccnz SP_54
  buffer_load_dwordx4 v[120:123], v32, s[20:23], s58 offen offset:0 sc1
  buffer_load_dwordx4 v[124:127], v32, s[20:23], s58 offen offset:1024 sc1
  buffer_load_dwordx4 v[128:131], v32, s[20:23], s58 offen offset:2048 sc1
  buffer_load_dwordx4 v[132:135], v32, s[20:23], s58 offen offset:3072 sc1
  s_add_u32 s45, s58, 4096
  buffer_load_dwordx4 v[136:139], v32, s[20:23], s45 offen offset:0 sc1
  buffer_load_dwordx4 v[140:143], v32, s[20:23], s45 offen offset:1024 sc1
  buffer_load_dwordx4 v[144:147], v32, s[20:23], s45 offen offset:2048 sc1
  buffer_load_dwordx4 v[148:151], v32, s[20:23], s45 offen offset:3072 sc1
  s_waitcnt vmcnt(10)
  s_cmp_lg_u32 s17, 1
  s_cbranch_scc1 MS_55
  v_mov_b32 v2, s14
  v_mov_b32 v3, s15
  s_mov_b64 exec, 1
  buffer_store_dwordx2 v[2:3], v33, s[24:27], s52 offen
  s_mov_b64 exec, -1
MJ_56:
SP_57:
  ds_read_b32 v10, v29 offset:0
  s_sub_u32 s13, s13, 1
  s_cbranch_scc1 ABORT
  s_waitcnt lgkmcnt(0)
  v_cmp_gt_u32 vcc, 19, v10
  s_cbranch_vccnz SP_57
  ds_read_b128 v[56:59], v22 offset:40960
  ds_read_b128 v[60:63], v22 offset:43008
  ds_read_b128 v[64:67], v22 offset:45056
  ds_read_b128 v[68:71], v22 offset:47104
  ds_read_b128 v[72:75], v23 offset:40960
  ds_read_b128 v[76:79], v23 offset:43008
  ds_read_b128 v[80:83], v23 offset:45056
  ds_read_b128 v[84:87], v23 offset:47104
  s_waitcnt vmcnt(8) lgkmcnt(6)
  v_mfma_f32_16x16x32_bf16 v[40:43], v[56:59], v[120:123], v[40:43]
  ds_read_b128 v[88:91], v22 offset:49152
  v_mfma_f32_16x16x32_bf16 v[44:47], v[60:63], v[120:123], v[44:47]
  ds_read_b128 v[92:95], v22 offset:51200
  s_waitcnt lgkmcnt(6)
  v_mfma_f32_16x16x32_bf16 v[48:51], v[64:67], v[120:123], v[48:51]
  ds_read_b128 v[96:99], v22 offset:53248
  v_mfma_f32_16x16x32_bf16 v[52:55], v[68:71], v[120:123], v[52:55]
  ds_read_b128 v[100:103], v22 offset:55296
  s_waitcnt vmcnt(7)
  v_mfma_f32_16x16x32_bf16 v[40:43], v[56:59], v[124:127], v[40:43]
  ds_read_b128 v[104:107], v23 offset:49152
  v_mfma_f32_16x16x32_bf16 v[44:47], v[60:63], v[124:127], v[44:47]
  ds_read_b128 v[108:111], v23 offset:51200
  v_mfma_f32_16x16x32_bf16 v[48:51], v[64:67], v[124:127], v[48:51]
  ds_read_b128 v[112:115], v23 offset:53248
  v_mfma_f32_16x16x32_bf16 v[52:55], v[68:71], v[124:127], v[52:55]
  ds_read_b128 v[116:119], v23 offset:55296
  s_waitcnt vmcnt(6) lgkmcnt(10)
  v_mfma_f32_16x16x32_bf16 v[40:43], v[72:75], v[128:131], v[40:43]
  ds_read_b32 v10, v29
  v_mfma_f32_16x16x32_bf16 v[44:47], v[76:79], v[128:131], v[44:47]
  ds_add_u32 v30, v31
  s_waitcnt lgkmcnt(10)
  v_mfma_f32_16x16x32_bf16 v[48:51], v[80:83], v[128:131], v[48:51]
  buffer_load_dwordx4 v[152:155], v32, s[20:23], s59 offen offset:0 sc1
  v_mfma_f32_16x16x32_bf16 v[52:55], v[84:87], v[128:131], v[52:55]
  buffer_load_dwordx4 v[156:159], v32, s[20:23], s59 offen offset:1024 sc1
  s_waitcnt vmcnt(7)
  v_mfma_f32_16x16x32_bf16 v[40:43], v[72:75], v[132:135], v[40:43]
  buffer_load_dwordx4 v[160:163], v32, s[20:23], s59 offen offset:2048 sc1
  v_mfma_f32_16x16x32_bf16 v[44:47], v[76:79], v[132:135], v[44:47]
  buffer_load_dwordx4 v[164:167], v32, s[20:23], s59 offen offset:3072 sc1
  v_mfma_f32_16x16x32_bf16 v[48:51], v[80:83], v[132:135], v[48:51]
  s_add_u32 s45, s59, 4096
  buffer_load_dwordx4 v[168:171], v32, s[20:23], s45 offen offset:0 sc1
  v_mfma_f32_16x16x32_bf16 v[52:55], v[84:87], v[132:135], v[52:55]
  s_waitcnt vmcnt(9) lgkmcnt(8)
  v_mfma_f32_16x16x32_bf16 v[40:43], v[88:91], v[136:139], v[40:43]
  s_waitcnt lgkmcnt(1)
  v_cmp_gt_u32 vcc, 20, v10
  s_cbranch_vccnz SLOW_58
JOIN_59:
  ds_read_b128 v[56:59], v22 offset:57344
  v_mfma_f32_16x16x32_bf16 v[44:47], v[92:95], v[136:139], v[44:47]
  ds_read_b128 v[60:63], v22 offset:59392
  v_mfma_f32_16x16x32_bf16 v[48:51], v[96:99], v[136:139], v[48:51]
  ds_read_b128 v[64:67], v22 offset:61440
  v_mfma_f32_16x16x32_bf16 v[52:55], v[100:103], v[136:139], v[52:55]
  ds_read_b128 v[68:71], v22 offset:63488
  s_waitcnt vmcnt(8)
  v_mfma_f32_16x16x32_bf16 v[40:43], v[88:91], v[140:143], v[40:43]
  ds_read_b128 v[72:75], v23 offset:57344
  v_mfma_f32_16x16x32_bf16 v[44:47], v[92:95], v[140:143], v[44:47]
  ds_read_b128 v[76:79], v23 offset:59392
  v_mfma_f32_16x16x32_bf16 v[48:51], v[96:99], v[140:143], v[48:51]
  ds_read_b128 v[80:83], v23 offset:61440
  v_mfma_f32_16x16x32_bf16 v[52:55], v[100:103], v[140:143], v[52:55]
  ds_read_b128 v[84:87], v23 offset:63488
  s_waitcnt vmcnt(7)
  v_mfma_f32_16x16x32_bf16 v[40:43], v[104:107], v[144:147], v[40:43]
  buffer_load_dwordx4 v[172:175], v32, s[20:23], s45 offen offset:1024 sc1
  v_mfma_f32_16x16x32_bf16 v[44:47], v[108:111], v[144:147], v[44:47]
  buffer_load_dwordx4 v[176:179], v32, s[20:23], s45 offen offset:2048 sc1
  v_mfma_f32_16x16x32_bf16 v[48:51], v[112:115], v[144:147], v[48:51]
  v_mfma_f32_16x16x32_bf16 v[52:55], v[116:119], v[144:147], v[52:55]
  buffer_load_dwordx4 v[180:183], v32, s[20:23], s45 offen offset:3072 sc1
  s_waitcnt vmcnt(9)
  v_mfma_f32_16x16x32_bf16 v[40:43], v[104:107], v[148:151], v[40:43]
  buffer_load_dwordx4 v[184:187], v32, s[20:23], s60 offen offset:0 sc1
  v_mfma_f32_16x16x32_bf16 v[44:47], v[108:111], v[148:151], v[44:47]
  v_mfma_f32_16x16x32_bf16 v[48:51], v[112:115], v[148:151], v[48:51]
  buffer_load_dwordx4 v[188:191], v32, s[20:23], s60 offen offset:1024 sc1
  v_mfma_f32_16x16x32_bf16 v[52:55], v[116:119], v[148:151], v[52:55]
  s_waitcnt vmcnt(9) lgkmcnt(6)
  v_mfma_f32_16x16x32_bf16 v[40:43], v[56:59], v[152:155], v[40:43]
  ds_read_b128 v[88:91], v24 offset:0
  v_mfma_f32_16x16x32_bf16 v[44:47], v[60:63], v[152:155], v[44:47]
  ds_read_b128 v[92:95], v24 offset:2048
  s_waitcnt lgkmcnt(6)
  v_mfma_f32_16x16x32_bf16 v[48:51], v[64:67], v[152:155], v[48:51]
  ds_read_b128 v[96:99], v24 offset:4096
  v_mfma_f32_16x16x32_bf16 v[52:55], v[68:71], v[152:155], v[52:55]
  ds_read_b128 v[100:103], v24 offset:6144
  s_waitcnt vmcnt(8)
  v_mfma_f32_16x16x32_bf16 v[40:43], v[56:59], v[156:159], v[40:43]
  ds_read_b128 v[104:107], v25 offset:0
  v_mfma_f32_16x16x32_bf16 v[44:47], v[60:63], v[156:159], v[44:47]
  ds_read_b128 v[108:111], v25 offset:2048
  v_mfma_f32_16x16x32_bf16 v[48:51], v[64:67], v[156:159], v[48:51]
  ds_read_b128 v[112:115], v25 offset:4096
  v_mfma_f32_16x16x32_bf16 v[52:55], v[68:71], v[156:159], v[52:55]
  ds_read_b128 v[116:119], v25 offset:6144
  s_waitcnt vmcnt(7) lgkmcnt(10)
  v_mfma_f32_16x16x32_bf16 v[40:43], v[72:75], v[160:163], v[40:43]
  ds_read_b32 v10, v29
  v_mfma_f32_16x16x32_bf16 v[44:47], v[76:79], v[160:163], v[44:47]
  ds_add_u32 v30, v31
  s_waitcnt lgkmcnt(10)
  v_mfma_f32_16x16x32_bf16 v[48:51], v[80:83], v[160:163], v[48:51]
  buffer_load_dwordx4 v[192:195], v32, s[20:23], s60 offen offset:2048 sc1
  v_mfma_f32_16x16x32_bf16 v[52:55], v[84:87], v[160:163], v[52:55]
  buffer_load_dwordx4 v[196:199], v32, s[20:23], s60 offen offset:3072 sc1
  s_waitcnt vmcnt(8)
  v_mfma_f32_16x16x32_bf16 v[40:43], v[72:75], v[164:167], v[40:43]
  s_add_u32 s45, s60, 4096
  buffer_load_dwordx4 v[200:203], v32, s[20:23], s45 offen offset:0 sc1
  v_mfma_f32_16x16x32_bf16 v[44:47], v[76:79], v[164:167], v[44:47]
  buffer_load_dwordx4 v[204:207], v32, s[20:23], s45 offen offset:1024 sc1
  v_mfma_f32_16x16x32_bf16 v[48:51], v[80:83], v[164:167], v[48:51]
  buffer_load_dwordx4 v[208:211], v32, s[20:23], s45 offen offset:2048 sc1
  v_mfma_f32_16x16x32_bf16 v[52:55], v[84:87], v[164:167], v[52:55]
  s_waitcnt vmcnt(10) lgkmcnt(8)
  v_mfma_f32_16x16x32_bf16 v[40:43], v[88:91], v[168:171], v[40:43]
  s_waitcnt lgkmcnt(1)
  v_cmp_gt_u32 vcc, 21, v10
  s_cbranch_vccnz SLOW_61
JOIN_62:
  ds_read_b128 v[56:59], v24 offset:8192
  v_mfma_f32_16x16x32_bf16 v[44:47], v[92:95], v[168:171], v[44:47]
  ds_read_b128 v[60:63], v24 offset:10240
  v_mfma_f32_16x16x32_bf16 v[48:51], v[96:99], v[168:171], v[48:51]
  ds_read_b128 v[64:67], v24 offset:12288
  v_mfma_f32_16x16x32_bf16 v[52:55], v[100:103], v[168:171], v[52:55]
  ds_read_b128 v[68:71], v24 offset:14336
  s_waitcnt vmcnt(9)
  v_mfma_f32_16x16x32_bf16 v[40:43], v[88:91], v[172:175], v[40:43]
  ds_read_b128 v[72:75], v25 offset:8192
  v_mfma_f32_16x16x32_bf16 v[44:47], v[92:95], v[172:175], v[44:47]
  ds_read_b128 v[76:79], v25 offset:10240
  v_mfma_f32_16x16x32_bf16 v[48:51], v[96:99], v[172:175], v[48:51]
  ds_read_b128 v[80:83], v25 offset:12288
  v_mfma_f32_16x16x32_bf16 v[52:55], v[100:103], v[172:175], v[52:55]
  ds_read_b128 v[84:87], v25 offset:14336
  s_waitcnt vmcnt(8)
  v_mfma_f32_16x16x32_bf16 v[40:43], v[104:107], v[176:179], v[40:43]
  buffer_load_dwordx4 v[212:215], v32, s[20:23], s45 offen offset:3072 sc1
  v_mfma_f32_16x16x32_bf16 v[44:47], v[108:111], v[176:179], v[44:47]
  buffer_load_dwordx4 v[216:219], v32, s[20:23], s61 offen offset:0 sc1
  v_mfma_f32_16x16x32_bf16 v[48:51], v[112:115], v[176:179], v[48:51]
  v_mfma_f32_16x16x32_bf16 v[52:55], v[116:119], v[176:179], v[52:55]
  buffer_load_dwordx4 v[220:223], v32, s[20:23], s61 offen offset:1024 sc1
  s_waitcnt vmcnt(10)
  v_mfma_f32_16x16x32_bf16 v[40:43], v[104:107], v[180:183], v[40:43]
  buffer_load_dwordx4 v[224:227], v32, s[20:23], s61 offen offset:2048 sc1
  v_mfma_f32_16x16x32_bf16 v[44:47], v[108:111], v[180:183], v[44:47]
  v_mfma_f32_16x16x32_bf16 v[48:51], v[112:115], v[180:183], v[48:51]
  buffer_load_dwordx4 v[228:231], v32, s[20:23], s61 offen offset:3072 sc1
  v_mfma_f32_16x16x32_bf16 v[52:55], v[116:119], v[180:183], v[52:55]
  s_waitcnt vmcnt(11) lgkmcnt(6)
  v_mfma_f32_16x16x32_bf16 v[40:43], v[56:59], v[184:187], v[40:43]
  ds_read_b128 v[88:91], v24 offset:16384
  v_mfma_f32_16x16x32_bf16 v[44:47], v[60:63], v[184:187], v[44:47]
  ds_read_b128 v[92:95], v24 offset:18432
  s_waitcnt lgkmcnt(6)
  v_mfma_f32_16x16x32_bf16 v[48:51], v[64:67], v[184:187], v[48:51]
  ds_read_b128 v[96:99], v24 offset:20480
  v_mfma_f32_16x16x32_bf16 v[52:55], v[68:71], v[184:187], v[52:55]
  ds_read_b128 v[100:103], v24 offset:22528
  s_waitcnt vmcnt(10)
  v_mfma_f32_16x16x32_bf16 v[40:43], v[56:59], v[188:191], v[40:43]
  ds_read_b128 v[104:107], v25 offset:16384
  v_mfma_f32_16x16x32_bf16 v[44:47], v[60:63], v[188:191], v[44:47]
  ds_read_b128 v[108:111], v25 offset:18432
  v_mfma_f32_16x16x32_bf16 v[48:51], v[64:67], v[188:191], v[48:51]
  ds_read_b128 v[112:115], v25 offset:20480
  v_mfma_f32_16x16x32_bf16 v[52:55], v[68:71], v[188:191], v[52:55]
  ds_read_b128 v[116:119], v25 offset:22528
  s_waitcnt vmcnt(9) lgkmcnt(10)
  v_mfma_f32_16x16x32_bf16 v[40:43], v[72:75], v[192:195], v[40:43]
  ds_read_b32 v10, v29
  v_mfma_f32_16x16x32_bf16 v[44:47], v[76:79], v[192:195], v[44:47]
  ds_add_u32 v30, v31
  s_waitcnt lgkmcnt(10)
  v_mfma_f32_16x16x32_bf16 v[48:51], v[80:83], v[192:195], v[48:51]
  s_add_u32 s45, s61, 4096
  buffer_load_dwordx4 v[232:235], v32, s[20:23], s45 offen offset:0 sc1
  v_mfma_f32_16x16x32_bf16 v[52:55], v[84:87], v[192:195], v[52:55]
  buffer_load_dwordx4 v[236:239], v32, s[20:23], s45 offen offset:1024 sc1
  s_waitcnt vmcnt(10)
  v_mfma_f32_16x16x32_bf16 v[40:43], v[72:75], v[196:199], v[40:43]
  buffer_load_dwordx4 v[240:243], v32, s[20:23], s45 offen offset:2048 sc1
  v_mfma_f32_16x16x32_bf16 v[44:47], v[76:79], v[196:199], v[44:47]
  buffer_load_dwordx4 v[244:247], v32, s[20:23], s45 offen offset:3072 sc1
  v_mfma_f32_16x16x32_bf16 v[48:51], v[80:83], v[196:199], v[48:51]
  s_add_u32 s45, s58, 32768
  buffer_load_dwordx4 v[120:123], v32, s[20:23], s45 offen offset:0 sc1
  v_mfma_f32_16x16x32_bf16 v[52:55], v[84:87], v[196:199], v[52:55]
  s_waitcnt vmcnt(12) lgkmcnt(8)
  v_mfma_f32_16x16x32_bf16 v[40:43], v[88:91], v[200:203], v[40:43]
  s_waitcnt lgkmcnt(1)
  v_cmp_gt_u32 vcc, 22, v10
  s_cbranch_vccnz SLOW_64
JOIN_65:
  ds_read_b128 v[56:59], v20 offset:0
  v_mfma_f32_16x16x32_bf16 v[44:47], v[92:95], v[200:203], v[44:47]
  ds_read_b128 v[60:63], v20 offset:2048
  v_mfma_f32_16x16x32_bf16 v[48:51], v[96:99], v[200:203], v[48:51]
  ds_read_b128 v[64:67], v20 offset:4096
  v_mfma_f32_16x16x32_bf16 v[52:55], v[100:103], v[200:203], v[52:55]
  ds_read_b128 v[68:71], v20 offset:6144
  s_waitcnt vmcnt(11)
  v_mfma_f32_16x16x32_bf16 v[40:43], v[88:91], v[204:207], v[40:43]
  ds_read_b128 v[72:75], v21 offset:0
  v_mfma_f32_16x16x32_bf16 v[44:47], v[92:95], v[204:207], v[44:47]
  ds_read_b128 v[76:79], v21 offset:2048
  v_mfma_f32_16x16x32_bf16 v[48:51], v[96:99], v[204:207], v[48:51]
  ds_read_b128 v[80:83], v21 offset:4096
  v_mfma_f32_16x16x32_bf16 v[52:55], v[100:103], v[204:207], v[52:55]
  ds_read_b128 v[84:87], v21 offset:6144
  s_waitcnt vmcnt(10)
  v_mfma_f32_16x16x32_bf16 v[40:43], v[104:107], v[208:211], v[40:43]
  buffer_load_dwordx4 v[124:127], v32, s[20:23], s45 offen offset:1024 sc1
  v_mfma_f32_16x16x32_bf16 v[44:47], v[108:111], v[208:211], v[44:47]
  buffer_load_dwordx4 v[128:131], v32, s[20:23], s45 offen offset:2048 sc1
  v_mfma_f32_16x16x32_bf16 v[48:51], v[112:115], v[208:211], v[48:51]
  v_mfma_f32_16x16x32_bf16 v[52:55], v[116:119], v[208:211], v[52:55]
  buffer_load_dwordx4 v[132:135], v32, s[20:23], s45 offen offset:3072 sc1
  s_waitcnt vmcnt(12)
  v_mfma_f32_16x16x32_bf16 v[40:43], v[104:107], v[212:215], v[40:43]
  s_add_u32 s45, s58, 36864
  buffer_load_dwordx4 v[136:139], v32, s[20:23], s45 offen offset:0 sc1
  v_mfma_f32_16x16x32_bf16 v[44:47], v[108:111], v[212:215], v[44:47]
  v_mfma_f32_16x16x32_bf16 v[48:51], v[112:115], v[212:215], v[48:51]
  buffer_load_dwordx4 v[140:143], v32, s[20:23], s45 offen offset:1024 sc1
  v_mfma_f32_16x16x32_bf16 v[52:55], v[116:119], v[212:215], v[52:55]
  s_waitcnt vmcnt(13) lgkmcnt(6)
  v_mfma_f32_16x16x32_bf16 v[40:43], v[56:59], v[216:219], v[40:43]
  ds_read_b128 v[88:91], v20 offset:8192
  v_mfma_f32_16x16x32_bf16 v[44:47], v[60:63], v[216:219], v[44:47]
  ds_read_b128 v[92:95], v20 offset:10240
  s_waitcnt lgkmcnt(6)
  v_mfma_f32_16x16x32_bf16 v[48:51], v[64:67], v[216:219], v[48:51]
  ds_read_b128 v[96:99], v20 offset:12288
  v_mfma_f32_16x16x32_bf16 v[52:55], v[68:71], v[216:219], v[52:55]
  ds_read_b128 v[100:103], v20 offset:14336
  s_waitcnt vmcnt(12)
  v_mfma_f32_16x16x32_bf16 v[40:43], v[56:59], v[220:223], v[40:43]
  ds_read_b128 v[104:107], v21 offset:8192
  v_mfma_f32_16x16x32_bf16 v[44:47], v[60:63], v[220:223], v[44:47]
  ds_read_b128 v[108:111], v21 offset:10240
  v_mfma_f32_16x16x32_bf16 v[48:51], v[64:67], v[220:223], v[48:51]
  ds_read_b128 v[112:115], v21 offset:12288
  v_mfma_f32_16x16x32_bf16 v[52:55], v[68:71], v[220:223], v[52:55]
  ds_read_b128 v[116:119], v21 offset:14336
  s_waitcnt vmcnt(11) lgkmcnt(10)
  v_mfma_f32_16x16x32_bf16 v[40:43], v[72:75], v[224:227], v[40:43]
  ds_read_b32 v10, v29
  v_mfma_f32_16x16x32_bf16 v[44:47], v[76:79], v[224:227], v[44:47]
  ds_add_u32 v30, v31
  s_waitcnt lgkmcnt(10)
  v_mfma_f32_16x16x32_bf16 v[48:51], v[80:83], v[224:227], v[48:51]
  buffer_load_dwordx4 v[144:147], v32, s[20:23], s45 offen offset:2048 sc1
  v_mfma_f32_16x16x32_bf16 v[52:55], v[84:87], v[224:227], v[52:55]
  buffer_load_dwordx4 v[148:151], v32, s[20:23], s45 offen offset:3072 sc1
  s_waitcnt vmcnt(12)
  v_mfma_f32_16x16x32_bf16 v[40:43], v[72:75], v[228:231], v[40:43]
  s_add_u32 s45, s59, 32768
  buffer_load_dwordx4 v[152:155], v32, s[20:23], s45 offen offset:0 sc1
  v_mfma_f32_16x16x32_bf16 v[44:47], v[76:79], v[228:231], v[44:47]
  buffer_load_dwordx4 v[156:159], v32, s[20:23], s45 offen offset:1024 sc1
  v_mfma_f32_16x16x32_bf16 v[48:51], v[80:83], v[228:231], v[48:51]
  buffer_load_dwordx4 v[160:163], v32, s[20:23], s45 offen offset:2048 sc1
  v_mfma_f32_16x16x32_bf16 v[52:55], v[84:87], v[228:231], v[52:55]
  s_waitcnt vmcnt(14) lgkmcnt(8)
  v_mfma_f32_16x16x32_bf16 v[40:43], v[88:91], v[232:235], v[40:43]
  s_waitcnt lgkmcnt(1)
  v_cmp_gt_u32 vcc, 23, v10
  s_cbranch_vccnz SLOW_67
JOIN_68:
  ds_read_b128 v[56:59], v20 offset:16384
  v_mfma_f32_16x16x32_bf16 v[44:47], v[92:95], v[232:235], v[44:47]
  ds_read_b128 v[60:63], v20 offset:18432
  v_mfma_f32_16x16x32_bf16 v[48:51], v[96:99], v[232:235], v[48:51]
  ds_read_b128 v[64:67], v20 offset:20480
  v_mfma_f32_16x16x32_bf16 v[52:55], v[100:103], v[232:235], v[52:55]
  ds_read_b128 v[68:71], v20 offset:22528
  s_waitcnt vmcnt(13)
  v_mfma_f32_16x16x32_bf16 v[40:43], v[88:91], v[236:239], v[40:43]
  ds_read_b128 v[72:75], v21 offset:16384
  v_mfma_f32_16x16x32_bf16 v[44:47], v[92:95], v[236:239], v[44:47]
  ds_read_b128 v[76:79], v21 offset:18432
  v_mfma_f32_16x16x32_bf16 v[48:51], v[96:99], v[236:239], v[48:51]
  ds_read_b128 v[80:83], v21 offset:20480
  v_mfma_f32_16x16x32_bf16 v[52:55], v[100:103], v[236:239], v[52:55]
  ds_read_b128 v[84:87], v21 offset:22528
  s_waitcnt vmcnt(12)
  v_mfma_f32_16x16x32_bf16 v[40:43], v[104:107], v[240:243], v[40:43]
  buffer_load_dwordx4 v[164:167], v32, s[20:23], s45 offen offset:3072 sc1
  v_mfma_f32_16x16x32_bf16 v[44:47], v[108:111], v[240:243], v[44:47]
  s_add_u32 s45, s59, 36864
  buffer_load_dwordx4 v[168:171], v32, s[20:23], s45 offen offset:0 sc1
  v_mfma_f32_16x16x32_bf16 v[48:51], v[112:115], v[240:243], v[48:51]
  v_mfma_f32_16x16x32_bf16 v[52:55], v[116:119], v[240:243], v[52:55]
  buffer_load_dwordx4 v[172:175], v32, s[20:23], s45 offen offset:1024 sc1
  s_waitcnt vmcnt(14)
  v_mfma_f32_16x16x32_bf16 v[40:43], v[104:107], v[244:247], v[40:43]
  buffer_load_dwordx4 v[176:179], v32, s[20:23], s45 offen offset:2048 sc1
  v_mfma_f32_16x16x32_bf16 v[44:47], v[108:111], v[244:247], v[44:47]
  v_mfma_f32_16x16x32_bf16 v[48:51], v[112:115], v[244:247], v[48:51]
  buffer_load_dwordx4 v[180:183], v32, s[20:23], s45 offen offset:3072 sc1
  v_mfma_f32_16x16x32_bf16 v[52:55], v[116:119], v[244:247], v[52:55]
  s_waitcnt vmcnt(15) lgkmcnt(6)
  v_mfma_f32_16x16x32_bf16 v[40:43], v[56:59], v[120:123], v[40:43]
  ds_read_b128 v[88:91], v20 offset:24576
  v_mfma_f32_16x16x32_bf16 v[44:47], v[60:63], v[120:123], v[44:47]
  ds_read_b128 v[92:95], v20 offset:26624
  s_waitcnt lgkmcnt(6)
  v_mfma_f32_16x16x32_bf16 v[48:51], v[64:67], v[120:123], v[48:51]
  ds_read_b128 v[96:99], v20 offset:28672
  v_mfma_f32_16x16x32_bf16 v[52:55], v[68:71], v[120:123], v[52:55]
  ds_read_b128 v[100:103], v20 offset:30720
  s_waitcnt vmcnt(14)
  v_mfma_f32_16x16x32_bf16 v[40:43], v[56:59], v[124:127], v[40:43]
  ds_read_b128 v[104:107], v21 offset:24576
  v_mfma_f32_16x16x32_bf16 v[44:47], v[60:63], v[124:127], v[44:47]
  ds_read_b128 v[108:111], v21 offset:26624
  v_mfma_f32_16x16x32_bf16 v[48:51], v[64:67], v[124:127], v[48:51]
  ds_read_b128 v[112:115], v21 offset:28672
  v_mfma_f32_16x16x32_bf16 v[52:55], v[68:71], v[124:127], v[52:55]
  ds_read_b128 v[116:119], v21 offset:30720
  s_waitcnt vmcnt(13) lgkmcnt(10)
  v_mfma_f32_16x16x32_bf16 v[40:43], v[72:75], v[128:131], v[40:43]
  ds_read_b32 v10, v29
  v_mfma_f32_16x16x32_bf16 v[44:47], v[76:79], v[128:131], v[44:47]
  ds_add_u32 v30, v31
  s_waitcnt lgkmcnt(10)
  v_mfma_f32_16x16x32_bf16 v[48:51], v[80:83], v[128:131], v[48:51]
  s_add_u32 s45, s60, 32768
  buffer_load_dwordx4 v[184:187], v32, s[20:23], s45 offen offset:0 sc1
  v_mfma_f32_16x16x32_bf16 v[52:55], v[84:87], v[128:131], v[52:55]
  buffer_load_dwordx4 v[188:191], v32, s[20:23], s45 offen offset:1024 sc1
  s_waitcnt vmcnt(14)
  v_mfma_f32_16x16x32_bf16 v[40:43], v[72:75], v[132:135], v[40:43]
  buffer_load_dwordx4 v[192:195], v32, s[20:23], s45 offen offset:2048 sc1
  v_mfma_f32_16x16x32_bf16 v[44:47], v[76:79], v[132:135], v[44:47]
  buffer_load_dwordx4 v[196:199], v32, s[20:23], s45 offen offset:3072 sc1
  v_mfma_f32_16x16x32_bf16 v[48:51], v[80:83], v[132:135], v[48:51]
  s_add_u32 s45, s60, 36864
  buffer_load_dwordx4 v[200:203], v32, s[20:23], s45 offen offset:0 sc1
  v_mfma_f32_16x16x32_bf16 v[52:55], v[84:87], v[132:135], v[52:55]
  s_waitcnt vmcnt(16) lgkmcnt(8)
  v_mfma_f32_16x16x32_bf16 v[40:43], v[88:91], v[136:139], v[40:43]
  s_waitcnt lgkmcnt(1)
  v_cmp_gt_u32 vcc, 24, v10
  s_cbranch_vccnz SLOW_70
JOIN_71:
  ds_read_b128 v[56:59], v20 offset:32768
  v_mfma_f32_16x16x32_bf16 v[44:47], v[92:95], v[136:139], v[44:47]
  ds_read_b128 v[60:63], v20 offset:34816
  v_mfma_f32_16x16x32_bf16 v[48:51], v[96:99], v[136:139], v[48:51]
  ds_read_b128 v[64:67], v20 offset:36864
  v_mfma_f32_16x16x32_bf16 v[52:55], v[100:103], v[136:139], v[52:55]
  ds_read_b128 v[68:71], v20 offset:38912
  s_waitcnt vmcnt(15)
  v_mfma_f32_16x16x32_bf16 v[40:43], v[88:91], v[140:143], v[40:43]
  ds_read_b128 v[72:75], v21 offset:32768
  v_mfma_f32_16x16x32_bf16 v[44:47], v[92:95], v[140:143], v[44:47]
  ds_read_b128 v[76:79], v21 offset:34816
  v_mfma_f32_16x16x32_bf16 v[48:51], v[96:99], v[140:143], v[48:51]
  ds_read_b128 v[80:83], v21 offset:36864
  v_mfma_f32_16x16x32_bf16 v[52:55], v[100:103], v[140:143], v[52:55]
  ds_read_b128 v[84:87], v21 offset:38912
  s_waitcnt vmcnt(14)
  v_mfma_f32_16x16x32_bf16 v[40:43], v[104:107], v[144:147], v[40:43]
  buffer_load_dwordx4 v[204:207], v32, s[20:23], s45 offen offset:1024 sc1
  v_mfma_f32_16x16x32_bf16 v[44:47], v[108:111], v[144:147], v[44:47]
  buffer_load_dwordx4 v[208:211], v32, s[20:23], s45 offen offset:2048 sc1
  v_mfma_f32_16x16x32_bf16 v[48:51], v[112:115], v[144:147], v[48:51]
  v_mfma_f32_16x16x32_bf16 v[52:55], v[116:119], v[144:147], v[52:55]
  buffer_load_dwordx4 v[212:215], v32, s[20:23], s45 offen offset:3072 sc1
  s_waitcnt vmcnt(16)
  v_mfma_f32_16x16x32_bf16 v[40:43], v[104:107], v[148:151], v[40:43]
  s_add_u32 s45, s61, 32768
  buffer_load_dwordx4 v[216:219], v32, s[20:23], s45 offen offset:0 sc1
  v_mfma_f32_16x16x32_bf16 v[44:47], v[108:111], v[148:151], v[44:47]
  v_mfma_f32_16x16x32_bf16 v[48:51], v[112:115], v[148:151], v[48:51]
  buffer_load_dwordx4 v[220:223], v32, s[20:23], s45 offen offset:1024 sc1
  v_mfma_f32_16x16x32_bf16 v[52:55], v[116:119], v[148:151], v[52:55]
  s_waitcnt vmcnt(17) lgkmcnt(6)
  v_mfma_f32_16x16x32_bf16 v[40:43], v[56:59], v[152:155], v[40:43]
  ds_read_b128 v[88:91], v20 offset:40960
  v_mfma_f32_16x16x32_bf16 v[44:47], v[60:63], v[152:155], v[44:47]
  ds_read_b128 v[92:95], v20 offset:43008
  s_waitcnt lgkmcnt(6)
  v_mfma_f32_16x16x32_bf16 v[48:51], v[64:67], v[152:155], v[48:51]
  ds_read_b128 v[96:99], v20 offset:45056
  v_mfma_f32_16x16x32_bf16 v[52:55], v[68:71], v[152:155], v[52:55]
  ds_read_b128 v[100:103], v20 offset:47104
  s_waitcnt vmcnt(16)
  v_mfma_f32_16x16x32_bf16 v[40:43], v[56:59], v[156:159], v[40:43]
  ds_read_b128 v[104:107], v21 offset:40960
  v_mfma_f32_16x16x32_bf16 v[44:47], v[60:63], v[156:159], v[44:47]
  ds_read_b128 v[108:111], v21 offset:43008
  v_mfma_f32_16x16x32_bf16 v[48:51], v[64:67], v[156:159], v[48:51]
  ds_read_b128 v[112:115], v21 offset:45056
  v_mfma_f32_16x16x32_bf16 v[52:55], v[68:71], v[156:159], v[52:55]
  ds_read_b128 v[116:119], v21 offset:47104
  s_waitcnt vmcnt(15) lgkmcnt(10)
  v_mfma_f32_16x16x32_bf16 v[40:43], v[72:75], v[160:163], v[40:43]
  ds_read_b32 v10, v29
  v_mfma_f32_16x16x32_bf16 v[44:47], v[76:79], v[160:163], v[44:47]
  ds_add_u32 v30, v31
  s_waitcnt lgkmcnt(10)
  v_mfma_f32_16x16x32_bf16 v[48:51], v[80:83], v[160:163], v[48:51]
  buffer_load_dwordx4 v[224:227], v32, s[20:23], s45 offen offset:2048 sc1
  v_mfma_f32_16x16x32_bf16 v[52:55], v[84:87], v[160:163], v[52:55]
  buffer_load_dwordx4 v[228:231], v32, s[20:23], s45 offen offset:3072 sc1
  s_waitcnt vmcnt(16)
  v_mfma_f32_16x16x32_bf16 v[40:43], v[72:75], v[164:167], v[40:43]
  s_add_u32 s45, s61, 36864
  buffer_load_dwordx4 v[232:235], v32, s[20:23], s45 offen offset:0 sc1
  v_mfma_f32_16x16x32_bf16 v[44:47], v[76:79], v[164:167], v[44:47]
  buffer_load_dwordx4 v[236:239], v32, s[20:23], s45 offen offset:1024 sc1
  v_mfma_f32_16x16x32_bf16 v[48:51], v[80:83], v[164:167], v[48:51]
  buffer_load_dwordx4 v[240:243], v32, s[20:23], s45 offen offset:2048 sc1
  v_mfma_f32_16x16x32_bf16 v[52:55], v[84:87], v[164:167], v[52:55]
  s_waitcnt vmcnt(18) lgkmcnt(8)
  v_mfma_f32_16x16x32_bf16 v[40:43], v[88:91], v[168:171], v[40:43]
  s_waitcnt lgkmcnt(1)
  v_cmp_gt_u32 vcc, 25, v10
  s_cbranch_vccnz SLOW_73
JOIN_74:
  ds_read_b128 v[56:59], v20 offset:49152
  v_mfma_f32_16x16x32_bf16 v[44:47], v[92:95], v[168:171], v[44:47]
  ds_read_b128 v[60:63], v20 offset:51200
  v_mfma_f32_16x16x32_bf16 v[48:51], v[96:99], v[168:171], v[48:51]
  ds_read_b128 v[64:67], v20 offset:53248
  v_mfma_f32_16x16x32_bf16 v[52:55], v[100:103], v[168:171], v[52:55]
  ds_read_b128 v[68:71], v20 offset:55296
  s_waitcnt vmcnt(17)
  v_mfma_f32_16x16x32_bf16 v[40:43], v[88:91], v[172:175], v[40:43]
  ds_read_b128 v[72:75], v21 offset:49152
  v_mfma_f32_16x16x32_bf16 v[44:47], v[92:95], v[172:175], v[44:47]
  ds_read_b128 v[76:79], v21 offset:51200
  v_mfma_f32_16x16x32_bf16 v[48:51], v[96:99], v[172:175], v[48:51]
  ds_read_b128 v[80:83], v21 offset:53248
  v_mfma_f32_16x16x32_bf16 v[52:55], v[100:103], v[172:175], v[52:55]
  ds_read_b128 v[84:87], v21 offset:55296
  s_waitcnt vmcnt(16)
  v_mfma_f32_16x16x32_bf16 v[40:43], v[104:107], v[176:179], v[40:43]
  buffer_load_dwordx4 v[244:247], v32, s[20:23], s45 offen offset:3072 sc1
  v_mfma_f32_16x16x32_bf16 v[44:47], v[108:111], v[176:179], v[44:47]
  v_mfma_f32_16x16x32_bf16 v[48:51], v[112:115], v[176:179], v[48:51]
  v_mfma_f32_16x16x32_bf16 v[52:55], v[116:119], v[176:179], v[52:55]
  s_waitcnt vmcnt(16)
  v_mfma_f32_16x16x32_bf16 v[40:43], v[104:107], v[180:183], v[40:43]
  v_mfma_f32_16x16x32_bf16 v[44:47], v[108:111], v[180:183], v[44:47]
  v_mfma_f32_16x16x32_bf16 v[48:51], v[112:115], v[180:183], v[48:51]
  v_mfma_f32_16x16x32_bf16 v[52:55], v[116:119], v[180:183], v[52:55]
  s_waitcnt vmcnt(15) lgkmcnt(6)
  v_mfma_f32_16x16x32_bf16 v[40:43], v[56:59], v[184:187], v[40:43]
  ds_read_b128 v[88:91], v20 offset:57344
  v_mfma_f32_16x16x32_bf16 v[44:47], v[60:63], v[184:187], v[44:47]
  ds_read_b128 v[92:95], v20 offset:59392
  s_waitcnt lgkmcnt(6)
  v_mfma_f32_16x16x32_bf16 v[48:51], v[64:67], v[184:187], v[48:51]
  ds_read_b128 v[96:99], v20 offset:61440
  v_mfma_f32_16x16x32_bf16 v[52:55], v[68:71], v[184:187], v[52:55]
  ds_read_b128 v[100:103], v20 offset:63488
  s_waitcnt vmcnt(14)
  v_mfma_f32_16x16x32_bf16 v[40:43], v[56:59], v[188:191], v[40:43]
  ds_read_b128 v[104:107], v21 offset:57344
  v_mfma_f32_16x16x32_bf16 v[44:47], v[60:63], v[188:191], v[44:47]
  ds_read_b128 v[108:111], v21 offset:59392
  v_mfma_f32_16x16x32_bf16 v[48:51], v[64:67], v[188:191], v[48:51]
  ds_read_b128 v[112:115], v21 offset:61440
  v_mfma_f32_16x16x32_bf16 v[52:55], v[68:71], v[188:191], v[52:55]
  ds_read_b128 v[116:119], v21 offset:63488
  s_waitcnt vmcnt(13) lgkmcnt(10)
  v_mfma_f32_16x16x32_bf16 v[40:43], v[72:75], v[192:195], v[40:43]
  ds_read_b32 v10, v29
  v_mfma_f32_16x16x32_bf16 v[44:47], v[76:79], v[192:195], v[44:47]
  s_waitcnt lgkmcnt(9)
  v_mfma_f32_16x16x32_bf16 v[48:51], v[80:83], v[192:195], v[48:51]
  ds_add_u32 v30, v31
  v_mfma_f32_16x16x32_bf16 v[52:55], v[84:87], v[192:195], v[52:55]
  s_waitcnt vmcnt(12)
  v_mfma_f32_16x16x32_bf16 v[40:43], v[72:75], v[196:199], v[40:43]
  v_mfma_f32_16x16x32_bf16 v[44:47], v[76:79], v[196:199], v[44:47]
  v_permlane16_swap_b32 v12, v14
  v_permlane16_swap_b32 v13, v15
  v_permlane16_swap_b32 v16, v18
  v_permlane16_swap_b32 v17, v19
  v_mfma_f32_16x16x32_bf16 v[48:51], v[80:83], v[196:199], v[48:51]
  v_mfma_f32_16x16x32_bf16 v[52:55], v[84:87], v[196:199], v[52:55]
  s_waitcnt vmcnt(11) lgkmcnt(8)
  v_mfma_f32_16x16x32_bf16 v[40:43], v[88:91], v[200:203], v[40:43]
  s_waitcnt lgkmcnt(1)
  v_cmp_gt_u32 vcc, 26, v10
  s_cbranch_vccnz SLOW_76
JOIN_77:
  ds_read_b128 v[56:59], v22 offset:0
  v_mfma_f32_16x16x32_bf16 v[44:47], v[92:95], v[200:203], v[44:47]
  ds_read_b128 v[60:63], v22 offset:2048
  v_mfma_f32_16x16x32_bf16 v[48:51], v[96:99], v[200:203], v[48:51]
  ds_read_b128 v[64:67], v22 offset:4096
  v_mfma_f32_16x16x32_bf16 v[52:55], v[100:103], v[200:203], v[52:55]
  ds_read_b128 v[68:71], v22 offset:6144
  s_waitcnt vmcnt(10)
  v_mfma_f32_16x16x32_bf16 v[40:43], v[88:91], v[204:207], v[40:43]
  ds_read_b128 v[72:75], v23 offset:0
  v_mfma_f32_16x16x32_bf16 v[44:47], v[92:95], v[204:207], v[44:47]
  ds_read_b128 v[76:79], v23 offset:2048
  v_mfma_f32_16x16x32_bf16 v[48:51], v[96:99], v[204:207], v[48:51]
  ds_read_b128 v[80:83], v23 offset:4096
  v_mfma_f32_16x16x32_bf16 v[52:55], v[100:103], v[204:207], v[52:55]
  ds_read_b128 v[84:87], v23 offset:6144
  s_waitcnt vmcnt(9)
  v_mfma_f32_16x16x32_bf16 v[40:43], v[104:107], v[208:211], v[40:43]
  v_lshlrev_b32 v152, 16, v12
  v_and_b32 v153, 0xffff0000, v12
  v_lshlrev_b32 v154, 16, v13
  v_and_b32 v155, 0xffff0000, v13
  v_mfma_f32_16x16x32_bf16 v[44:47], v[108:111], v[208:211], v[44:47]
  v_mfma_f32_16x16x32_bf16 v[48:51], v[112:115], v[208:211], v[48:51]
  v_lshlrev_b32 v156, 16, v14
  v_and_b32 v157, 0xffff0000, v14
  v_lshlrev_b32 v158, 16, v15
  v_and_b32 v159, 0xffff0000, v15
  v_mfma_f32_16x16x32_bf16 v[52:55], v[116:119], v[208:211], v[52:55]
  s_waitcnt vmcnt(8)
  v_mfma_f32_16x16x32_bf16 v[40:43], v[104:107], v[212:215], v[40:43]
  v_lshlrev_b32 v160, 16, v16
  v_and_b32 v161, 0xffff0000, v16
  v_lshlrev_b32 v162, 16, v17
  v_and_b32 v163, 0xffff0000, v17
  v_mfma_f32_16x16x32_bf16 v[44:47], v[108:111], v[212:215], v[44:47]
  v_mfma_f32_16x16x32_bf16 v[48:51], v[112:115], v[212:215], v[48:51]
  v_lshlrev_b32 v164, 16, v18
  v_and_b32 v165, 0xffff0000, v18
  v_lshlrev_b32 v166, 16, v19
  v_and_b32 v167, 0xffff0000, v19
  v_mfma_f32_16x16x32_bf16 v[52:55], v[116:119], v[212:215], v[52:55]
  s_waitcnt vmcnt(7) lgkmcnt(6)
  v_mfma_f32_16x16x32_bf16 v[40:43], v[56:59], v[216:219], v[40:43]
  ds_read_b128 v[88:91], v22 offset:8192
  v_mfma_f32_16x16x32_bf16 v[44:47], v[60:63], v[216:219], v[44:47]
  ds_read_b128 v[92:95], v22 offset:10240
  s_waitcnt lgkmcnt(6)
  v_mfma_f32_16x16x32_bf16 v[48:51], v[64:67], v[216:219], v[48:51]
  ds_read_b128 v[96:99], v22 offset:12288
  v_mfma_f32_16x16x32_bf16 v[52:55], v[68:71], v[216:219], v[52:55]
  ds_read_b128 v[100:103], v22 offset:14336
  s_waitcnt vmcnt(6)
  v_mfma_f32_16x16x32_bf16 v[40:43], v[56:59], v[220:223], v[40:43]
  ds_read_b128 v[104:107], v23 offset:8192
  v_mfma_f32_16x16x32_bf16 v[44:47], v[60:63], v[220:223], v[44:47]
  ds_read_b128 v[108:111], v23 offset:10240
  v_mfma_f32_16x16x32_bf16 v[48:51], v[64:67], v[220:223], v[48:51]
  ds_read_b128 v[112:115], v23 offset:12288
  v_mfma_f32_16x16x32_bf16 v[52:55], v[68:71], v[220:223], v[52:55]
  ds_read_b128 v[116:119], v23 offset:14336
  s_waitcnt vmcnt(5) lgkmcnt(10)
  v_mfma_f32_16x16x32_bf16 v[40:43], v[72:75], v[224:227], v[40:43]
  ds_add_u32 v30, v31
  v_mfma_f32_16x16x32_bf16 v[44:47], v[76:79], v[224:227], v[44:47]
  s_waitcnt lgkmcnt(9)
  v_mfma_f32_16x16x32_bf16 v[48:51], v[80:83], v[224:227], v[48:51]
  v_mfma_f32_16x16x32_bf16 v[52:55], v[84:87], v[224:227], v[52:55]
  s_waitcnt vmcnt(4)
  v_mfma_f32_16x16x32_bf16 v[40:43], v[72:75], v[228:231], v[40:43]
  v_mfma_f32_16x16x32_bf16 v[44:47], v[76:79], v[228:231], v[44:47]
  v_mfma_f32_16x16x32_bf16 v[48:51], v[80:83], v[228:231], v[48:51]
  v_mfma_f32_16x16x32_bf16 v[52:55], v[84:87], v[228:231], v[52:55]
  s_waitcnt vmcnt(3) lgkmcnt(7)
  v_mfma_f32_16x16x32_bf16 v[40:43], v[88:91], v[232:235], v[40:43]
  v_mfma_f32_16x16x32_bf16 v[44:47], v[92:95], v[232:235], v[44:47]
  ds_read_b128 v[120:123], v35 offset:3840
  ds_read_b128 v[136:139], v35 offset:4096
  s_waitcnt lgkmcnt(7)
  v_mfma_f32_16x16x32_bf16 v[48:51], v[96:99], v[232:235], v[48:51]
  v_mfma_f32_16x16x32_bf16 v[52:55], v[100:103], v[232:235], v[52:55]
  s_waitcnt vmcnt(2)
  v_mfma_f32_16x16x32_bf16 v[40:43], v[88:91], v[236:239], v[40:43]
  ds_read_b128 v[124:127], v35 offset:3904
  ds_read_b128 v[140:143], v35 offset:4160
  v_mfma_f32_16x16x32_bf16 v[44:47], v[92:95], v[236:239], v[44:47]
  v_mfma_f32_16x16x32_bf16 v[48:51], v[96:99], v[236:239], v[48:51]
  v_mfma_f32_16x16x32_bf16 v[52:55], v[100:103], v[236:239], v[52:55]
  s_waitcnt vmcnt(1) lgkmcnt(7)
  v_mfma_f32_16x16x32_bf16 v[40:43], v[104:107], v[240:243], v[40:43]
  ds_read_b128 v[128:131], v35 offset:3968
  ds_read_b128 v[144:147], v35 offset:4224
  v_mfma_f32_16x16x32_bf16 v[44:47], v[108:111], v[240:243], v[44:47]
  s_waitcnt lgkmcnt(7)
  v_mfma_f32_16x16x32_bf16 v[48:51], v[112:115], v[240:243], v[48:51]
  v_mfma_f32_16x16x32_bf16 v[52:55], v[116:119], v[240:243], v[52:55]
  s_waitcnt vmcnt(0)
  v_mfma_f32_16x16x32_bf16 v[40:43], v[104:107], v[244:247], v[40:43]
  ds_read_b128 v[132:135], v35 offset:4032
  ds_read_b128 v[148:151], v35 offset:4288
  v_mfma_f32_16x16x32_bf16 v[44:47], v[108:111], v[244:247], v[44:47]
  v_mfma_f32_16x16x32_bf16 v[48:51], v[112:115], v[244:247], v[48:51]
  v_mfma_f32_16x16x32_bf16 v[52:55], v[116:119], v[244:247], v[52:55]
  s_waitcnt lgkmcnt(0)
  s_cmp_lg_u32 s17, 1
  s_cbranch_scc1 MS_79
  v_pk_fma_f32 v[40:41], v[40:41], v[120:121], v[152:153]
  v_pk_fma_f32 v[42:43], v[42:43], v[122:123], v[154:155]
  s_nop 0
  v_pk_fma_f32 v[44:45], v[44:45], v[124:125], v[156:157]
  v_pk_fma_f32 v[46:47], v[46:47], v[126:127], v[158:159]
  v_pk_mul_f32 v[56:57], v[40:41], v[136:137]
  v_pk_mul_f32 v[58:59], v[42:43], v[138:139]
  v_pk_mul_f32 v[60:61], v[44:45], v[140:141]
  v_pk_mul_f32 v[62:63], v[46:47], v[142:143]
  v_cvt_pk_bf16_f32 v72, v56, v57
  v_cvt_pk_bf16_f32 v73, v58, v59
  v_cvt_pk_bf16_f32 v74, v60, v61
  v_cvt_pk_bf16_f32 v75, v62, v63
  buffer_store_dwordx4 v[72:75], v32, s[20:23], s46 offen offset:0 sc1
  v_pk_fma_f32 v[48:49], v[48:49], v[128:129], v[160:161]
  v_pk_fma_f32 v[50:51], v[50:51], v[130:131], v[162:163]
  v_pk_fma_f32 v[52:53], v[52:53], v[132:133], v[164:165]
  v_pk_fma_f32 v[54:55], v[54:55], v[134:135], v[166:167]
  v_pk_mul_f32 v[64:65], v[48:49], v[144:145]
  v_pk_mul_f32 v[66:67], v[50:51], v[146:147]
  v_pk_mul_f32 v[68:69], v[52:53], v[148:149]
  v_pk_mul_f32 v[70:71], v[54:55], v[150:151]
  v_cvt_pk_bf16_f32 v76, v64, v65
  v_cvt_pk_bf16_f32 v77, v66, v67
  v_cvt_pk_bf16_f32 v78, v68, v69
  v_cvt_pk_bf16_f32 v79, v70, v71
  buffer_store_dwordx4 v[76:79], v32, s[20:23], s46 offen offset:1024 sc1
  v_cvt_pk_bf16_f32 v12, v40, v41
  v_cvt_pk_bf16_f32 v13, v42, v43
  v_cvt_pk_bf16_f32 v14, v44, v45
  v_cvt_pk_bf16_f32 v15, v46, v47
  v_cvt_pk_bf16_f32 v16, v48, v49
  v_cvt_pk_bf16_f32 v17, v50, v51
  v_cvt_pk_bf16_f32 v18, v52, v53
  v_cvt_pk_bf16_f32 v19, v54, v55
  v_dot2_f32_bf16 v4, v12, v8, 0
  v_dot2_f32_bf16 v6, v12, v12, 0
  v_dot2_f32_bf16 v4, v13, v8, v4
  v_dot2_f32_bf16 v6, v13, v13, v6
  v_dot2_f32_bf16 v4, v14, v8, v4
  v_dot2_f32_bf16 v6, v14, v14, v6
  v_dot2_f32_bf16 v4, v15, v8, v4
  v_dot2_f32_bf16 v6, v15, v15, v6
  v_dot2_f32_bf16 v4, v16, v8, v4
  v_dot2_f32_bf16 v6, v16, v16, v6
  v_dot2_f32_bf16 v4, v17, v8, v4
  v_dot2_f32_bf16 v6, v17, v17, v6
  v_dot2_f32_bf16 v4, v18, v8, v4
  v_dot2_f32_bf16 v6, v18, v18, v6
  v_dot2_f32_bf16 v4, v19, v8, v4
  v_dot2_f32_bf16 v6, v19, v19, v6
  s_nop 2
  v_permlane32_swap_b32 v4, v6
  v_add_f32 v4, v4, v6
  v_mov_b32 v5, v4
  s_nop 1
  v_permlane16_swap_b32 v4, v5
  v_add_f32 v4, v4, v5
  s_mov_b32 exec_lo, 0xffff
  s_mov_b32 exec_hi, 0xffff
  buffer_store_dword v4, v7, s[24:27], s47 offen sc1
  s_mov_b64 exec, -1
  s_waitcnt vmcnt(0)
  v_mov_b32 v4, s14
  v_mov_b32 v5, s15
  s_mov_b64 exec, 1
  buffer_store_dwordx2 v[4:5], v33, s[24:27], s50 offen
  s_mov_b64 exec, -1
MJ_80:
  s_cmp_eq_u32 s12, 15
  s_cbranch_scc1 SK3_81a
  v_mov_b32 v40, 0
  v_mov_b32 v41, 0
  v_mov_b32 v42, 0
  v_mov_b32 v43, 0
  v_mov_b32 v44, 0
  v_mov_b32 v45, 0
  v_mov_b32 v46, 0
  v_mov_b32 v47, 0
  v_mov_b32 v48, 0
  v_mov_b32 v49, 0
  v_mov_b32 v50, 0
  v_mov_b32 v51, 0
  v_mov_b32 v52, 0
  v_mov_b32 v53, 0
  v_mov_b32 v54, 0
  v_mov_b32 v55, 0
  v_mov_b32 v56, 0
  v_mov_b32 v57, 0
  v_mov_b32 v58, 0
  v_mov_b32 v59, 0
  v_mov_b32 v60, 0
  v_mov_b32 v61, 0
  v_mov_b32 v62, 0
  v_mov_b32 v63, 0
  v_mov_b32 v64, 0
  v_mov_b32 v65, 0
  v_mov_b32 v66, 0
  v_mov_b32 v67, 0
  v_mov_b32 v68, 0
  v_mov_b32 v69, 0
  v_mov_b32 v70, 0
  v_mov_b32 v71, 0
  v_mov_b32 v72, 0
  v_mov_b32 v73, 0
  v_mov_b32 v74, 0
  v_mov_b32 v75, 0
  v_mov_b32 v76, 0
  v_mov_b32 v77, 0
  v_mov_b32 v78, 0
  v_mov_b32 v79, 0
  v_mov_b32 v80, 0
  v_mov_b32 v81, 0
  v_mov_b32 v82, 0
  v_mov_b32 v83, 0
  v_mov_b32 v84, 0
  v_mov_b32 v85, 0
  v_mov_b32 v86, 0
  v_mov_b32 v87, 0
  v_lshrrev_b32 v5, 2, v1
  v_mul_u32_u24 v5, 192, v5
  v_and_b32 v6, 3, v1
  v_lshl_add_u32 v5, v6, 3, v5
  v_bfe_u32 v6, v1, 4, 1
  v_lshl_add_u32 v20, v6, 5, v5
  v_xor_b32 v6, 1, v6
  v_lshl_add_u32 v21, v6, 5, v5
  v_add_u32 v22, 0x10000, v20
  v_add_u32 v24, 0x20000, v20
  v_add_u32 v23, 0x10000, v21
  v_add_u32 v25, 0x20000, v21
  s_lshl_b32 s56, s11, 17
  s_lshl_b32 s44, s3, 15
  s_add_u32 s56, s56, s44
  s_add_u32 s56, s56, 0xc00000
  s_add_u32 s58, s56, 0x4000
  s_lshl_b32 s47, s11, 13
  s_lshl_b32 s44, s3, 11
  s_add_u32 s47, s47, s44
  s_add_u32 s47, s47, 0x10000
  s_mul_i32 s46, s11, 393216
  s_mul_i32 s44, s3, 98304
  s_add_u32 s46, s46, s44
  s_mul_i32 s44, s12, 3072
  s_add_u32 s46, s46, s44
  s_add_u32 s46, s46, 0x1000000
  s_add_u32 s48, s46, 49152
  s_lshl_b32 s50, s11, 9
  s_lshl_b32 s44, s12, 5
  s_add_u32 s50, s50, s44
  s_lshl_b32 s44, s3, 3
  s_add_u32 s50, s50, s44
  s_add_u32 s50, s50, 0x58000
  v_and_b32 v4, 15, v1
  v_lshrrev_b32 v5, 4, v1
  v_lshlrev_b32 v7, 4, v5
  v_lshl_add_u32 v7, v4, 6, v7
SP_82:
  ds_read_b32 v10, v34 offset:0
  s_sub_u32 s13, s13, 1
  s_cbranch_scc1 ABORT
  s_waitcnt lgkmcnt(0)
  v_cmp_gt_u32 vcc, 27, v10
  s_cbranch_vccnz SP_82
  buffer_load_dwordx4 v[136:139], v32, s[20:23], s56 offen offset:0 sc1
  buffer_load_dwordx4 v[140:143], v32, s[20:23], s58 offen offset:0 sc1
  buffer_load_dwordx4 v[144:147], v32, s[20:23], s56 offen offset:1024 sc1
  buffer_load_dwordx4 v[148:151], v32, s[20:23], s58 offen offset:1024 sc1
  buffer_load_dwordx4 v[152:155], v32, s[20:23], s56 offen offset:2048 sc1
  buffer_load_dwordx4 v[156:159], v32, s[20:23], s58 offen offset:2048 sc1
  buffer_load_dwordx4 v[160:163], v32, s[20:23], s56 offen offset:3072 sc1
  buffer_load_dwordx4 v[164:167], v32, s[20:23], s58 offen offset:3072 sc1
SP_83:
  ds_read_b32 v10, v29 offset:0
  s_sub_u32 s13, s13, 1
  s_cbranch_scc1 ABORT
  s_waitcnt lgkmcnt(0)
  v_cmp_gt_u32 vcc, 28, v10
  s_cbranch_vccnz SP_83
  ds_read_b64_tr_b16 v[88:89], v22 offset:16384
  ds_read_b64_tr_b16 v[90:91], v22 offset:19456
  ds_read_b64_tr_b16 v[92:93], v23 offset:16384
  ds_read_b64_tr_b16 v[94:95], v23 offset:19456
  ds_read_b64_tr_b16 v[96:97], v22 offset:16448
  ds_read_b64_tr_b16 v[98:99], v22 offset:19520
  ds_read_b64_tr_b16 v[100:101], v23 offset:16448
  ds_read_b64_tr_b16 v[102:103], v23 offset:19520
  ds_read_b64_tr_b16 v[104:105], v22 offset:16512
  ds_read_b64_tr_b16 v[106:107], v22 offset:19584
  ds_read_b64_tr_b16 v[108:109], v23 offset:16512
  ds_read_b64_tr_b16 v[110:111], v23 offset:19584
  s_waitcnt vmcnt(6) lgkmcnt(8)
  v_mfma_f32_16x16x32_bf16 v[40:43], v[88:91], v[136:139], v[40:43]
  ds_read_b64_tr_b16 v[112:113], v22 offset:22528
  ds_read_b64_tr_b16 v[114:115], v22 offset:25600
  v_mfma_f32_16x16x32_bf16 v[64:67], v[88:91], v[140:143], v[64:67]
  ds_read_b64_tr_b16 v[116:117], v23 offset:22528
  ds_read_b64_tr_b16 v[118:119], v23 offset:25600
  v_mfma_f32_16x16x32_bf16 v[68:71], v[92:95], v[140:143], v[68:71]
  ds_read_b64_tr_b16 v[120:121], v22 offset:22592
  ds_read_b64_tr_b16 v[122:123], v22 offset:25664
  v_mfma_f32_16x16x32_bf16 v[44:47], v[92:95], v[136:139], v[44:47]
  ds_read_b64_tr_b16 v[124:125], v23 offset:22592
  ds_read_b64_tr_b16 v[126:127], v23 offset:25664
  s_waitcnt lgkmcnt(12)
  v_mfma_f32_16x16x32_bf16 v[48:51], v[96:99], v[136:139], v[48:51]
  ds_read_b64_tr_b16 v[128:129], v22 offset:22656
  ds_read_b64_tr_b16 v[130:131], v22 offset:25728
  v_mfma_f32_16x16x32_bf16 v[72:75], v[96:99], v[140:143], v[72:75]
  ds_read_b64_tr_b16 v[132:133], v23 offset:22656
  ds_read_b64_tr_b16 v[134:135], v23 offset:25728
  v_mfma_f32_16x16x32_bf16 v[76:79], v[100:103], v[140:143], v[76:79]
  ds_read_b32 v10, v29
  v_mfma_f32_16x16x32_bf16 v[52:55], v[100:103], v[136:139], v[52:55]
  ds_add_u32 v30, v31
  s_waitcnt lgkmcnt(14)
  v_mfma_f32_16x16x32_bf16 v[56:59], v[104:107], v[136:139], v[56:59]
  v_mfma_f32_16x16x32_bf16 v[80:83], v[104:107], v[140:143], v[80:83]
  s_add_u32 s59, s56, 4096
  buffer_load_dwordx4 v[168:171], v32, s[20:23], s59 offen offset:0 sc1
  v_mfma_f32_16x16x32_bf16 v[84:87], v[108:111], v[140:143], v[84:87]
  s_add_u32 s60, s58, 4096
  buffer_load_dwordx4 v[172:175], v32, s[20:23], s60 offen offset:0 sc1
  v_mfma_f32_16x16x32_bf16 v[60:63], v[108:111], v[136:139], v[60:63]
  s_waitcnt vmcnt(6) lgkmcnt(10)
  v_mfma_f32_16x16x32_bf16 v[40:43], v[112:115], v[144:147], v[40:43]
  s_waitcnt lgkmcnt(1)
  v_cmp_gt_u32 vcc, 29, v10
  s_cbranch_vccnz SLOW_84
JOIN_85:
  ds_read_b64_tr_b16 v[88:89], v22 offset:28672
  ds_read_b64_tr_b16 v[90:91], v22 offset:31744
  v_mfma_f32_16x16x32_bf16 v[64:67], v[112:115], v[148:151], v[64:67]
  ds_read_b64_tr_b16 v[92:93], v23 offset:28672
  ds_read_b64_tr_b16 v[94:95], v23 offset:31744
  v_mfma_f32_16x16x32_bf16 v[68:71], v[116:119], v[148:151], v[68:71]
  ds_read_b64_tr_b16 v[96:97], v22 offset:28736
  ds_read_b64_tr_b16 v[98:99], v22 offset:31808
  v_mfma_f32_16x16x32_bf16 v[44:47], v[116:119], v[144:147], v[44:47]
  ds_read_b64_tr_b16 v[100:101], v23 offset:28736
  ds_read_b64_tr_b16 v[102:103], v23 offset:31808
  v_mfma_f32_16x16x32_bf16 v[48:51], v[120:123], v[144:147], v[48:51]
  ds_read_b64_tr_b16 v[104:105], v22 offset:28800
  ds_read_b64_tr_b16 v[106:107], v22 offset:31872
  v_mfma_f32_16x16x32_bf16 v[72:75], v[120:123], v[148:151], v[72:75]
  ds_read_b64_tr_b16 v[108:109], v23 offset:28800
  ds_read_b64_tr_b16 v[110:111], v23 offset:31872
  v_mfma_f32_16x16x32_bf16 v[76:79], v[124:127], v[148:151], v[76:79]
  buffer_load_dwordx4 v[176:179], v32, s[20:23], s59 offen offset:1024 sc1
  v_mfma_f32_16x16x32_bf16 v[52:55], v[124:127], v[144:147], v[52:55]
  v_mfma_f32_16x16x32_bf16 v[56:59], v[128:131], v[144:147], v[56:59]
  v_mfma_f32_16x16x32_bf16 v[80:83], v[128:131], v[148:151], v[80:83]
  buffer_load_dwordx4 v[180:183], v32, s[20:23], s60 offen offset:1024 sc1
  v_mfma_f32_16x16x32_bf16 v[84:87], v[132:135], v[148:151], v[84:87]
  v_mfma_f32_16x16x32_bf16 v[60:63], v[132:135], v[144:147], v[60:63]
  s_waitcnt vmcnt(6) lgkmcnt(8)
  v_mfma_f32_16x16x32_bf16 v[40:43], v[88:91], v[152:155], v[40:43]
  ds_read_b64_tr_b16 v[112:113], v22 offset:34816
  ds_read_b64_tr_b16 v[114:115], v22 offset:37888
  v_mfma_f32_16x16x32_bf16 v[64:67], v[88:91], v[156:159], v[64:67]
  ds_read_b64_tr_b16 v[116:117], v23 offset:34816
  ds_read_b64_tr_b16 v[118:119], v23 offset:37888
  v_mfma_f32_16x16x32_bf16 v[68:71], v[92:95], v[156:159], v[68:71]
  ds_read_b64_tr_b16 v[120:121], v22 offset:34880
  ds_read_b64_tr_b16 v[122:123], v22 offset:37952
  v_mfma_f32_16x16x32_bf16 v[44:47], v[92:95], v[152:155], v[44:47]
  ds_read_b64_tr_b16 v[124:125], v23 offset:34880
  ds_read_b64_tr_b16 v[126:127], v23 offset:37952
  s_waitcnt lgkmcnt(12)
  v_mfma_f32_16x16x32_bf16 v[48:51], v[96:99], v[152:155], v[48:51]
  ds_read_b64_tr_b16 v[128:129], v22 offset:34944
  ds_read_b64_tr_b16 v[130:131], v22 offset:38016
  v_mfma_f32_16x16x32_bf16 v[72:75], v[96:99], v[156:159], v[72:75]
  ds_read_b64_tr_b16 v[132:133], v23 offset:34944
  ds_read_b64_tr_b16 v[134:135], v23 offset:38016
  v_mfma_f32_16x16x32_bf16 v[76:79], v[100:103], v[156:159], v[76:79]
  ds_read_b32 v10, v29
  v_mfma_f32_16x16x32_bf16 v[52:55], v[100:103], v[152:155], v[52:55]
  ds_add_u32 v30, v31
  s_waitcnt lgkmcnt(14)
  v_mfma_f32_16x16x32_bf16 v[56:59], v[104:107], v[152:155], v[56:59]
  v_mfma_f32_16x16x32_bf16 v[80:83], v[104:107], v[156:159], v[80:83]
  buffer_load_dwordx4 v[184:187], v32, s[20:23], s59 offen offset:2048 sc1
  v_mfma_f32_16x16x32_bf16 v[84:87], v[108:111], v[156:159], v[84:87]
  buffer_load_dwordx4 v[188:191], v32, s[20:23], s60 offen offset:2048 sc1
  v_mfma_f32_16x16x32_bf16 v[60:63], v[108:111], v[152:155], v[60:63]
  s_waitcnt vmcnt(6) lgkmcnt(10)
  v_mfma_f32_16x16x32_bf16 v[40:43], v[112:115], v[160:163], v[40:43]
  s_waitcnt lgkmcnt(1)
  v_cmp_gt_u32 vcc, 30, v10
  s_cbranch_vccnz SLOW_87
JOIN_88:
  ds_read_b64_tr_b16 v[88:89], v22 offset:40960
  ds_read_b64_tr_b16 v[90:91], v22 offset:44032
  v_mfma_f32_16x16x32_bf16 v[64:67], v[112:115], v[164:167], v[64:67]
  ds_read_b64_tr_b16 v[92:93], v23 offset:40960
  ds_read_b64_tr_b16 v[94:95], v23 offset:44032
  v_mfma_f32_16x16x32_bf16 v[68:71], v[116:119], v[164:167], v[68:71]
  ds_read_b64_tr_b16 v[96:97], v22 offset:41024
  ds_read_b64_tr_b16 v[98:99], v22 offset:44096
  v_mfma_f32_16x16x32_bf16 v[44:47], v[116:119], v[160:163], v[44:47]
  ds_read_b64_tr_b16 v[100:101], v23 offset:41024
  ds_read_b64_tr_b16 v[102:103], v23 offset:44096
  v_mfma_f32_16x16x32_bf16 v[48:51], v[120:123], v[160:163], v[48:51]
  ds_read_b64_tr_b16 v[104:105], v22 offset:41088
  ds_read_b64_tr_b16 v[106:107], v22 offset:44160
  v_mfma_f32_16x16x32_bf16 v[72:75], v[120:123], v[164:167], v[72:75]
  ds_read_b64_tr_b16 v[108:109], v23 offset:41088
  ds_read_b64_tr_b16 v[110:111], v23 offset:44160
  v_mfma_f32_16x16x32_bf16 v[76:79], v[124:127], v[164:167], v[76:79]
  buffer_load_dwordx4 v[192:195], v32, s[20:23], s59 offen offset:3072 sc1
  v_mfma_f32_16x16x32_bf16 v[52:55], v[124:127], v[160:163], v[52:55]
  v_mfma_f32_16x16x32_bf16 v[56:59], v[128:131], v[160:163], v[56:59]
  v_mfma_f32_16x16x32_bf16 v[80:83], v[128:131], v[164:167], v[80:83]
  buffer_load_dwordx4 v[196:199], v32, s[20:23], s60 offen offset:3072 sc1
  v_mfma_f32_16x16x32_bf16 v[84:87], v[132:135], v[164:167], v[84:87]
  v_mfma_f32_16x16x32_bf16 v[60:63], v[132:135], v[160:163], v[60:63]
  s_waitcnt vmcnt(6) lgkmcnt(8)
  v_mfma_f32_16x16x32_bf16 v[40:43], v[88:91], v[168:171], v[40:43]
  ds_read_b64_tr_b16 v[112:113], v22 offset:47104
  ds_read_b64_tr_b16 v[114:115], v22 offset:50176
  v_mfma_f32_16x16x32_bf16 v[64:67], v[88:91], v[172:175], v[64:67]
  ds_read_b64_tr_b16 v[116:117], v23 offset:47104
  ds_read_b64_tr_b16 v[118:119], v23 offset:50176
  v_mfma_f32_16x16x32_bf16 v[68:71], v[92:95], v[172:175], v[68:71]
  ds_read_b64_tr_b16 v[120:121], v22 offset:47168
  ds_read_b64_tr_b16 v[122:123], v22 offset:50240
  v_mfma_f32_16x16x32_bf16 v[44:47], v[92:95], v[168:171], v[44:47]
  ds_read_b64_tr_b16 v[124:125], v23 offset:47168
  ds_read_b64_tr_b16 v[126:127], v23 offset:50240
  s_waitcnt lgkmcnt(12)
  v_mfma_f32_16x16x32_bf16 v[48:51], v[96:99], v[168:171], v[48:51]
  ds_read_b64_tr_b16 v[128:129], v22 offset:47232
  ds_read_b64_tr_b16 v[130:131], v22 offset:50304
  v_mfma_f32_16x16x32_bf16 v[72:75], v[96:99], v[172:175], v[72:75]
  ds_read_b64_tr_b16 v[132:133], v23 offset:47232
  ds_read_b64_tr_b16 v[134:135], v23 offset:50304
  v_mfma_f32_16x16x32_bf16 v[76:79], v[100:103], v[172:175], v[76:79]
  ds_read_b32 v10, v29
  v_mfma_f32_16x16x32_bf16 v[52:55], v[100:103], v[168:171], v[52:55]
  ds_add_u32 v30, v31
  s_waitcnt lgkmcnt(14)
  v_mfma_f32_16x16x32_bf16 v[56:59], v[104:107], v[168:171], v[56:59]
  v_mfma_f32_16x16x32_bf16 v[80:83], v[104:107], v[172:175], v[80:83]
  s_add_u32 s59, s56, 8192
  buffer_load_dwordx4 v[200:203], v32, s[20:23], s59 offen offset:0 sc1
  v_mfma_f32_16x16x32_bf16 v[84:87], v[108:111], v[172:175], v[84:87]
  s_add_u32 s60, s58, 8192
  buffer_load_dwordx4 v[204:207], v32, s[20:23], s60 offen offset:0 sc1
  v_mfma_f32_16x16x32_bf16 v[60:63], v[108:111], v[168:171], v[60:63]
  s_waitcnt vmcnt(6) lgkmcnt(10)
  v_mfma_f32_16x16x32_bf16 v[40:43], v[112:115], v[176:179], v[40:43]
  s_waitcnt lgkmcnt(1)
  v_cmp_gt_u32 vcc, 31, v10
  s_cbranch_vccnz SLOW_90
JOIN_91:
  ds_read_b64_tr_b16 v[88:89], v22 offset:53248
  ds_read_b64_tr_b16 v[90:91], v22 offset:56320
  v_mfma_f32_16x16x32_bf16 v[64:67], v[112:115], v[180:183], v[64:67]
  ds_read_b64_tr_b16 v[92:93], v23 offset:53248
  ds_read_b64_tr_b16 v[94:95], v23 offset:56320
  v_mfma_f32_16x16x32_bf16 v[68:71], v[116:119], v[180:183], v[68:71]
  ds_read_b64_tr_b16 v[96:97], v22 offset:53312
  ds_read_b64_tr_b16 v[98:99], v22 offset:56384
  v_mfma_f32_16x16x32_bf16 v[44:47], v[116:119], v[176:179], v[44:47]
  ds_read_b64_tr_b16 v[100:101], v23 offset:53312
  ds_read_b64_tr_b16 v[102:103], v23 offset:56384
  v_mfma_f32_16x16x32_bf16 v[48:51], v[120:123], v[176:179], v[48:51]
  ds_read_b64_tr_b16 v[104:105], v22 offset:53376
  ds_read_b64_tr_b16 v[106:107], v22 offset:56448
  v_mfma_f32_16x16x32_bf16 v[72:75], v[120:123], v[180:183], v[72:75]
  ds_read_b64_tr_b16 v[108:109], v23 offset:53376
  ds_read_b64_tr_b16 v[110:111], v23 offset:56448
  v_mfma_f32_16x16x32_bf16 v[76:79], v[124:127], v[180:183], v[76:79]
  buffer_load_dwordx4 v[208:211], v32, s[20:23], s59 offen offset:1024 sc1
  v_mfma_f32_16x16x32_bf16 v[52:55], v[124:127], v[176:179], v[52:55]
  v_mfma_f32_16x16x32_bf16 v[56:59], v[128:131], v[176:179], v[56:59]
  v_mfma_f32_16x16x32_bf16 v[80:83], v[128:131], v[180:183], v[80:83]
  buffer_load_dwordx4 v[212:215], v32, s[20:23], s60 offen offset:1024 sc1
  v_mfma_f32_16x16x32_bf16 v[84:87], v[132:135], v[180:183], v[84:87]
  v_mfma_f32_16x16x32_bf16 v[60:63], v[132:135], v[176:179], v[60:63]
  s_waitcnt vmcnt(6) lgkmcnt(8)
  v_mfma_f32_16x16x32_bf16 v[40:43], v[88:91], v[184:187], v[40:43]
  ds_read_b64_tr_b16 v[112:113], v22 offset:59392
  ds_read_b64_tr_b16 v[114:115], v22 offset:62464
  v_mfma_f32_16x16x32_bf16 v[64:67], v[88:91], v[188:191], v[64:67]
  ds_read_b64_tr_b16 v[116:117], v23 offset:59392
  ds_read_b64_tr_b16 v[118:119], v23 offset:62464
  v_mfma_f32_16x16x32_bf16 v[68:71], v[92:95], v[188:191], v[68:71]
  ds_read_b64_tr_b16 v[120:121], v22 offset:59456
  ds_read_b64_tr_b16 v[122:123], v22 offset:62528
  v_mfma_f32_16x16x32_bf16 v[44:47], v[92:95], v[184:187], v[44:47]
  ds_read_b64_tr_b16 v[124:125], v23 offset:59456
  ds_read_b64_tr_b16 v[126:127], v23 offset:62528
  s_waitcnt lgkmcnt(12)
  v_mfma_f32_16x16x32_bf16 v[48:51], v[96:99], v[184:187], v[48:51]
  ds_read_b64_tr_b16 v[128:129], v22 offset:59520
  ds_read_b64_tr_b16 v[130:131], v22 offset:62592
  v_mfma_f32_16x16x32_bf16 v[72:75], v[96:99], v[188:191], v[72:75]
  ds_read_b64_tr_b16 v[132:133], v23 offset:59520
  ds_read_b64_tr_b16 v[134:135], v23 offset:62592
  v_mfma_f32_16x16x32_bf16 v[76:79], v[100:103], v[188:191], v[76:79]
  ds_read_b32 v10, v29
  v_mfma_f32_16x16x32_bf16 v[52:55], v[100:103], v[184:187], v[52:55]
  ds_add_u32 v30, v31
  s_waitcnt lgkmcnt(14)
  v_mfma_f32_16x16x32_bf16 v[56:59], v[104:107], v[184:187], v[56:59]
  v_mfma_f32_16x16x32_bf16 v[80:83], v[104:107], v[188:191], v[80:83]
  buffer_load_dwordx4 v[216:219], v32, s[20:23], s59 offen offset:2048 sc1
  v_mfma_f32_16x16x32_bf16 v[84:87], v[108:111], v[188:191], v[84:87]
  buffer_load_dwordx4 v[220:223], v32, s[20:23], s60 offen offset:2048 sc1
  v_mfma_f32_16x16x32_bf16 v[60:63], v[108:111], v[184:187], v[60:63]
  s_waitcnt vmcnt(6) lgkmcnt(10)
  v_mfma_f32_16x16x32_bf16 v[40:43], v[112:115], v[192:195], v[40:43]
  s_waitcnt lgkmcnt(1)
  v_cmp_gt_u32 vcc, 32, v10
  s_cbranch_vccnz SLOW_93
JOIN_94:
  ds_read_b64_tr_b16 v[88:89], v24 offset:0
  ds_read_b64_tr_b16 v[90:91], v24 offset:3072
  v_mfma_f32_16x16x32_bf16 v[64:67], v[112:115], v[196:199], v[64:67]
  ds_read_b64_tr_b16 v[92:93], v25 offset:0
  ds_read_b64_tr_b16 v[94:95], v25 offset:3072
  v_mfma_f32_16x16x32_bf16 v[68:71], v[116:119], v[196:199], v[68:71]
  ds_read_b64_tr_b16 v[96:97], v24 offset:64
  ds_read_b64_tr_b16 v[98:99], v24 offset:3136
  v_mfma_f32_16x16x32_bf16 v[44:47], v[116:119], v[192:195], v[44:47]
  ds_read_b64_tr_b16 v[100:101], v25 offset:64
  ds_read_b64_tr_b16 v[102:103], v25 offset:3136
  v_mfma_f32_16x16x32_bf16 v[48:51], v[120:123], v[192:195], v[48:51]
  ds_read_b64_tr_b16 v[104:105], v24 offset:128
  ds_read_b64_tr_b16 v[106:107], v24 offset:3200
  v_mfma_f32_16x16x32_bf16 v[72:75], v[120:123], v[196:199], v[72:75]
  ds_read_b64_tr_b16 v[108:109], v25 offset:128
  ds_read_b64_tr_b16 v[110:111], v25 offset:3200
  v_mfma_f32_16x16x32_bf16 v[76:79], v[124:127], v[196:199], v[76:79]
  buffer_load_dwordx4 v[224:227], v32, s[20:23], s59 offen offset:3072 sc1
  v_mfma_f32_16x16x32_bf16 v[52:55], v[124:127], v[192:195], v[52:55]
  v_mfma_f32_16x16x32_bf16 v[56:59], v[128:131], v[192:195], v[56:59]
  v_mfma_f32_16x16x32_bf16 v[80:83], v[128:131], v[196:199], v[80:83]
  buffer_load_dwordx4 v[228:231], v32, s[20:23], s60 offen offset:3072 sc1
  v_mfma_f32_16x16x32_bf16 v[84:87], v[132:135], v[196:199], v[84:87]
  v_mfma_f32_16x16x32_bf16 v[60:63], v[132:135], v[192:195], v[60:63]
  s_waitcnt vmcnt(6) lgkmcnt(8)
  v_mfma_f32_16x16x32_bf16 v[40:43], v[88:91], v[200:203], v[40:43]
  ds_read_b64_tr_b16 v[112:113], v24 offset:6144
  ds_read_b64_tr_b16 v[114:115], v24 offset:9216
  v_mfma_f32_16x16x32_bf16 v[64:67], v[88:91], v[204:207], v[64:67]
  ds_read_b64_tr_b16 v[116:117], v25 offset:6144
  ds_read_b64_tr_b16 v[118:119], v25 offset:9216
  v_mfma_f32_16x16x32_bf16 v[68:71], v[92:95], v[204:207], v[68:71]
  ds_read_b64_tr_b16 v[120:121], v24 offset:6208
  ds_read_b64_tr_b16 v[122:123], v24 offset:9280
  v_mfma_f32_16x16x32_bf16 v[44:47], v[92:95], v[200:203], v[44:47]
  ds_read_b64_tr_b16 v[124:125], v25 offset:6208
  ds_read_b64_tr_b16 v[126:127], v25 offset:9280
  s_waitcnt lgkmcnt(12)
  v_mfma_f32_16x16x32_bf16 v[48:51], v[96:99], v[200:203], v[48:51]
  ds_read_b64_tr_b16 v[128:129], v24 offset:6272
  ds_read_b64_tr_b16 v[130:131], v24 offset:9344
  v_mfma_f32_16x16x32_bf16 v[72:75], v[96:99], v[204:207], v[72:75]
  ds_read_b64_tr_b16 v[132:133], v25 offset:6272
  ds_read_b64_tr_b16 v[134:135], v25 offset:9344
  v_mfma_f32_16x16x32_bf16 v[76:79], v[100:103], v[204:207], v[76:79]
  ds_read_b32 v10, v29
  v_mfma_f32_16x16x32_bf16 v[52:55], v[100:103], v[200:203], v[52:55]
  ds_add_u32 v30, v31
  s_waitcnt lgkmcnt(14)
  v_mfma_f32_16x16x32_bf16 v[56:59], v[104:107], v[200:203], v[56:59]
  v_mfma_f32_16x16x32_bf16 v[80:83], v[104:107], v[204:207], v[80:83]
  s_add_u32 s59, s56, 12288
  buffer_load_dwordx4 v[232:235], v32, s[20:23], s59 offen offset:0 sc1
  v_mfma_f32_16x16x32_bf16 v[84:87], v[108:111], v[204:207], v[84:87]
  s_add_u32 s60, s58, 12288
  buffer_load_dwordx4 v[236:239], v32, s[20:23], s60 offen offset:0 sc1
  v_mfma_f32_16x16x32_bf16 v[60:63], v[108:111], v[200:203], v[60:63]
  s_waitcnt vmcnt(6) lgkmcnt(10)
  v_mfma_f32_16x16x32_bf16 v[40:43], v[112:115], v[208:211], v[40:43]
  s_waitcnt lgkmcnt(1)
  v_cmp_gt_u32 vcc, 33, v10
  s_cbranch_vccnz SLOW_96
JOIN_97:
  ds_read_b64_tr_b16 v[88:89], v24 offset:12288
  ds_read_b64_tr_b16 v[90:91], v24 offset:15360
  v_mfma_f32_16x16x32_bf16 v[64:67], v[112:115], v[212:215], v[64:67]
  ds_read_b64_tr_b16 v[92:93], v25 offset:12288
  ds_read_b64_tr_b16 v[94:95], v25 offset:15360
  v_mfma_f32_16x16x32_bf16 v[68:71], v[116:119], v[212:215], v[68:71]
  ds_read_b64_tr_b16 v[96:97], v24 offset:12352
  ds_read_b64_tr_b16 v[98:99], v24 offset:15424
  v_mfma_f32_16x16x32_bf16 v[44:47], v[116:119], v[208:211], v[44:47]
  ds_read_b64_tr_b16 v[100:101], v25 offset:12352
  ds_read_b64_tr_b16 v[102:103], v25 offset:15424
  v_mfma_f32_16x16x32_bf16 v[48:51], v[120:123], v[208:211], v[48:51]
  ds_read_b64_tr_b16 v[104:105], v24 offset:12416
  ds_read_b64_tr_b16 v[106:107], v24 offset:15488
  v_mfma_f32_16x16x32_bf16 v[72:75], v[120:123], v[212:215], v[72:75]
  ds_read_b64_tr_b16 v[108:109], v25 offset:12416
  ds_read_b64_tr_b16 v[110:111], v25 offset:15488
  v_mfma_f32_16x16x32_bf16 v[76:79], v[124:127], v[212:215], v[76:79]
  buffer_load_dwordx4 v[240:243], v32, s[20:23], s59 offen offset:1024 sc1
  v_mfma_f32_16x16x32_bf16 v[52:55], v[124:127], v[208:211], v[52:55]
  v_mfma_f32_16x16x32_bf16 v[56:59], v[128:131], v[208:211], v[56:59]
  v_mfma_f32_16x16x32_bf16 v[80:83], v[128:131], v[212:215], v[80:83]
  buffer_load_dwordx4 v[244:247], v32, s[20:23], s60 offen offset:1024 sc1
  v_mfma_f32_16x16x32_bf16 v[84:87], v[132:135], v[212:215], v[84:87]
  v_mfma_f32_16x16x32_bf16 v[60:63], v[132:135], v[208:211], v[60:63]
  s_waitcnt vmcnt(6) lgkmcnt(8)
  v_mfma_f32_16x16x32_bf16 v[40:43], v[88:91], v[216:219], v[40:43]
  ds_read_b64_tr_b16 v[112:113], v24 offset:18432
  ds_read_b64_tr_b16 v[114:115], v24 offset:21504
  v_mfma_f32_16x16x32_bf16 v[64:67], v[88:91], v[220:223], v[64:67]
  ds_read_b64_tr_b16 v[116:117], v25 offset:18432
  ds_read_b64_tr_b16 v[118:119], v25 offset:21504
  v_mfma_f32_16x16x32_bf16 v[68:71], v[92:95], v[220:223], v[68:71]
  ds_read_b64_tr_b16 v[120:121], v24 offset:18496
  ds_read_b64_tr_b16 v[122:123], v24 offset:21568
  v_mfma_f32_16x16x32_bf16 v[44:47], v[92:95], v[216:219], v[44:47]
  ds_read_b64_tr_b16 v[124:125], v25 offset:18496
  ds_read_b64_tr_b16 v[126:127], v25 offset:21568
  s_waitcnt lgkmcnt(12)
  v_mfma_f32_16x16x32_bf16 v[48:51], v[96:99], v[216:219], v[48:51]
  ds_read_b64_tr_b16 v[128:129], v24 offset:18560
  ds_read_b64_tr_b16 v[130:131], v24 offset:21632
  v_mfma_f32_16x16x32_bf16 v[72:75], v[96:99], v[220:223], v[72:75]
  ds_read_b64_tr_b16 v[132:133], v25 offset:18560
  ds_read_b64_tr_b16 v[134:135], v25 offset:21632
  v_mfma_f32_16x16x32_bf16 v[76:79], v[100:103], v[220:223], v[76:79]
  ds_read_b32 v10, v29
  v_mfma_f32_16x16x32_bf16 v[52:55], v[100:103], v[216:219], v[52:55]
  ds_add_u32 v30, v31
  s_waitcnt lgkmcnt(14)
  v_mfma_f32_16x16x32_bf16 v[56:59], v[104:107], v[216:219], v[56:59]
  v_mfma_f32_16x16x32_bf16 v[80:83], v[104:107], v[220:223], v[80:83]
  buffer_load_dwordx4 v[248:251], v32, s[20:23], s59 offen offset:2048 sc1
  v_mfma_f32_16x16x32_bf16 v[84:87], v[108:111], v[220:223], v[84:87]
  buffer_load_dwordx4 v[252:255], v32, s[20:23], s60 offen offset:2048 sc1
  v_mfma_f32_16x16x32_bf16 v[60:63], v[108:111], v[216:219], v[60:63]
  s_waitcnt vmcnt(6) lgkmcnt(10)
  v_mfma_f32_16x16x32_bf16 v[40:43], v[112:115], v[224:227], v[40:43]
  s_waitcnt lgkmcnt(1)
  v_cmp_gt_u32 vcc, 34, v10
  s_cbranch_vccnz SLOW_99
JOIN_100:
  ds_read_b64_tr_b16 v[88:89], v20 offset:0
  ds_read_b64_tr_b16 v[90:91], v20 offset:3072
  v_mfma_f32_16x16x32_bf16 v[64:67], v[112:115], v[228:231], v[64:67]
  ds_read_b64_tr_b16 v[92:93], v21 offset:0
  ds_read_b64_tr_b16 v[94:95], v21 offset:3072
  v_mfma_f32_16x16x32_bf16 v[68:71], v[116:119], v[228:231], v[68:71]
  ds_read_b64_tr_b16 v[96:97], v20 offset:64
  ds_read_b64_tr_b16 v[98:99], v20 offset:3136
  v_mfma_f32_16x16x32_bf16 v[44:47], v[116:119], v[224:227], v[44:47]
  ds_read_b64_tr_b16 v[100:101], v21 offset:64
  ds_read_b64_tr_b16 v[102:103], v21 offset:3136
  v_mfma_f32_16x16x32_bf16 v[48:51], v[120:123], v[224:227], v[48:51]
  ds_read_b64_tr_b16 v[104:105], v20 offset:128
  ds_read_b64_tr_b16 v[106:107], v20 offset:3200
  v_mfma_f32_16x16x32_bf16 v[72:75], v[120:123], v[228:231], v[72:75]
  ds_read_b64_tr_b16 v[108:109], v21 offset:128
  ds_read_b64_tr_b16 v[110:111], v21 offset:3200
  v_mfma_f32_16x16x32_bf16 v[76:79], v[124:127], v[228:231], v[76:79]
  buffer_load_dwordx4 v[136:139], v32, s[20:23], s59 offen offset:3072 sc1
  v_mfma_f32_16x16x32_bf16 v[52:55], v[124:127], v[224:227], v[52:55]
  v_mfma_f32_16x16x32_bf16 v[56:59], v[128:131], v[224:227], v[56:59]
  v_mfma_f32_16x16x32_bf16 v[80:83], v[128:131], v[228:231], v[80:83]
  buffer_load_dwordx4 v[140:143], v32, s[20:23], s60 offen offset:3072 sc1
  v_mov_b32 v38, v7
  buffer_load_dwordx4 v[2:5], v38, s[24:27], s47 offen offset:0 sc1
  buffer_load_dwordx4 v[6:9], v38, s[24:27], s47 offen offset:1024 sc1
  v_mfma_f32_16x16x32_bf16 v[84:87], v[132:135], v[228:231], v[84:87]
  v_mfma_f32_16x16x32_bf16 v[60:63], v[132:135], v[224:227], v[60:63]
  s_waitcnt vmcnt(8) lgkmcnt(8)
  v_mfma_f32_16x16x32_bf16 v[40:43], v[88:91], v[232:235], v[40:43]
  ds_read_b64_tr_b16 v[112:113], v20 offset:6144
  ds_read_b64_tr_b16 v[114:115], v20 offset:9216
  v_mfma_f32_16x16x32_bf16 v[64:67], v[88:91], v[236:239], v[64:67]
  ds_read_b64_tr_b16 v[116:117], v21 offset:6144
  ds_read_b64_tr_b16 v[118:119], v21 offset:9216
  v_mfma_f32_16x16x32_bf16 v[68:71], v[92:95], v[236:239], v[68:71]
  ds_read_b64_tr_b16 v[120:121], v20 offset:6208
  ds_read_b64_tr_b16 v[122:123], v20 offset:9280
  v_mfma_f32_16x16x32_bf16 v[44:47], v[92:95], v[232:235], v[44:47]
  ds_read_b64_tr_b16 v[124:125], v21 offset:6208
  ds_read_b64_tr_b16 v[126:127], v21 offset:9280
  s_waitcnt lgkmcnt(12)
  v_mfma_f32_16x16x32_bf16 v[48:51], v[96:99], v[232:235], v[48:51]
  ds_read_b64_tr_b16 v[128:129], v20 offset:6272
  ds_read_b64_tr_b16 v[130:131], v20 offset:9344
  v_mfma_f32_16x16x32_bf16 v[72:75], v[96:99], v[236:239], v[72:75]
  ds_read_b64_tr_b16 v[132:133], v21 offset:6272
  ds_read_b64_tr_b16 v[134:135], v21 offset:9344
  v_mfma_f32_16x16x32_bf16 v[76:79], v[100:103], v[236:239], v[76:79]
  ds_read_b32 v10, v29
  v_mfma_f32_16x16x32_bf16 v[52:55], v[100:103], v[232:235], v[52:55]
  s_waitcnt lgkmcnt(13)
  v_mfma_f32_16x16x32_bf16 v[56:59], v[104:107], v[232:235], v[56:59]
  v_mfma_f32_16x16x32_bf16 v[80:83], v[104:107], v[236:239], v[80:83]
  ds_add_u32 v30, v31
  v_mfma_f32_16x16x32_bf16 v[84:87], v[108:111], v[236:239], v[84:87]
  v_mfma_f32_16x16x32_bf16 v[60:63], v[108:111], v[232:235], v[60:63]
  s_waitcnt vmcnt(6) lgkmcnt(10)
  v_mfma_f32_16x16x32_bf16 v[40:43], v[112:115], v[240:243], v[40:43]
  s_waitcnt lgkmcnt(1)
  v_cmp_gt_u32 vcc, 35, v10
  s_cbranch_vccnz SLOW_102
JOIN_103:
  ds_read_b64_tr_b16 v[88:89], v20 offset:12288
  ds_read_b64_tr_b16 v[90:91], v20 offset:15360
  v_mfma_f32_16x16x32_bf16 v[64:67], v[112:115], v[244:247], v[64:67]
  ds_read_b64_tr_b16 v[92:93], v21 offset:12288
  ds_read_b64_tr_b16 v[94:95], v21 offset:15360
  v_mfma_f32_16x16x32_bf16 v[68:71], v[116:119], v[244:247], v[68:71]
  ds_read_b64_tr_b16 v[96:97], v20 offset:12352
  ds_read_b64_tr_b16 v[98:99], v20 offset:15424
  v_mfma_f32_16x16x32_bf16 v[44:47], v[116:119], v[240:243], v[44:47]
  ds_read_b64_tr_b16 v[100:101], v21 offset:12352
  ds_read_b64_tr_b16 v[102:103], v21 offset:15424
  v_mfma_f32_16x16x32_bf16 v[48:51], v[120:123], v[240:243], v[48:51]
  ds_read_b64_tr_b16 v[104:105], v20 offset:12416
  ds_read_b64_tr_b16 v[106:107], v20 offset:15488
  v_mfma_f32_16x16x32_bf16 v[72:75], v[120:123], v[244:247], v[72:75]
  ds_read_b64_tr_b16 v[108:109], v21 offset:12416
  ds_read_b64_tr_b16 v[110:111], v21 offset:15488
  v_mfma_f32_16x16x32_bf16 v[76:79], v[124:127], v[244:247], v[76:79]
  v_mfma_f32_16x16x32_bf16 v[52:55], v[124:127], v[240:243], v[52:55]
  v_mfma_f32_16x16x32_bf16 v[56:59], v[128:131], v[240:243], v[56:59]
  v_mfma_f32_16x16x32_bf16 v[80:83], v[128:131], v[244:247], v[80:83]
  v_mfma_f32_16x16x32_bf16 v[84:87], v[132:135], v[244:247], v[84:87]
  v_mfma_f32_16x16x32_bf16 v[60:63], v[132:135], v[240:243], v[60:63]
  s_waitcnt vmcnt(4) lgkmcnt(8)
  v_mfma_f32_16x16x32_bf16 v[40:43], v[88:91], v[248:251], v[40:43]
  ds_read_b64_tr_b16 v[112:113], v20 offset:18432
  ds_read_b64_tr_b16 v[114:115], v20 offset:21504
  v_mfma_f32_16x16x32_bf16 v[64:67], v[88:91], v[252:255], v[64:67]
  ds_read_b64_tr_b16 v[116:117], v21 offset:18432
  ds_read_b64_tr_b16 v[118:119], v21 offset:21504
  v_mfma_f32_16x16x32_bf16 v[68:71], v[92:95], v[252:255], v[68:71]
  ds_read_b64_tr_b16 v[120:121], v20 offset:18496
  ds_read_b64_tr_b16 v[122:123], v20 offset:21568
  v_mfma_f32_16x16x32_bf16 v[44:47], v[92:95], v[248:251], v[44:47]
  ds_read_b64_tr_b16 v[124:125], v21 offset:18496
  ds_read_b64_tr_b16 v[126:127], v21 offset:21568
  s_waitcnt lgkmcnt(12)
  v_mfma_f32_16x16x32_bf16 v[48:51], v[96:99], v[248:251], v[48:51]
  ds_read_b64_tr_b16 v[128:129], v20 offset:18560
  ds_read_b64_tr_b16 v[130:131], v20 offset:21632
  v_mfma_f32_16x16x32_bf16 v[72:75], v[96:99], v[252:255], v[72:75]
  ds_read_b64_tr_b16 v[132:133], v21 offset:18560
  ds_read_b64_tr_b16 v[134:135], v21 offset:21632
  v_mfma_f32_16x16x32_bf16 v[76:79], v[100:103], v[252:255], v[76:79]
  ds_add_u32 v30, v31
  v_mfma_f32_16x16x32_bf16 v[52:55], v[100:103], v[248:251], v[52:55]
  s_waitcnt lgkmcnt(13)
  v_mfma_f32_16x16x32_bf16 v[56:59], v[104:107], v[248:251], v[56:59]
  v_mfma_f32_16x16x32_bf16 v[80:83], v[104:107], v[252:255], v[80:83]
SP_105:
  ds_read_b32 v10, v34 offset:256
  s_sub_u32 s13, s13, 1
  s_cbranch_scc1 ABORT
  s_waitcnt lgkmcnt(0)
  v_cmp_gt_u32 vcc, 3, v10
  s_cbranch_vccnz SP_105
  v_mfma_f32_16x16x32_bf16 v[84:87], v[108:111], v[252:255], v[84:87]
  v_mfma_f32_16x16x32_bf16 v[60:63], v[108:111], v[248:251], v[60:63]
  s_waitcnt vmcnt(2)
  v_mfma_f32_16x16x32_bf16 v[40:43], v[112:115], v[136:139], v[40:43]
  v_mfma_f32_16x16x32_bf16 v[64:67], v[112:115], v[140:143], v[64:67]
  ds_read_b128 v[152:155], v35 offset:4608
  ds_read_b128 v[176:179], v35 offset:5120
  v_mfma_f32_16x16x32_bf16 v[68:71], v[116:119], v[140:143], v[68:71]
  ds_read_b128 v[156:159], v35 offset:4672
  ds_read_b128 v[180:183], v35 offset:5184
  v_mfma_f32_16x16x32_bf16 v[44:47], v[116:119], v[136:139], v[44:47]
  v_mfma_f32_16x16x32_bf16 v[48:51], v[120:123], v[136:139], v[48:51]
  ds_read_b128 v[160:163], v35 offset:4736
  ds_read_b128 v[184:187], v35 offset:5248
  v_mfma_f32_16x16x32_bf16 v[72:75], v[120:123], v[140:143], v[72:75]
  v_mfma_f32_16x16x32_bf16 v[76:79], v[124:127], v[140:143], v[76:79]
  ds_read_b128 v[164:167], v35 offset:4800
  ds_read_b128 v[188:191], v35 offset:5312
  v_mfma_f32_16x16x32_bf16 v[52:55], v[124:127], v[136:139], v[52:55]
  v_mfma_f32_16x16x32_bf16 v[56:59], v[128:131], v[136:139], v[56:59]
  ds_read_b128 v[168:171], v35 offset:4864
  ds_read_b128 v[192:195], v35 offset:5376
  v_mfma_f32_16x16x32_bf16 v[80:83], v[128:131], v[140:143], v[80:83]
  v_mfma_f32_16x16x32_bf16 v[84:87], v[132:135], v[140:143], v[84:87]
  ds_read_b128 v[172:175], v35 offset:4928
  ds_read_b128 v[196:199], v35 offset:5440
  v_mfma_f32_16x16x32_bf16 v[60:63], v[132:135], v[136:139], v[60:63]
  s_waitcnt vmcnt(0)
  v_add_f32 v2, v2, v4
  v_add_f32 v3, v3, v5
  v_add_f32 v6, v6, v8
  v_add_f32 v7, v7, v9
  s_nop 0
  v_permlane32_swap_b32 v2, v6
  v_permlane32_swap_b32 v3, v7
  v_add_f32 v2, v2, v6
  v_add_f32 v3, v3, v7
  v_mov_b32 v6, v2
  v_mov_b32 v7, v3
  s_nop 0
  v_permlane16_swap_b32 v2, v6
  v_permlane16_swap_b32 v3, v7
  v_add_f32 v2, v2, v6
  v_add_f32 v4, v3, v7
  v_mul_f32 v2, 0x3b000000, v2
  v_mul_f32 v4, 0x3b000000, v4
  v_fma_f32 v4, -v2, v2, v4
  v_max_f32 v4, 0, v4
  v_cvt_pk_bf16_f32 v3, v2, v4
  v_and_b32 v4, 0xffff0000, v3
  v_lshlrev_b32 v2, 16, v3
  v_add_f32 v4, 0x3727c5ac, v4
  v_cvt_pk_bf16_f32 v4, v4, v4
  v_lshlrev_b32 v4, 16, v4
  v_sqrt_f32 v4, v4
  s_nop 0
  v_cvt_pk_bf16_f32 v4, v4, v4
  v_lshlrev_b32 v4, 16, v4
  v_rcp_f32 v4, v4
  s_nop 0
  v_mul_f32 v2, -v2, v4
  v_mov_b32 v6, v2
  v_mov_b32 v8, v4
  s_nop 0
  v_permlane32_swap_b32 v2, v6
  v_permlane32_swap_b32 v4, v8
  s_waitcnt lgkmcnt(0)
  s_cmp_lg_u32 s17, 1
  s_cbranch_scc1 MS_106
  v_pk_fma_f32 v[200:201], v[152:153], v[2:3], v[176:177] op_sel_hi:[1,0,1]
  v_pk_fma_f32 v[202:203], v[154:155], v[2:3], v[178:179] op_sel_hi:[1,0,1]
  v_pk_fma_f32 v[204:205], v[156:157], v[2:3], v[180:181] op_sel_hi:[1,0,1]
  v_pk_fma_f32 v[206:207], v[158:159], v[2:3], v[182:183] op_sel_hi:[1,0,1]
  v_pk_fma_f32 v[40:41], v[40:41], v[4:5], v[200:201] op_sel_hi:[1,0,1]
  v_pk_fma_f32 v[42:43], v[42:43], v[4:5], v[202:203] op_sel_hi:[1,0,1]
  v_pk_fma_f32 v[44:45], v[44:45], v[4:5], v[204:205] op_sel_hi:[1,0,1]
  v_pk_fma_f32 v[46:47], v[46:47], v[4:5], v[206:207] op_sel_hi:[1,0,1]
  v_cvt_pk_bf16_f32 v88, v40, v41
  v_cvt_pk_bf16_f32 v89, v42, v43
  v_cvt_pk_bf16_f32 v90, v44, v45
  v_cvt_pk_bf16_f32 v91, v46, v47
  v_pk_max_i16 v88, v88, 0
  v_pk_max_i16 v89, v89, 0
  v_pk_max_i16 v90, v90, 0
  v_pk_max_i16 v91, v91, 0
  buffer_store_dwordx4 v[88:91], v32, s[20:23], s46 offen offset:0 sc1
  v_pk_fma_f32 v[200:201], v[160:161], v[2:3], v[184:185] op_sel_hi:[1,0,1]
  v_pk_fma_f32 v[202:203], v[162:163], v[2:3], v[186:187] op_sel_hi:[1,0,1]
  v_pk_fma_f32 v[204:205], v[164:165], v[2:3], v[188:189] op_sel_hi:[1,0,1]
  v_pk_fma_f32 v[206:207], v[166:167], v[2:3], v[190:191] op_sel_hi:[1,0,1]
  v_pk_fma_f32 v[48:49], v[48:49], v[4:5], v[200:201] op_sel_hi:[1,0,1]
  v_pk_fma_f32 v[50:51], v[50:51], v[4:5], v[202:203] op_sel_hi:[1,0,1]
  v_pk_fma_f32 v[52:53], v[52:53], v[4:5], v[204:205] op_sel_hi:[1,0,1]
  v_pk_fma_f32 v[54:55], v[54:55], v[4:5], v[206:207] op_sel_hi:[1,0,1]
  v_cvt_pk_bf16_f32 v92, v48, v49
  v_cvt_pk_bf16_f32 v93, v50, v51
  v_cvt_pk_bf16_f32 v94, v52, v53
  v_cvt_pk_bf16_f32 v95, v54, v55
  v_pk_max_i16 v92, v92, 0
  v_pk_max_i16 v93, v93, 0
  v_pk_max_i16 v94, v94, 0
  v_pk_max_i16 v95, v95, 0
  buffer_store_dwordx4 v[92:95], v32, s[20:23], s46 offen offset:1024 sc1
  v_pk_fma_f32 v[200:201], v[168:169], v[2:3], v[192:193] op_sel_hi:[1,0,1]
  v_pk_fma_f32 v[202:203], v[170:171], v[2:3], v[194:195] op_sel_hi:[1,0,1]
  v_pk_fma_f32 v[204:205], v[172:173], v[2:3], v[196:197] op_sel_hi:[1,0,1]
  v_pk_fma_f32 v[206:207], v[174:175], v[2:3], v[198:199] op_sel_hi:[1,0,1]
  v_pk_fma_f32 v[56:57], v[56:57], v[4:5], v[200:201] op_sel_hi:[1,0,1]
  v_pk_fma_f32 v[58:59], v[58:59], v[4:5], v[202:203] op_sel_hi:[1,0,1]
  v_pk_fma_f32 v[60:61], v[60:61], v[4:5], v[204:205] op_sel_hi:[1,0,1]
  v_pk_fma_f32 v[62:63], v[62:63], v[4:5], v[206:207] op_sel_hi:[1,0,1]
  v_cvt_pk_bf16_f32 v96, v56, v57
  v_cvt_pk_bf16_f32 v97, v58, v59
  v_cvt_pk_bf16_f32 v98, v60, v61
  v_cvt_pk_bf16_f32 v99, v62, v63
  v_pk_max_i16 v96, v96, 0
  v_pk_max_i16 v97, v97, 0
  v_pk_max_i16 v98, v98, 0
  v_pk_max_i16 v99, v99, 0
  buffer_store_dwordx4 v[96:99], v32, s[20:23], s46 offen offset:2048 sc1
  v_pk_fma_f32 v[200:201], v[152:153], v[6:7], v[176:177] op_sel_hi:[1,0,1]
  v_pk_fma_f32 v[202:203], v[154:155], v[6:7], v[178:179] op_sel_hi:[1,0,1]
  v_pk_fma_f32 v[204:205], v[156:157], v[6:7], v[180:181] op_sel_hi:[1,0,1]
  v_pk_fma_f32 v[206:207], v[158:159], v[6:7], v[182:183] op_sel_hi:[1,0,1]
  v_pk_fma_f32 v[64:65], v[64:65], v[8:9], v[200:201] op_sel_hi:[1,0,1]
  v_pk_fma_f32 v[66:67], v[66:67], v[8:9], v[202:203] op_sel_hi:[1,0,1]
  v_pk_fma_f32 v[68:69], v[68:69], v[8:9], v[204:205] op_sel_hi:[1,0,1]
  v_pk_fma_f32 v[70:71], v[70:71], v[8:9], v[206:207] op_sel_hi:[1,0,1]
  v_cvt_pk_bf16_f32 v100, v64, v65
  v_cvt_pk_bf16_f32 v101, v66, v67
  v_cvt_pk_bf16_f32 v102, v68, v69
  v_cvt_pk_bf16_f32 v103, v70, v71
  v_pk_max_i16 v100, v100, 0
  v_pk_max_i16 v101, v101, 0
  v_pk_max_i16 v102, v102, 0
  v_pk_max_i16 v103, v103, 0
  buffer_store_dwordx4 v[100:103], v32, s[20:23], s48 offen offset:0 sc1
  v_pk_fma_f32 v[200:201], v[160:161], v[6:7], v[184:185] op_sel_hi:[1,0,1]
  v_pk_fma_f32 v[202:203], v[162:163], v[6:7], v[186:187] op_sel_hi:[1,0,1]
  v_pk_fma_f32 v[204:205], v[164:165], v[6:7], v[188:189] op_sel_hi:[1,0,1]
  v_pk_fma_f32 v[206:207], v[166:167], v[6:7], v[190:191] op_sel_hi:[1,0,1]
  v_pk_fma_f32 v[72:73], v[72:73], v[8:9], v[200:201] op_sel_hi:[1,0,1]
  v_pk_fma_f32 v[74:75], v[74:75], v[8:9], v[202:203] op_sel_hi:[1,0,1]
  v_pk_fma_f32 v[76:77], v[76:77], v[8:9], v[204:205] op_sel_hi:[1,0,1]
  v_pk_fma_f32 v[78:79], v[78:79], v[8:9], v[206:207] op_sel_hi:[1,0,1]
  v_cvt_pk_bf16_f32 v104, v72, v73
  v_cvt_pk_bf16_f32 v105, v74, v75
  v_cvt_pk_bf16_f32 v106, v76, v77
  v_cvt_pk_bf16_f32 v107, v78, v79
  v_pk_max_i16 v104, v104, 0
  v_pk_max_i16 v105, v105, 0
  v_pk_max_i16 v106, v106, 0
  v_pk_max_i16 v107, v107, 0
  buffer_store_dwordx4 v[104:107], v32, s[20:23], s48 offen offset:1024 sc1
  v_pk_fma_f32 v[200:201], v[168:169], v[6:7], v[192:193] op_sel_hi:[1,0,1]
  v_pk_fma_f32 v[202:203], v[170:171], v[6:7], v[194:195] op_sel_hi:[1,0,1]
  v_pk_fma_f32 v[204:205], v[172:173], v[6:7], v[196:197] op_sel_hi:[1,0,1]
  v_pk_fma_f32 v[206:207], v[174:175], v[6:7], v[198:199] op_sel_hi:[1,0,1]
  v_pk_fma_f32 v[80:81], v[80:81], v[8:9], v[200:201] op_sel_hi:[1,0,1]
  v_pk_fma_f32 v[82:83], v[82:83], v[8:9], v[202:203] op_sel_hi:[1,0,1]
  v_pk_fma_f32 v[84:85], v[84:85], v[8:9], v[204:205] op_sel_hi:[1,0,1]
  v_pk_fma_f32 v[86:87], v[86:87], v[8:9], v[206:207] op_sel_hi:[1,0,1]
  v_cvt_pk_bf16_f32 v108, v80, v81
  v_cvt_pk_bf16_f32 v109, v82, v83
  v_cvt_pk_bf16_f32 v110, v84, v85
  v_cvt_pk_bf16_f32 v111, v86, v87
  v_pk_max_i16 v108, v108, 0
  v_pk_max_i16 v109, v109, 0
  v_pk_max_i16 v110, v110, 0
  v_pk_max_i16 v111, v111, 0
  buffer_store_dwordx4 v[108:111], v32, s[20:23], s48 offen offset:2048 sc1
  s_waitcnt vmcnt(0)
  v_mov_b32 v4, s14
  v_mov_b32 v5, s15
  s_mov_b64 exec, 1
  buffer_store_dwordx2 v[4:5], v33, s[24:27], s50 offen
  s_mov_b64 exec, -1
MJ_107:
SK3_81:
  v_mov_b32 v40, 0
  v_mov_b32 v41, 0
  v_mov_b32 v42, 0
  v_mov_b32 v43, 0
  v_mov_b32 v44, 0
  v_mov_b32 v45, 0
  v_mov_b32 v46, 0
  v_mov_b32 v47, 0
  v_mov_b32 v48, 0
  v_mov_b32 v49, 0
  v_mov_b32 v50, 0
  v_mov_b32 v51, 0
  v_mov_b32 v52, 0
  v_mov_b32 v53, 0
  v_mov_b32 v54, 0
  v_mov_b32 v55, 0
  s_mov_b32 s28, s84
  s_and_b32 s29, s85, 0xffff
  s_mov_b32 s30, 0x200000
  s_mov_b32 s31, 0x00020000
  v_lshrrev_b32 v5, 2, v1
  v_lshlrev_b32 v5, 7, v5
  v_and_b32 v6, 3, v1
  v_lshl_add_u32 v5, v6, 3, v5
  v_bfe_u32 v6, v1, 3, 2
  v_lshl_add_u32 v5, v6, 5, v5
  v_xor_b32 v20, 0, v5
  v_add_u32 v21, 0x10000, v20
  v_add_u32 v22, 0x20000, v20
  v_xor_b32 v23, 32, v5
  v_add_u32 v24, 0x10000, v23
  v_add_u32 v25, 0x20000, v23
  v_xor_b32 v26, 64, v5
  v_add_u32 v27, 0x10000, v26
  v_add_u32 v28, 0x20000, v26
  v_xor_b32 v2, 96, v5
  v_add_u32 v3, 0x10000, v2
  v_add_u32 v4, 0x20000, v2
  s_mul_i32 s56, s9, 196608
  s_mul_i32 s44, s3, 49152
  s_add_u32 s56, s56, s44
  s_add_u32 s56, s56, 0x1000000
SP_108:
  ds_read_b32 v10, v34 offset:0
  s_sub_u32 s13, s13, 1
  s_cbranch_scc1 ABORT
  s_waitcnt lgkmcnt(0)
  v_cmp_gt_u32 vcc, 36, v10
  s_cbranch_vccnz SP_108
  buffer_load_dwordx4 v[120:123], v32, s[20:23], s56 offen offset:0 sc1
  buffer_load_dwordx4 v[124:127], v32, s[20:23], s56 offen offset:1024 sc1
  buffer_load_dwordx4 v[128:131], v32, s[20:23], s56 offen offset:2048 sc1
  buffer_load_dwordx4 v[132:135], v32, s[20:23], s56 offen offset:3072 sc1
  s_add_u32 s45, s56, 4096
  buffer_load_dwordx4 v[136:139], v32, s[20:23], s45 offen offset:0 sc1
  buffer_load_dwordx4 v[140:143], v32, s[20:23], s45 offen offset:1024 sc1
  buffer_load_dwordx4 v[144:147], v32, s[20:23], s45 offen offset:2048 sc1
  buffer_load_dwordx4 v[148:151], v32, s[20:23], s45 offen offset:3072 sc1
  s_add_u32 s45, s56, 8192
  buffer_load_dwordx4 v[152:155], v32, s[20:23], s45 offen offset:0 sc1
SP_109:
  ds_read_b32 v10, v29 offset:0
  s_sub_u32 s13, s13, 1
  s_cbranch_scc1 ABORT
  s_waitcnt lgkmcnt(0)
  v_cmp_gt_u32 vcc, 37, v10
  s_cbranch_vccnz SP_109
  ds_read_b64_tr_b16 v[56:57], v20 offset:24576
  ds_read_b64_tr_b16 v[58:59], v20 offset:26624
  ds_read_b64_tr_b16 v[60:61], v23 offset:24576
  ds_read_b64_tr_b16 v[62:63], v23 offset:26624
  ds_read_b64_tr_b16 v[64:65], v26 offset:24576
  ds_read_b64_tr_b16 v[66:67], v26 offset:26624
  ds_read_b64_tr_b16 v[68:69], v2 offset:24576
  ds_read_b64_tr_b16 v[70:71], v2 offset:26624
  ds_read_b64_tr_b16 v[72:73], v20 offset:28672
  ds_read_b64_tr_b16 v[74:75], v20 offset:30720
  ds_read_b64_tr_b16 v[76:77], v23 offset:28672
  ds_read_b64_tr_b16 v[78:79], v23 offset:30720
  ds_read_b64_tr_b16 v[80:81], v26 offset:28672
  ds_read_b64_tr_b16 v[82:83], v26 offset:30720
  ds_read_b64_tr_b16 v[84:85], v2 offset:28672
  ds_read_b64_tr_b16 v[86:87], v2 offset:30720
  s_waitcnt vmcnt(8) lgkmcnt(12)
  v_mfma_f32_16x16x32_bf16 v[40:43], v[56:59], v[120:123], v[40:43]
  ds_read_b64_tr_b16 v[88:89], v20 offset:32768
  ds_read_b64_tr_b16 v[90:91], v20 offset:34816
  v_mfma_f32_16x16x32_bf16 v[44:47], v[60:63], v[120:123], v[44:47]
  ds_read_b64_tr_b16 v[92:93], v23 offset:32768
  ds_read_b64_tr_b16 v[94:95], v23 offset:34816
  buffer_load_dwordx4 v[156:159], v32, s[20:23], s45 offen offset:1024 sc1
  s_waitcnt lgkmcnt(12)
  v_mfma_f32_16x16x32_bf16 v[48:51], v[64:67], v[120:123], v[48:51]
  ds_read_b64_tr_b16 v[96:97], v26 offset:32768
  ds_read_b64_tr_b16 v[98:99], v26 offset:34816
  v_mfma_f32_16x16x32_bf16 v[52:55], v[68:71], v[120:123], v[52:55]
  ds_read_b64_tr_b16 v[100:101], v2 offset:32768
  ds_read_b64_tr_b16 v[102:103], v2 offset:34816
  s_waitcnt vmcnt(8) lgkmcnt(12)
  v_mfma_f32_16x16x32_bf16 v[40:43], v[72:75], v[124:127], v[40:43]
  ds_read_b64_tr_b16 v[104:105], v20 offset:36864
  ds_read_b64_tr_b16 v[106:107], v20 offset:38912
  buffer_load_dwordx4 v[160:163], v32, s[20:23], s45 offen offset:2048 sc1
  ds_read_b32 v10, v29
  v_mfma_f32_16x16x32_bf16 v[44:47], v[76:79], v[124:127], v[44:47]
  ds_read_b64_tr_b16 v[108:109], v23 offset:36864
  ds_read_b64_tr_b16 v[110:111], v23 offset:38912
  s_waitcnt lgkmcnt(13)
  v_mfma_f32_16x16x32_bf16 v[48:51], v[80:83], v[124:127], v[48:51]
  ds_read_b64_tr_b16 v[112:113], v26 offset:36864
  ds_read_b64_tr_b16 v[114:115], v26 offset:38912
  v_mfma_f32_16x16x32_bf16 v[52:55], v[84:87], v[124:127], v[52:55]
  ds_read_b64_tr_b16 v[116:117], v2 offset:36864
  ds_read_b64_tr_b16 v[118:119], v2 offset:38912
  ds_add_u32 v30, v31
  s_waitcnt vmcnt(8) lgkmcnt(14)
  v_mfma_f32_16x16x32_bf16 v[40:43], v[88:91], v[128:131], v[40:43]
  s_waitcnt lgkmcnt(7)
  v_cmp_gt_u32 vcc, 38, v10
  s_cbranch_vccnz SLOW_110
JOIN_111:
  ds_read_b64_tr_b16 v[56:57], v20 offset:40960
  ds_read_b64_tr_b16 v[58:59], v20 offset:43008
  v_mfma_f32_16x16x32_bf16 v[44:47], v[92:95], v[128:131], v[44:47]
  ds_read_b64_tr_b16 v[60:61], v23 offset:40960
  ds_read_b64_tr_b16 v[62:63], v23 offset:43008
  buffer_load_dwordx4 v[164:167], v32, s[20:23], s45 offen offset:3072 sc1
  v_mfma_f32_16x16x32_bf16 v[48:51], v[96:99], v[128:131], v[48:51]
  ds_read_b64_tr_b16 v[64:65], v26 offset:40960
  ds_read_b64_tr_b16 v[66:67], v26 offset:43008
  v_mfma_f32_16x16x32_bf16 v[52:55], v[100:103], v[128:131], v[52:55]
  ds_read_b64_tr_b16 v[68:69], v2 offset:40960
  ds_read_b64_tr_b16 v[70:71], v2 offset:43008
  s_waitcnt vmcnt(8) lgkmcnt(13)
  v_mfma_f32_16x16x32_bf16 v[40:43], v[104:107], v[132:135], v[40:43]
  ds_read_b64_tr_b16 v[72:73], v20 offset:45056
  ds_read_b64_tr_b16 v[74:75], v20 offset:47104
  s_add_u32 s45, s56, 12288
  buffer_load_dwordx4 v[168:171], v32, s[20:23], s45 offen offset:0 sc1
  v_mfma_f32_16x16x32_bf16 v[44:47], v[108:111], v[132:135], v[44:47]
  ds_read_b64_tr_b16 v[76:77], v23 offset:45056
  ds_read_b64_tr_b16 v[78:79], v23 offset:47104
  s_waitcnt lgkmcnt(13)
  v_mfma_f32_16x16x32_bf16 v[48:51], v[112:115], v[132:135], v[48:51]
  ds_read_b64_tr_b16 v[80:81], v26 offset:45056
  ds_read_b64_tr_b16 v[82:83], v26 offset:47104
  v_mfma_f32_16x16x32_bf16 v[52:55], v[116:119], v[132:135], v[52:55]
  ds_read_b64_tr_b16 v[84:85], v2 offset:45056
  ds_read_b64_tr_b16 v[86:87], v2 offset:47104
  s_waitcnt vmcnt(8) lgkmcnt(12)
  v_mfma_f32_16x16x32_bf16 v[40:43], v[56:59], v[136:139], v[40:43]
  ds_read_b64_tr_b16 v[88:89], v20 offset:49152
  ds_read_b64_tr_b16 v[90:91], v20 offset:51200
  v_mfma_f32_16x16x32_bf16 v[44:47], v[60:63], v[136:139], v[44:47]
  ds_read_b64_tr_b16 v[92:93], v23 offset:49152
  ds_read_b64_tr_b16 v[94:95], v23 offset:51200
  buffer_load_dwordx4 v[172:175], v32, s[20:23], s45 offen offset:1024 sc1
  s_waitcnt lgkmcnt(12)
  v_mfma_f32_16x16x32_bf16 v[48:51], v[64:67], v[136:139], v[48:51]
  ds_read_b64_tr_b16 v[96:97], v26 offset:49152
  ds_read_b64_tr_b16 v[98:99], v26 offset:51200
  v_mfma_f32_16x16x32_bf16 v[52:55], v[68:71], v[136:139], v[52:55]
  ds_read_b64_tr_b16 v[100:101], v2 offset:49152
  ds_read_b64_tr_b16 v[102:103], v2 offset:51200
  s_waitcnt vmcnt(8) lgkmcnt(12)
  v_mfma_f32_16x16x32_bf16 v[40:43], v[72:75], v[140:143], v[40:43]
  ds_read_b64_tr_b16 v[104:105], v20 offset:53248
  ds_read_b64_tr_b16 v[106:107], v20 offset:55296
  buffer_load_dwordx4 v[176:179], v32, s[20:23], s45 offen offset:2048 sc1
  ds_read_b32 v10, v29
  v_mfma_f32_16x16x32_bf16 v[44:47], v[76:79], v[140:143], v[44:47]
  ds_read_b64_tr_b16 v[108:109], v23 offset:53248
  ds_read_b64_tr_b16 v[110:111], v23 offset:55296
  s_waitcnt lgkmcnt(13)
  v_mfma_f32_16x16x32_bf16 v[48:51], v[80:83], v[140:143], v[48:51]
  ds_read_b64_tr_b16 v[112:113], v26 offset:53248
  ds_read_b64_tr_b16 v[114:115], v26 offset:55296
  v_mfma_f32_16x16x32_bf16 v[52:55], v[84:87], v[140:143], v[52:55]
  ds_read_b64_tr_b16 v[116:117], v2 offset:53248
  ds_read_b64_tr_b16 v[118:119], v2 offset:55296
  ds_add_u32 v30, v31
  s_waitcnt vmcnt(8) lgkmcnt(14)
  v_mfma_f32_16x16x32_bf16 v[40:43], v[88:91], v[144:147], v[40:43]
  s_waitcnt lgkmcnt(7)
  v_cmp_gt_u32 vcc, 39, v10
  s_cbranch_vccnz SLOW_113
JOIN_114:
  ds_read_b64_tr_b16 v[56:57], v20 offset:57344
  ds_read_b64_tr_b16 v[58:59], v20 offset:59392
  v_mfma_f32_16x16x32_bf16 v[44:47], v[92:95], v[144:147], v[44:47]
  ds_read_b64_tr_b16 v[60:61], v23 offset:57344
  ds_read_b64_tr_b16 v[62:63], v23 offset:59392
  buffer_load_dwordx4 v[180:183], v32, s[20:23], s45 offen offset:3072 sc1
  v_mfma_f32_16x16x32_bf16 v[48:51], v[96:99], v[144:147], v[48:51]
  ds_read_b64_tr_b16 v[64:65], v26 offset:57344
  ds_read_b64_tr_b16 v[66:67], v26 offset:59392
  v_mfma_f32_16x16x32_bf16 v[52:55], v[100:103], v[144:147], v[52:55]
  ds_read_b64_tr_b16 v[68:69], v2 offset:57344
  ds_read_b64_tr_b16 v[70:71], v2 offset:59392
  s_waitcnt vmcnt(8) lgkmcnt(13)
  v_mfma_f32_16x16x32_bf16 v[40:43], v[104:107], v[148:151], v[40:43]
  ds_read_b64_tr_b16 v[72:73], v20 offset:61440
  ds_read_b64_tr_b16 v[74:75], v20 offset:63488
  s_add_u32 s45, s56, 16384
  buffer_load_dwordx4 v[184:187], v32, s[20:23], s45 offen offset:0 sc1
  v_mfma_f32_16x16x32_bf16 v[44:47], v[108:111], v[148:151], v[44:47]
  ds_read_b64_tr_b16 v[76:77], v23 offset:61440
  ds_read_b64_tr_b16 v[78:79], v23 offset:63488
  s_waitcnt lgkmcnt(13)
  v_mfma_f32_16x16x32_bf16 v[48:51], v[112:115], v[148:151], v[48:51]
  ds_read_b64_tr_b16 v[80:81], v26 offset:61440
  ds_read_b64_tr_b16 v[82:83], v26 offset:63488
  v_mfma_f32_16x16x32_bf16 v[52:55], v[116:119], v[148:151], v[52:55]
  ds_read_b64_tr_b16 v[84:85], v2 offset:61440
  ds_read_b64_tr_b16 v[86:87], v2 offset:63488
  s_waitcnt vmcnt(8) lgkmcnt(12)
  v_mfma_f32_16x16x32_bf16 v[40:43], v[56:59], v[152:155], v[40:43]
  ds_read_b64_tr_b16 v[88:89], v21 offset:0
  ds_read_b64_tr_b16 v[90:91], v21 offset:2048
  v_mfma_f32_16x16x32_bf16 v[44:47], v[60:63], v[152:155], v[44:47]
  ds_read_b64_tr_b16 v[92:93], v24 offset:0
  ds_read_b64_tr_b16 v[94:95], v24 offset:2048
  buffer_load_dwordx4 v[188:191], v32, s[20:23], s45 offen offset:1024 sc1
  s_waitcnt lgkmcnt(12)
  v_mfma_f32_16x16x32_bf16 v[48:51], v[64:67], v[152:155], v[48:51]
  ds_read_b64_tr_b16 v[96:97], v27 offset:0
  ds_read_b64_tr_b16 v[98:99], v27 offset:2048
  v_mfma_f32_16x16x32_bf16 v[52:55], v[68:71], v[152:155], v[52:55]
  ds_read_b64_tr_b16 v[100:101], v3 offset:0
  ds_read_b64_tr_b16 v[102:103], v3 offset:2048
  s_waitcnt vmcnt(8) lgkmcnt(12)
  v_mfma_f32_16x16x32_bf16 v[40:43], v[72:75], v[156:159], v[40:43]
  ds_read_b64_tr_b16 v[104:105], v21 offset:4096
  ds_read_b64_tr_b16 v[106:107], v21 offset:6144
  buffer_load_dwordx4 v[192:195], v32, s[20:23], s45 offen offset:2048 sc1
  ds_read_b32 v10, v29
  v_mfma_f32_16x16x32_bf16 v[44:47], v[76:79], v[156:159], v[44:47]
  ds_read_b64_tr_b16 v[108:109], v24 offset:4096
  ds_read_b64_tr_b16 v[110:111], v24 offset:6144
  s_waitcnt lgkmcnt(13)
  v_mfma_f32_16x16x32_bf16 v[48:51], v[80:83], v[156:159], v[48:51]
  ds_read_b64_tr_b16 v[112:113], v27 offset:4096
  ds_read_b64_tr_b16 v[114:115], v27 offset:6144
  v_mfma_f32_16x16x32_bf16 v[52:55], v[84:87], v[156:159], v[52:55]
  ds_read_b64_tr_b16 v[116:117], v3 offset:4096
  ds_read_b64_tr_b16 v[118:119], v3 offset:6144
  ds_add_u32 v30, v31
  s_waitcnt vmcnt(8) lgkmcnt(14)
  v_mfma_f32_16x16x32_bf16 v[40:43], v[88:91], v[160:163], v[40:43]
  s_waitcnt lgkmcnt(7)
  v_cmp_gt_u32 vcc, 40, v10
  s_cbranch_vccnz SLOW_116
JOIN_117:
  ds_read_b64_tr_b16 v[56:57], v21 offset:8192
  ds_read_b64_tr_b16 v[58:59], v21 offset:10240
  v_mfma_f32_16x16x32_bf16 v[44:47], v[92:95], v[160:163], v[44:47]
  ds_read_b64_tr_b16 v[60:61], v24 offset:8192
  ds_read_b64_tr_b16 v[62:63], v24 offset:10240
  buffer_load_dwordx4 v[196:199], v32, s[20:23], s45 offen offset:3072 sc1
  v_mfma_f32_16x16x32_bf16 v[48:51], v[96:99], v[160:163], v[48:51]
  ds_read_b64_tr_b16 v[64:65], v27 offset:8192
  ds_read_b64_tr_b16 v[66:67], v27 offset:10240
  v_mfma_f32_16x16x32_bf16 v[52:55], v[100:103], v[160:163], v[52:55]
  ds_read_b64_tr_b16 v[68:69], v3 offset:8192
  ds_read_b64_tr_b16 v[70:71], v3 offset:10240
  s_waitcnt vmcnt(8) lgkmcnt(13)
  v_mfma_f32_16x16x32_bf16 v[40:43], v[104:107], v[164:167], v[40:43]
  ds_read_b64_tr_b16 v[72:73], v21 offset:12288
  ds_read_b64_tr_b16 v[74:75], v21 offset:14336
  s_add_u32 s45, s56, 20480
  buffer_load_dwordx4 v[200:203], v32, s[20:23], s45 offen offset:0 sc1
  v_mfma_f32_16x16x32_bf16 v[44:47], v[108:111], v[164:167], v[44:47]
  ds_read_b64_tr_b16 v[76:77], v24 offset:12288
  ds_read_b64_tr_b16 v[78:79], v24 offset:14336
  s_waitcnt lgkmcnt(13)
  v_mfma_f32_16x16x32_bf16 v[48:51], v[112:115], v[164:167], v[48:51]
  ds_read_b64_tr_b16 v[80:81], v27 offset:12288
  ds_read_b64_tr_b16 v[82:83], v27 offset:14336
  v_mfma_f32_16x16x32_bf16 v[52:55], v[116:119], v[164:167], v[52:55]
  ds_read_b64_tr_b16 v[84:85], v3 offset:12288
  ds_read_b64_tr_b16 v[86:87], v3 offset:14336
  s_waitcnt vmcnt(8) lgkmcnt(12)
  v_mfma_f32_16x16x32_bf16 v[40:43], v[56:59], v[168:171], v[40:43]
  ds_read_b64_tr_b16 v[88:89], v21 offset:16384
  ds_read_b64_tr_b16 v[90:91], v21 offset:18432
  v_mfma_f32_16x16x32_bf16 v[44:47], v[60:63], v[168:171], v[44:47]
  ds_read_b64_tr_b16 v[92:93], v24 offset:16384
  ds_read_b64_tr_b16 v[94:95], v24 offset:18432
  buffer_load_dwordx4 v[204:207], v32, s[20:23], s45 offen offset:1024 sc1
  s_waitcnt lgkmcnt(12)
  v_mfma_f32_16x16x32_bf16 v[48:51], v[64:67], v[168:171], v[48:51]
  ds_read_b64_tr_b16 v[96:97], v27 offset:16384
  ds_read_b64_tr_b16 v[98:99], v27 offset:18432
  v_mfma_f32_16x16x32_bf16 v[52:55], v[68:71], v[168:171], v[52:55]
  ds_read_b64_tr_b16 v[100:101], v3 offset:16384
  ds_read_b64_tr_b16 v[102:103], v3 offset:18432
  s_waitcnt vmcnt(8) lgkmcnt(12)
  v_mfma_f32_16x16x32_bf16 v[40:43], v[72:75], v[172:175], v[40:43]
  ds_read_b64_tr_b16 v[104:105], v21 offset:20480
  ds_read_b64_tr_b16 v[106:107], v21 offset:22528
  buffer_load_dwordx4 v[208:211], v32, s[20:23], s45 offen offset:2048 sc1
  ds_read_b32 v10, v29
  v_mfma_f32_16x16x32_bf16 v[44:47], v[76:79], v[172:175], v[44:47]
  ds_read_b64_tr_b16 v[108:109], v24 offset:20480
  ds_read_b64_tr_b16 v[110:111], v24 offset:22528
  s_waitcnt lgkmcnt(13)
  v_mfma_f32_16x16x32_bf16 v[48:51], v[80:83], v[172:175], v[48:51]
  ds_read_b64_tr_b16 v[112:113], v27 offset:20480
  ds_read_b64_tr_b16 v[114:115], v27 offset:22528
  v_mfma_f32_16x16x32_bf16 v[52:55], v[84:87], v[172:175], v[52:55]
  ds_read_b64_tr_b16 v[116:117], v3 offset:20480
  ds_read_b64_tr_b16 v[118:119], v3 offset:22528
  ds_add_u32 v30, v31
  s_waitcnt vmcnt(8) lgkmcnt(14)
  v_mfma_f32_16x16x32_bf16 v[40:43], v[88:91], v[176:179], v[40:43]
  s_waitcnt lgkmcnt(7)
  v_cmp_gt_u32 vcc, 41, v10
  s_cbranch_vccnz SLOW_119
JOIN_120:
  ds_read_b64_tr_b16 v[56:57], v21 offset:24576
  ds_read_b64_tr_b16 v[58:59], v21 offset:26624
  v_mfma_f32_16x16x32_bf16 v[44:47], v[92:95], v[176:179], v[44:47]
  ds_read_b64_tr_b16 v[60:61], v24 offset:24576
  ds_read_b64_tr_b16 v[62:63], v24 offset:26624
  buffer_load_dwordx4 v[212:215], v32, s[20:23], s45 offen offset:3072 sc1
  v_mfma_f32_16x16x32_bf16 v[48:51], v[96:99], v[176:179], v[48:51]
  ds_read_b64_tr_b16 v[64:65], v27 offset:24576
  ds_read_b64_tr_b16 v[66:67], v27 offset:26624
  v_mfma_f32_16x16x32_bf16 v[52:55], v[100:103], v[176:179], v[52:55]
  ds_read_b64_tr_b16 v[68:69], v3 offset:24576
  ds_read_b64_tr_b16 v[70:71], v3 offset:26624
  s_waitcnt vmcnt(8) lgkmcnt(13)
  v_mfma_f32_16x16x32_bf16 v[40:43], v[104:107], v[180:183], v[40:43]
  ds_read_b64_tr_b16 v[72:73], v21 offset:28672
  ds_read_b64_tr_b16 v[74:75], v21 offset:30720
  s_add_u32 s45, s56, 24576
  buffer_load_dwordx4 v[216:219], v32, s[20:23], s45 offen offset:0 sc1
  v_mfma_f32_16x16x32_bf16 v[44:47], v[108:111], v[180:183], v[44:47]
  ds_read_b64_tr_b16 v[76:77], v24 offset:28672
  ds_read_b64_tr_b16 v[78:79], v24 offset:30720
  s_waitcnt lgkmcnt(13)
  v_mfma_f32_16x16x32_bf16 v[48:51], v[112:115], v[180:183], v[48:51]
  ds_read_b64_tr_b16 v[80:81], v27 offset:28672
  ds_read_b64_tr_b16 v[82:83], v27 offset:30720
  v_mfma_f32_16x16x32_bf16 v[52:55], v[116:119], v[180:183], v[52:55]
  ds_read_b64_tr_b16 v[84:85], v3 offset:28672
  ds_read_b64_tr_b16 v[86:87], v3 offset:30720
  s_waitcnt vmcnt(8) lgkmcnt(12)
  v_mfma_f32_16x16x32_bf16 v[40:43], v[56:59], v[184:187], v[40:43]
  ds_read_b64_tr_b16 v[88:89], v21 offset:32768
  ds_read_b64_tr_b16 v[90:91], v21 offset:34816
  v_mfma_f32_16x16x32_bf16 v[44:47], v[60:63], v[184:187], v[44:47]
  ds_read_b64_tr_b16 v[92:93], v24 offset:32768
  ds_read_b64_tr_b16 v[94:95], v24 offset:34816
  buffer_load_dwordx4 v[220:223], v32, s[20:23], s45 offen offset:1024 sc1
  s_waitcnt lgkmcnt(12)
  v_mfma_f32_16x16x32_bf16 v[48:51], v[64:67], v[184:187], v[48:51]
  ds_read_b64_tr_b16 v[96:97], v27 offset:32768
  ds_read_b64_tr_b16 v[98:99], v27 offset:34816
  v_mfma_f32_16x16x32_bf16 v[52:55], v[68:71], v[184:187], v[52:55]
  ds_read_b64_tr_b16 v[100:101], v3 offset:32768
  ds_read_b64_tr_b16 v[102:103], v3 offset:34816
  s_waitcnt vmcnt(8) lgkmcnt(12)
  v_mfma_f32_16x16x32_bf16 v[40:43], v[72:75], v[188:191], v[40:43]
  ds_read_b64_tr_b16 v[104:105], v21 offset:36864
  ds_read_b64_tr_b16 v[106:107], v21 offset:38912
  buffer_load_dwordx4 v[224:227], v32, s[20:23], s45 offen offset:2048 sc1
  ds_read_b32 v10, v29
  v_mfma_f32_16x16x32_bf16 v[44:47], v[76:79], v[188:191], v[44:47]
  ds_read_b64_tr_b16 v[108:109], v24 offset:36864
  ds_read_b64_tr_b16 v[110:111], v24 offset:38912
  s_waitcnt lgkmcnt(13)
  v_mfma_f32_16x16x32_bf16 v[48:51], v[80:83], v[188:191], v[48:51]
  ds_read_b64_tr_b16 v[112:113], v27 offset:36864
  ds_read_b64_tr_b16 v[114:115], v27 offset:38912
  v_mfma_f32_16x16x32_bf16 v[52:55], v[84:87], v[188:191], v[52:55]
  ds_read_b64_tr_b16 v[116:117], v3 offset:36864
  ds_read_b64_tr_b16 v[118:119], v3 offset:38912
  ds_add_u32 v30, v31
  s_waitcnt vmcnt(8) lgkmcnt(14)
  v_mfma_f32_16x16x32_bf16 v[40:43], v[88:91], v[192:195], v[40:43]
  s_waitcnt lgkmcnt(7)
  v_cmp_gt_u32 vcc, 42, v10
  s_cbranch_vccnz SLOW_122
JOIN_123:
  ds_read_b64_tr_b16 v[56:57], v21 offset:40960
  ds_read_b64_tr_b16 v[58:59], v21 offset:43008
  v_mfma_f32_16x16x32_bf16 v[44:47], v[92:95], v[192:195], v[44:47]
  ds_read_b64_tr_b16 v[60:61], v24 offset:40960
  ds_read_b64_tr_b16 v[62:63], v24 offset:43008
  buffer_load_dwordx4 v[228:231], v32, s[20:23], s45 offen offset:3072 sc1
  v_mfma_f32_16x16x32_bf16 v[48:51], v[96:99], v[192:195], v[48:51]
  ds_read_b64_tr_b16 v[64:65], v27 offset:40960
  ds_read_b64_tr_b16 v[66:67], v27 offset:43008
  v_mfma_f32_16x16x32_bf16 v[52:55], v[100:103], v[192:195], v[52:55]
  ds_read_b64_tr_b16 v[68:69], v3 offset:40960
  ds_read_b64_tr_b16 v[70:71], v3 offset:43008
  s_waitcnt vmcnt(8) lgkmcnt(13)
  v_mfma_f32_16x16x32_bf16 v[40:43], v[104:107], v[196:199], v[40:43]
  ds_read_b64_tr_b16 v[72:73], v21 offset:45056
  ds_read_b64_tr_b16 v[74:75], v21 offset:47104
  s_add_u32 s45, s56, 28672
  buffer_load_dwordx4 v[232:235], v32, s[20:23], s45 offen offset:0 sc1
  v_mfma_f32_16x16x32_bf16 v[44:47], v[108:111], v[196:199], v[44:47]
  ds_read_b64_tr_b16 v[76:77], v24 offset:45056
  ds_read_b64_tr_b16 v[78:79], v24 offset:47104
  s_waitcnt lgkmcnt(13)
  v_mfma_f32_16x16x32_bf16 v[48:51], v[112:115], v[196:199], v[48:51]
  ds_read_b64_tr_b16 v[80:81], v27 offset:45056
  ds_read_b64_tr_b16 v[82:83], v27 offset:47104
  v_mfma_f32_16x16x32_bf16 v[52:55], v[116:119], v[196:199], v[52:55]
  ds_read_b64_tr_b16 v[84:85], v3 offset:45056
  ds_read_b64_tr_b16 v[86:87], v3 offset:47104
  s_waitcnt vmcnt(8) lgkmcnt(12)
  v_mfma_f32_16x16x32_bf16 v[40:43], v[56:59], v[200:203], v[40:43]
  ds_read_b64_tr_b16 v[88:89], v21 offset:49152
  ds_read_b64_tr_b16 v[90:91], v21 offset:51200
  v_mfma_f32_16x16x32_bf16 v[44:47], v[60:63], v[200:203], v[44:47]
  ds_read_b64_tr_b16 v[92:93], v24 offset:49152
  ds_read_b64_tr_b16 v[94:95], v24 offset:51200
  buffer_load_dwordx4 v[236:239], v32, s[20:23], s45 offen offset:1024 sc1
  s_waitcnt lgkmcnt(12)
  v_mfma_f32_16x16x32_bf16 v[48:51], v[64:67], v[200:203], v[48:51]
  ds_read_b64_tr_b16 v[96:97], v27 offset:49152
  ds_read_b64_tr_b16 v[98:99], v27 offset:51200
  v_mfma_f32_16x16x32_bf16 v[52:55], v[68:71], v[200:203], v[52:55]
  ds_read_b64_tr_b16 v[100:101], v3 offset:49152
  ds_read_b64_tr_b16 v[102:103], v3 offset:51200
  s_waitcnt vmcnt(8) lgkmcnt(12)
  v_mfma_f32_16x16x32_bf16 v[40:43], v[72:75], v[204:207], v[40:43]
  ds_read_b64_tr_b16 v[104:105], v21 offset:53248
  ds_read_b64_tr_b16 v[106:107], v21 offset:55296
  buffer_load_dwordx4 v[240:243], v32, s[20:23], s45 offen offset:2048 sc1
  ds_read_b32 v10, v29
  v_mfma_f32_16x16x32_bf16 v[44:47], v[76:79], v[204:207], v[44:47]
  ds_read_b64_tr_b16 v[108:109], v24 offset:53248
  ds_read_b64_tr_b16 v[110:111], v24 offset:55296
  s_waitcnt lgkmcnt(13)
  v_mfma_f32_16x16x32_bf16 v[48:51], v[80:83], v[204:207], v[48:51]
  ds_read_b64_tr_b16 v[112:113], v27 offset:53248
  ds_read_b64_tr_b16 v[114:115], v27 offset:55296
  v_mfma_f32_16x16x32_bf16 v[52:55], v[84:87], v[204:207], v[52:55]
  ds_read_b64_tr_b16 v[116:117], v3 offset:53248
  ds_read_b64_tr_b16 v[118:119], v3 offset:55296
  ds_add_u32 v30, v31
  s_waitcnt vmcnt(8) lgkmcnt(14)
  v_mfma_f32_16x16x32_bf16 v[40:43], v[88:91], v[208:211], v[40:43]
  s_waitcnt lgkmcnt(7)
  v_cmp_gt_u32 vcc, 43, v10
  s_cbranch_vccnz SLOW_125
JOIN_126:
  ds_read_b64_tr_b16 v[56:57], v21 offset:57344
  ds_read_b64_tr_b16 v[58:59], v21 offset:59392
  v_mfma_f32_16x16x32_bf16 v[44:47], v[92:95], v[208:211], v[44:47]
  ds_read_b64_tr_b16 v[60:61], v24 offset:57344
  ds_read_b64_tr_b16 v[62:63], v24 offset:59392
  buffer_load_dwordx4 v[244:247], v32, s[20:23], s45 offen offset:3072 sc1
  v_mfma_f32_16x16x32_bf16 v[48:51], v[96:99], v[208:211], v[48:51]
  ds_read_b64_tr_b16 v[64:65], v27 offset:57344
  ds_read_b64_tr_b16 v[66:67], v27 offset:59392
  v_mfma_f32_16x16x32_bf16 v[52:55], v[100:103], v[208:211], v[52:55]
  ds_read_b64_tr_b16 v[68:69], v3 offset:57344
  ds_read_b64_tr_b16 v[70:71], v3 offset:59392
  s_waitcnt vmcnt(8) lgkmcnt(13)
  v_mfma_f32_16x16x32_bf16 v[40:43], v[104:107], v[212:215], v[40:43]
  ds_read_b64_tr_b16 v[72:73], v21 offset:61440
  ds_read_b64_tr_b16 v[74:75], v21 offset:63488
  s_add_u32 s45, s56, 32768
  buffer_load_dwordx4 v[248:251], v32, s[20:23], s45 offen offset:0 sc1
  v_mfma_f32_16x16x32_bf16 v[44:47], v[108:111], v[212:215], v[44:47]
  ds_read_b64_tr_b16 v[76:77], v24 offset:61440
  ds_read_b64_tr_b16 v[78:79], v24 offset:63488
  s_waitcnt lgkmcnt(13)
  v_mfma_f32_16x16x32_bf16 v[48:51], v[112:115], v[212:215], v[48:51]
  ds_read_b64_tr_b16 v[80:81], v27 offset:61440
  ds_read_b64_tr_b16 v[82:83], v27 offset:63488
  v_mfma_f32_16x16x32_bf16 v[52:55], v[116:119], v[212:215], v[52:55]
  ds_read_b64_tr_b16 v[84:85], v3 offset:61440
  ds_read_b64_tr_b16 v[86:87], v3 offset:63488
  s_waitcnt vmcnt(8) lgkmcnt(12)
  v_mfma_f32_16x16x32_bf16 v[40:43], v[56:59], v[216:219], v[40:43]
  ds_read_b64_tr_b16 v[88:89], v22 offset:0
  ds_read_b64_tr_b16 v[90:91], v22 offset:2048
  v_mfma_f32_16x16x32_bf16 v[44:47], v[60:63], v[216:219], v[44:47]
  ds_read_b64_tr_b16 v[92:93], v25 offset:0
  ds_read_b64_tr_b16 v[94:95], v25 offset:2048
  buffer_load_dwordx4 v[252:255], v32, s[20:23], s45 offen offset:1024 sc1
  s_waitcnt lgkmcnt(12)
  v_mfma_f32_16x16x32_bf16 v[48:51], v[64:67], v[216:219], v[48:51]
  ds_read_b64_tr_b16 v[96:97], v28 offset:0
  ds_read_b64_tr_b16 v[98:99], v28 offset:2048
  v_mfma_f32_16x16x32_bf16 v[52:55], v[68:71], v[216:219], v[52:55]
  ds_read_b64_tr_b16 v[100:101], v4 offset:0
  ds_read_b64_tr_b16 v[102:103], v4 offset:2048
  s_waitcnt vmcnt(8) lgkmcnt(12)
  v_mfma_f32_16x16x32_bf16 v[40:43], v[72:75], v[220:223], v[40:43]
  ds_read_b64_tr_b16 v[104:105], v22 offset:4096
  ds_read_b64_tr_b16 v[106:107], v22 offset:6144
  buffer_load_dwordx4 v[120:123], v32, s[20:23], s45 offen offset:2048 sc1
  ds_read_b32 v10, v29
  v_mfma_f32_16x16x32_bf16 v[44:47], v[76:79], v[220:223], v[44:47]
  ds_read_b64_tr_b16 v[108:109], v25 offset:4096
  ds_read_b64_tr_b16 v[110:111], v25 offset:6144
  s_waitcnt lgkmcnt(13)
  v_mfma_f32_16x16x32_bf16 v[48:51], v[80:83], v[220:223], v[48:51]
  ds_read_b64_tr_b16 v[112:113], v28 offset:4096
  ds_read_b64_tr_b16 v[114:115], v28 offset:6144
  v_mfma_f32_16x16x32_bf16 v[52:55], v[84:87], v[220:223], v[52:55]
  ds_read_b64_tr_b16 v[116:117], v4 offset:4096
  ds_read_b64_tr_b16 v[118:119], v4 offset:6144
  ds_add_u32 v30, v31
  s_waitcnt vmcnt(8) lgkmcnt(14)
  v_mfma_f32_16x16x32_bf16 v[40:43], v[88:91], v[224:227], v[40:43]
  s_waitcnt lgkmcnt(7)
  v_cmp_gt_u32 vcc, 44, v10
  s_cbranch_vccnz SLOW_128
JOIN_129:
  ds_read_b64_tr_b16 v[56:57], v22 offset:8192
  ds_read_b64_tr_b16 v[58:59], v22 offset:10240
  v_mfma_f32_16x16x32_bf16 v[44:47], v[92:95], v[224:227], v[44:47]
  ds_read_b64_tr_b16 v[60:61], v25 offset:8192
  ds_read_b64_tr_b16 v[62:63], v25 offset:10240
  buffer_load_dwordx4 v[124:127], v32, s[20:23], s45 offen offset:3072 sc1
  v_mfma_f32_16x16x32_bf16 v[48:51], v[96:99], v[224:227], v[48:51]
  ds_read_b64_tr_b16 v[64:65], v28 offset:8192
  ds_read_b64_tr_b16 v[66:67], v28 offset:10240
  v_mfma_f32_16x16x32_bf16 v[52:55], v[100:103], v[224:227], v[52:55]
  ds_read_b64_tr_b16 v[68:69], v4 offset:8192
  ds_read_b64_tr_b16 v[70:71], v4 offset:10240
  s_waitcnt vmcnt(8) lgkmcnt(13)
  v_mfma_f32_16x16x32_bf16 v[40:43], v[104:107], v[228:231], v[40:43]
  ds_read_b64_tr_b16 v[72:73], v22 offset:12288
  ds_read_b64_tr_b16 v[74:75], v22 offset:14336
  s_add_u32 s45, s56, 36864
  buffer_load_dwordx4 v[128:131], v32, s[20:23], s45 offen offset:0 sc1
  v_mfma_f32_16x16x32_bf16 v[44:47], v[108:111], v[228:231], v[44:47]
  ds_read_b64_tr_b16 v[76:77], v25 offset:12288
  ds_read_b64_tr_b16 v[78:79], v25 offset:14336
  s_waitcnt lgkmcnt(13)
  v_mfma_f32_16x16x32_bf16 v[48:51], v[112:115], v[228:231], v[48:51]
  ds_read_b64_tr_b16 v[80:81], v28 offset:12288
  ds_read_b64_tr_b16 v[82:83], v28 offset:14336
  v_mfma_f32_16x16x32_bf16 v[52:55], v[116:119], v[228:231], v[52:55]
  ds_read_b64_tr_b16 v[84:85], v4 offset:12288
  ds_read_b64_tr_b16 v[86:87], v4 offset:14336
  s_waitcnt vmcnt(8) lgkmcnt(12)
  v_mfma_f32_16x16x32_bf16 v[40:43], v[56:59], v[232:235], v[40:43]
  ds_read_b64_tr_b16 v[88:89], v22 offset:16384
  ds_read_b64_tr_b16 v[90:91], v22 offset:18432
  v_mfma_f32_16x16x32_bf16 v[44:47], v[60:63], v[232:235], v[44:47]
  ds_read_b64_tr_b16 v[92:93], v25 offset:16384
  ds_read_b64_tr_b16 v[94:95], v25 offset:18432
  buffer_load_dwordx4 v[132:135], v32, s[20:23], s45 offen offset:1024 sc1
  s_waitcnt lgkmcnt(12)
  v_mfma_f32_16x16x32_bf16 v[48:51], v[64:67], v[232:235], v[48:51]
  ds_read_b64_tr_b16 v[96:97], v28 offset:16384
  ds_read_b64_tr_b16 v[98:99], v28 offset:18432
  v_mfma_f32_16x16x32_bf16 v[52:55], v[68:71], v[232:235], v[52:55]
  ds_read_b64_tr_b16 v[100:101], v4 offset:16384
  ds_read_b64_tr_b16 v[102:103], v4 offset:18432
  s_waitcnt vmcnt(8) lgkmcnt(12)
  v_mfma_f32_16x16x32_bf16 v[40:43], v[72:75], v[236:239], v[40:43]
  ds_read_b64_tr_b16 v[104:105], v22 offset:20480
  ds_read_b64_tr_b16 v[106:107], v22 offset:22528
  buffer_load_dwordx4 v[136:139], v32, s[20:23], s45 offen offset:2048 sc1
  ds_read_b32 v10, v29
  v_mfma_f32_16x16x32_bf16 v[44:47], v[76:79], v[236:239], v[44:47]
  ds_read_b64_tr_b16 v[108:109], v25 offset:20480
  ds_read_b64_tr_b16 v[110:111], v25 offset:22528
  s_waitcnt lgkmcnt(13)
  v_mfma_f32_16x16x32_bf16 v[48:51], v[80:83], v[236:239], v[48:51]
  ds_read_b64_tr_b16 v[112:113], v28 offset:20480
  ds_read_b64_tr_b16 v[114:115], v28 offset:22528
  v_mfma_f32_16x16x32_bf16 v[52:55], v[84:87], v[236:239], v[52:55]
  ds_read_b64_tr_b16 v[116:117], v4 offset:20480
  ds_read_b64_tr_b16 v[118:119], v4 offset:22528
  ds_add_u32 v30, v31
  s_waitcnt vmcnt(8) lgkmcnt(14)
  v_mfma_f32_16x16x32_bf16 v[40:43], v[88:91], v[240:243], v[40:43]
  s_waitcnt lgkmcnt(7)
  v_cmp_gt_u32 vcc, 45, v10
  s_cbranch_vccnz SLOW_131
JOIN_132:
  ds_read_b64_tr_b16 v[56:57], v20 offset:0
  ds_read_b64_tr_b16 v[58:59], v20 offset:2048
  v_mfma_f32_16x16x32_bf16 v[44:47], v[92:95], v[240:243], v[44:47]
  ds_read_b64_tr_b16 v[60:61], v23 offset:0
  ds_read_b64_tr_b16 v[62:63], v23 offset:2048
  buffer_load_dwordx4 v[140:143], v32, s[20:23], s45 offen offset:3072 sc1
  v_mfma_f32_16x16x32_bf16 v[48:51], v[96:99], v[240:243], v[48:51]
  ds_read_b64_tr_b16 v[64:65], v26 offset:0
  ds_read_b64_tr_b16 v[66:67], v26 offset:2048
  v_mfma_f32_16x16x32_bf16 v[52:55], v[100:103], v[240:243], v[52:55]
  ds_read_b64_tr_b16 v[68:69], v2 offset:0
  ds_read_b64_tr_b16 v[70:71], v2 offset:2048
  s_waitcnt vmcnt(8) lgkmcnt(13)
  v_mfma_f32_16x16x32_bf16 v[40:43], v[104:107], v[244:247], v[40:43]
  ds_read_b64_tr_b16 v[72:73], v20 offset:4096
  ds_read_b64_tr_b16 v[74:75], v20 offset:6144
  s_add_u32 s45, s56, 40960
  buffer_load_dwordx4 v[144:147], v32, s[20:23], s45 offen offset:0 sc1
  v_mfma_f32_16x16x32_bf16 v[44:47], v[108:111], v[244:247], v[44:47]
  ds_read_b64_tr_b16 v[76:77], v23 offset:4096
  ds_read_b64_tr_b16 v[78:79], v23 offset:6144
  s_waitcnt lgkmcnt(13)
  v_mfma_f32_16x16x32_bf16 v[48:51], v[112:115], v[244:247], v[48:51]
  ds_read_b64_tr_b16 v[80:81], v26 offset:4096
  ds_read_b64_tr_b16 v[82:83], v26 offset:6144
  v_mfma_f32_16x16x32_bf16 v[52:55], v[116:119], v[244:247], v[52:55]
  ds_read_b64_tr_b16 v[84:85], v2 offset:4096
  ds_read_b64_tr_b16 v[86:87], v2 offset:6144
  s_waitcnt vmcnt(8) lgkmcnt(12)
  v_mfma_f32_16x16x32_bf16 v[40:43], v[56:59], v[248:251], v[40:43]
  ds_read_b64_tr_b16 v[88:89], v20 offset:8192
  ds_read_b64_tr_b16 v[90:91], v20 offset:10240
  v_mfma_f32_16x16x32_bf16 v[44:47], v[60:63], v[248:251], v[44:47]
  ds_read_b64_tr_b16 v[92:93], v23 offset:8192
  ds_read_b64_tr_b16 v[94:95], v23 offset:10240
  buffer_load_dwordx4 v[148:151], v32, s[20:23], s45 offen offset:1024 sc1
  s_waitcnt lgkmcnt(12)
  v_mfma_f32_16x16x32_bf16 v[48:51], v[64:67], v[248:251], v[48:51]
  ds_read_b64_tr_b16 v[96:97], v26 offset:8192
  ds_read_b64_tr_b16 v[98:99], v26 offset:10240
  v_mfma_f32_16x16x32_bf16 v[52:55], v[68:71], v[248:251], v[52:55]
  ds_read_b64_tr_b16 v[100:101], v2 offset:8192
  ds_read_b64_tr_b16 v[102:103], v2 offset:10240
  s_waitcnt vmcnt(8) lgkmcnt(12)
  v_mfma_f32_16x16x32_bf16 v[40:43], v[72:75], v[252:255], v[40:43]
  ds_read_b64_tr_b16 v[104:105], v20 offset:12288
  ds_read_b64_tr_b16 v[106:107], v20 offset:14336
  buffer_load_dwordx4 v[152:155], v32, s[20:23], s45 offen offset:2048 sc1
  ds_read_b32 v10, v29
  v_mfma_f32_16x16x32_bf16 v[44:47], v[76:79], v[252:255], v[44:47]
  ds_read_b64_tr_b16 v[108:109], v23 offset:12288
  ds_read_b64_tr_b16 v[110:111], v23 offset:14336
  s_waitcnt lgkmcnt(13)
  v_mfma_f32_16x16x32_bf16 v[48:51], v[80:83], v[252:255], v[48:51]
  ds_read_b64_tr_b16 v[112:113], v26 offset:12288
  ds_read_b64_tr_b16 v[114:115], v26 offset:14336
  v_mfma_f32_16x16x32_bf16 v[52:55], v[84:87], v[252:255], v[52:55]
  ds_read_b64_tr_b16 v[116:117], v2 offset:12288
  ds_read_b64_tr_b16 v[118:119], v2 offset:14336
  ds_add_u32 v30, v31
  s_waitcnt vmcnt(8) lgkmcnt(14)
  v_mfma_f32_16x16x32_bf16 v[40:43], v[88:91], v[120:123], v[40:43]
  s_waitcnt lgkmcnt(7)
  v_cmp_gt_u32 vcc, 46, v10
  s_cbranch_vccnz SLOW_134
JOIN_135:
  ds_read_b64_tr_b16 v[56:57], v20 offset:16384
  ds_read_b64_tr_b16 v[58:59], v20 offset:18432
  v_mfma_f32_16x16x32_bf16 v[44:47], v[92:95], v[120:123], v[44:47]
  ds_read_b64_tr_b16 v[60:61], v23 offset:16384
  ds_read_b64_tr_b16 v[62:63], v23 offset:18432
  v_mfma_f32_16x16x32_bf16 v[48:51], v[96:99], v[120:123], v[48:51]
  ds_read_b64_tr_b16 v[64:65], v26 offset:16384
  ds_read_b64_tr_b16 v[66:67], v26 offset:18432
  v_mfma_f32_16x16x32_bf16 v[52:55], v[100:103], v[120:123], v[52:55]
  ds_read_b64_tr_b16 v[68:69], v2 offset:16384
  ds_read_b64_tr_b16 v[70:71], v2 offset:18432
  s_waitcnt vmcnt(7) lgkmcnt(13)
  v_mfma_f32_16x16x32_bf16 v[40:43], v[104:107], v[124:127], v[40:43]
  ds_read_b64_tr_b16 v[72:73], v20 offset:20480
  ds_read_b64_tr_b16 v[74:75], v20 offset:22528
  v_mfma_f32_16x16x32_bf16 v[44:47], v[108:111], v[124:127], v[44:47]
  ds_read_b64_tr_b16 v[76:77], v23 offset:20480
  ds_read_b64_tr_b16 v[78:79], v23 offset:22528
  s_waitcnt lgkmcnt(13)
  v_mfma_f32_16x16x32_bf16 v[48:51], v[112:115], v[124:127], v[48:51]
  ds_read_b64_tr_b16 v[80:81], v26 offset:20480
  ds_read_b64_tr_b16 v[82:83], v26 offset:22528
  v_mfma_f32_16x16x32_bf16 v[52:55], v[116:119], v[124:127], v[52:55]
  ds_read_b64_tr_b16 v[84:85], v2 offset:20480
  ds_read_b64_tr_b16 v[86:87], v2 offset:22528
  s_waitcnt vmcnt(6) lgkmcnt(12)
  v_mfma_f32_16x16x32_bf16 v[40:43], v[56:59], v[128:131], v[40:43]
  ds_read_b64_tr_b16 v[88:89], v20 offset:24576
  ds_read_b64_tr_b16 v[90:91], v20 offset:26624
  v_mfma_f32_16x16x32_bf16 v[44:47], v[60:63], v[128:131], v[44:47]
  ds_read_b64_tr_b16 v[92:93], v23 offset:24576
  ds_read_b64_tr_b16 v[94:95], v23 offset:26624
  s_waitcnt lgkmcnt(12)
  v_mfma_f32_16x16x32_bf16 v[48:51], v[64:67], v[128:131], v[48:51]
  ds_read_b64_tr_b16 v[96:97], v26 offset:24576
  ds_read_b64_tr_b16 v[98:99], v26 offset:26624
  v_mfma_f32_16x16x32_bf16 v[52:55], v[68:71], v[128:131], v[52:55]
  ds_read_b64_tr_b16 v[100:101], v2 offset:24576
  ds_read_b64_tr_b16 v[102:103], v2 offset:26624
  s_waitcnt vmcnt(5) lgkmcnt(12)
  v_mfma_f32_16x16x32_bf16 v[40:43], v[72:75], v[132:135], v[40:43]
  ds_read_b64_tr_b16 v[104:105], v20 offset:28672
  ds_read_b64_tr_b16 v[106:107], v20 offset:30720
  ds_read_b32 v10, v29
  v_mfma_f32_16x16x32_bf16 v[44:47], v[76:79], v[132:135], v[44:47]
  ds_read_b64_tr_b16 v[108:109], v23 offset:28672
  ds_read_b64_tr_b16 v[110:111], v23 offset:30720
  s_waitcnt lgkmcnt(13)
  v_mfma_f32_16x16x32_bf16 v[48:51], v[80:83], v[132:135], v[48:51]
  ds_read_b64_tr_b16 v[112:113], v26 offset:28672
  ds_read_b64_tr_b16 v[114:115], v26 offset:30720
  v_mfma_f32_16x16x32_bf16 v[52:55], v[84:87], v[132:135], v[52:55]
  ds_read_b64_tr_b16 v[116:117], v2 offset:28672
  ds_read_b64_tr_b16 v[118:119], v2 offset:30720
  ds_add_u32 v30, v31
  s_waitcnt vmcnt(4) lgkmcnt(14)
  v_mfma_f32_16x16x32_bf16 v[40:43], v[88:91], v[136:139], v[40:43]
  s_waitcnt lgkmcnt(7)
  v_cmp_gt_u32 vcc, 47, v10
  s_cbranch_vccnz SLOW_137
JOIN_138:
  ds_read_b64_tr_b16 v[56:57], v20 offset:32768
  ds_read_b64_tr_b16 v[58:59], v20 offset:34816
  v_mfma_f32_16x16x32_bf16 v[44:47], v[92:95], v[136:139], v[44:47]
  ds_read_b64_tr_b16 v[60:61], v23 offset:32768
  ds_read_b64_tr_b16 v[62:63], v23 offset:34816
  v_lshlrev_b32 v184, 16, v12
  v_and_b32 v185, 0xffff0000, v12
  v_lshlrev_b32 v186, 16, v13
  v_and_b32 v187, 0xffff0000, v13
  v_mfma_f32_16x16x32_bf16 v[48:51], v[96:99], v[136:139], v[48:51]
  ds_read_b64_tr_b16 v[64:65], v26 offset:32768
  ds_read_b64_tr_b16 v[66:67], v26 offset:34816
  v_lshlrev_b32 v188, 16, v14
  v_and_b32 v189, 0xffff0000, v14
  v_lshlrev_b32 v190, 16, v15
  v_and_b32 v191, 0xffff0000, v15
  v_mfma_f32_16x16x32_bf16 v[52:55], v[100:103], v[136:139], v[52:55]
  ds_read_b64_tr_b16 v[68:69], v2 offset:32768
  ds_read_b64_tr_b16 v[70:71], v2 offset:34816
  s_waitcnt vmcnt(3) lgkmcnt(13)
  v_mfma_f32_16x16x32_bf16 v[40:43], v[104:107], v[140:143], v[40:43]
  ds_read_b64_tr_b16 v[72:73], v20 offset:36864
  ds_read_b64_tr_b16 v[74:75], v20 offset:38912
  v_lshlrev_b32 v192, 16, v16
  v_and_b32 v193, 0xffff0000, v16
  v_lshlrev_b32 v194, 16, v17
  v_and_b32 v195, 0xffff0000, v17
  v_mfma_f32_16x16x32_bf16 v[44:47], v[108:111], v[140:143], v[44:47]
  ds_read_b64_tr_b16 v[76:77], v23 offset:36864
  ds_read_b64_tr_b16 v[78:79], v23 offset:38912
  s_waitcnt lgkmcnt(13)
  v_mfma_f32_16x16x32_bf16 v[48:51], v[112:115], v[140:143], v[48:51]
  ds_read_b64_tr_b16 v[80:81], v26 offset:36864
  ds_read_b64_tr_b16 v[82:83], v26 offset:38912
  v_lshlrev_b32 v196, 16, v18
  v_and_b32 v197, 0xffff0000, v18
  v_lshlrev_b32 v198, 16, v19
  v_and_b32 v199, 0xffff0000, v19
  v_mfma_f32_16x16x32_bf16 v[52:55], v[116:119], v[140:143], v[52:55]
  ds_read_b64_tr_b16 v[84:85], v2 offset:36864
  ds_read_b64_tr_b16 v[86:87], v2 offset:38912
  s_waitcnt vmcnt(2) lgkmcnt(12)
  v_mfma_f32_16x16x32_bf16 v[40:43], v[56:59], v[144:147], v[40:43]
  ds_read_b64_tr_b16 v[88:89], v20 offset:40960
  ds_read_b64_tr_b16 v[90:91], v20 offset:43008
  v_mfma_f32_16x16x32_bf16 v[44:47], v[60:63], v[144:147], v[44:47]
  ds_read_b64_tr_b16 v[92:93], v23 offset:40960
  ds_read_b64_tr_b16 v[94:95], v23 offset:43008
  s_waitcnt lgkmcnt(12)
  v_mfma_f32_16x16x32_bf16 v[48:51], v[64:67], v[144:147], v[48:51]
  ds_read_b64_tr_b16 v[96:97], v26 offset:40960
  ds_read_b64_tr_b16 v[98:99], v26 offset:43008
  v_mfma_f32_16x16x32_bf16 v[52:55], v[68:71], v[144:147], v[52:55]
  ds_read_b64_tr_b16 v[100:101], v2 offset:40960
  ds_read_b64_tr_b16 v[102:103], v2 offset:43008
  s_waitcnt vmcnt(1) lgkmcnt(12)
  v_mfma_f32_16x16x32_bf16 v[40:43], v[72:75], v[148:151], v[40:43]
  ds_add_u32 v30, v31
  v_mfma_f32_16x16x32_bf16 v[44:47], v[76:79], v[148:151], v[44:47]
  s_waitcnt lgkmcnt(9)
  v_mfma_f32_16x16x32_bf16 v[48:51], v[80:83], v[148:151], v[48:51]
  ds_read_b128 v[168:171], v35 offset:4352
  ds_read_b128 v[172:175], v35 offset:4416
  ds_read_b128 v[176:179], v35 offset:4480
  ds_read_b128 v[180:183], v35 offset:4544
  v_mfma_f32_16x16x32_bf16 v[52:55], v[84:87], v[148:151], v[52:55]
  s_waitcnt vmcnt(0) lgkmcnt(9)
  v_mfma_f32_16x16x32_bf16 v[40:43], v[88:91], v[152:155], v[40:43]
  v_mfma_f32_16x16x32_bf16 v[44:47], v[92:95], v[152:155], v[44:47]
  s_waitcnt lgkmcnt(5)
  v_mfma_f32_16x16x32_bf16 v[48:51], v[96:99], v[152:155], v[48:51]
  v_mfma_f32_16x16x32_bf16 v[52:55], v[100:103], v[152:155], v[52:55]
  s_waitcnt lgkmcnt(0)
  s_nop 2
  v_pk_fma_f32 v[40:41], v[40:41], v[168:169], v[184:185]
  v_pk_fma_f32 v[42:43], v[42:43], v[170:171], v[186:187]
  v_pk_fma_f32 v[44:45], v[44:45], v[172:173], v[188:189]
  v_pk_fma_f32 v[46:47], v[46:47], v[174:175], v[190:191]
  v_cvt_pk_bf16_f32 v56, v40, v41
  v_cvt_pk_bf16_f32 v57, v42, v43
  v_cvt_pk_bf16_f32 v58, v44, v45
  v_cvt_pk_bf16_f32 v59, v46, v47
  s_nop 0
  v_permlane16_swap_b32 v56, v58
  v_permlane16_swap_b32 v57, v59
  buffer_store_dwordx4 v[56:59], v37, s[28:31], s57 offen offset:0
  v_pk_fma_f32 v[48:49], v[48:49], v[176:177], v[192:193]
  v_pk_fma_f32 v[50:51], v[50:51], v[178:179], v[194:195]
  v_pk_fma_f32 v[52:53], v[52:53], v[180:181], v[196:197]
  v_pk_fma_f32 v[54:55], v[54:55], v[182:183], v[198:199]
  v_cvt_pk_bf16_f32 v60, v48, v49
  v_cvt_pk_bf16_f32 v61, v50, v51
  v_cvt_pk_bf16_f32 v62, v52, v53
  v_cvt_pk_bf16_f32 v63, v54, v55
  s_nop 0
  v_permlane16_swap_b32 v60, v62
  v_permlane16_swap_b32 v61, v63
  buffer_store_dwordx4 v[60:63], v37, s[28:31], s57 offen offset:64
  s_endpgm
SLOW_6:
SP_8:
  ds_read_b32 v10, v29 offset:0
  s_sub_u32 s13, s13, 1
  s_cbranch_scc1 ABORT
  s_waitcnt lgkmcnt(0)
  v_cmp_gt_u32 vcc, 3, v10
  s_cbranch_vccnz SP_8
  s_branch JOIN_7
SLOW_9:
SP_11:
  ds_read_b32 v10, v29 offset:0
  s_sub_u32 s13, s13, 1
  s_cbranch_scc1 ABORT
  s_waitcnt lgkmcnt(0)
  v_cmp_gt_u32 vcc, 4, v10
  s_cbranch_vccnz SP_11
  s_branch JOIN_10
SLOW_12:
SP_14:
  ds_read_b32 v10, v29 offset:0
  s_sub_u32 s13, s13, 1
  s_cbranch_scc1 ABORT
  s_waitcnt lgkmcnt(0)
  v_cmp_gt_u32 vcc, 5, v10
  s_cbranch_vccnz SP_14
  s_branch JOIN_13
SLOW_15:
SP_17:
  ds_read_b32 v10, v29 offset:0
  s_sub_u32 s13, s13, 1
  s_cbranch_scc1 ABORT
  s_waitcnt lgkmcnt(0)
  v_cmp_gt_u32 vcc, 6, v10
  s_cbranch_vccnz SP_17
  s_branch JOIN_16
SLOW_18:
SP_20:
  ds_read_b32 v10, v29 offset:0
  s_sub_u32 s13, s13, 1
  s_cbranch_scc1 ABORT
  s_waitcnt lgkmcnt(0)
  v_cmp_gt_u32 vcc, 7, v10
  s_cbranch_vccnz SP_20
  s_branch JOIN_19
SLOW_21:
SP_23:
  ds_read_b32 v10, v29 offset:0
  s_sub_u32 s13, s13, 1
  s_cbranch_scc1 ABORT
  s_waitcnt lgkmcnt(0)
  v_cmp_gt_u32 vcc, 8, v10
  s_cbranch_vccnz SP_23
  s_branch JOIN_22
SLOW_24:
SP_26:
  ds_read_b32 v10, v29 offset:0
  s_sub_u32 s13, s13, 1
  s_cbranch_scc1 ABORT
  s_waitcnt lgkmcnt(0)
  v_cmp_gt_u32 vcc, 9, v10
  s_cbranch_vccnz SP_26
  s_branch JOIN_25
SLOW_27:
SP_29:
  ds_read_b32 v10, v29 offset:0
  s_sub_u32 s13, s13, 1
  s_cbranch_scc1 ABORT
  s_waitcnt lgkmcnt(0)
  v_cmp_gt_u32 vcc, 10, v10
  s_cbranch_vccnz SP_29
  s_branch JOIN_28
SLOW_30:
SP_32:
  ds_read_b32 v10, v29 offset:0
  s_sub_u32 s13, s13, 1
  s_cbranch_scc1 ABORT
  s_waitcnt lgkmcnt(0)
  v_cmp_gt_u32 vcc, 11, v10
  s_cbranch_vccnz SP_32
  s_branch JOIN_31
SLOW_33:
SP_35:
  ds_read_b32 v10, v29 offset:0
  s_sub_u32 s13, s13, 1
  s_cbranch_scc1 ABORT
  s_waitcnt lgkmcnt(0)
  v_cmp_gt_u32 vcc, 12, v10
  s_cbranch_vccnz SP_35
  s_branch JOIN_34
SLOW_36:
SP_38:
  ds_read_b32 v10, v29 offset:0
  s_sub_u32 s13, s13, 1
  s_cbranch_scc1 ABORT
  s_waitcnt lgkmcnt(0)
  v_cmp_gt_u32 vcc, 13, v10
  s_cbranch_vccnz SP_38
  s_branch JOIN_37
SLOW_39:
SP_41:
  ds_read_b32 v10, v29 offset:0
  s_sub_u32 s13, s13, 1
  s_cbranch_scc1 ABORT
  s_waitcnt lgkmcnt(0)
  v_cmp_gt_u32 vcc, 14, v10
  s_cbranch_vccnz SP_41
  s_branch JOIN_40
SLOW_43:
SP_45:
  ds_read_b32 v10, v29 offset:0
  s_sub_u32 s13, s13, 1
  s_cbranch_scc1 ABORT
  s_waitcnt lgkmcnt(0)
  v_cmp_gt_u32 vcc, 15, v10
  s_cbranch_vccnz SP_45
  s_branch JOIN_44
SLOW_46:
SP_48:
  ds_read_b32 v10, v29 offset:0
  s_sub_u32 s13, s13, 1
  s_cbranch_scc1 ABORT
  s_waitcnt lgkmcnt(0)
  v_cmp_gt_u32 vcc, 16, v10
  s_cbranch_vccnz SP_48
  s_branch JOIN_47
SLOW_49:
SP_51:
  ds_read_b32 v10, v29 offset:0
  s_sub_u32 s13, s13, 1
  s_cbranch_scc1 ABORT
  s_waitcnt lgkmcnt(0)
  v_cmp_gt_u32 vcc, 17, v10
  s_cbranch_vccnz SP_51
  s_branch JOIN_50
MS_52:
  s_nop 15
  v_mov_b32 v2, s14
  v_mov_b32 v3, s15
  s_mov_b64 exec, 1
  buffer_store_dwordx2 v[2:3], v33, s[24:27], s51 offen sc1
  s_mov_b64 exec, -1
  s_branch MJ_53
MS_55:
  s_nop 15
  v_mov_b32 v2, s14
  v_mov_b32 v3, s15
  s_mov_b64 exec, 1
  buffer_store_dwordx2 v[2:3], v33, s[24:27], s52 offen sc1
  s_mov_b64 exec, -1
  s_branch MJ_56
SLOW_58:
SP_60:
  ds_read_b32 v10, v29 offset:0
  s_sub_u32 s13, s13, 1
  s_cbranch_scc1 ABORT
  s_waitcnt lgkmcnt(0)
  v_cmp_gt_u32 vcc, 20, v10
  s_cbranch_vccnz SP_60
  s_branch JOIN_59
SLOW_61:
SP_63:
  ds_read_b32 v10, v29 offset:0
  s_sub_u32 s13, s13, 1
  s_cbranch_scc1 ABORT
  s_waitcnt lgkmcnt(0)
  v_cmp_gt_u32 vcc, 21, v10
  s_cbranch_vccnz SP_63
  s_branch JOIN_62
SLOW_64:
SP_66:
  ds_read_b32 v10, v29 offset:0
  s_sub_u32 s13, s13, 1
  s_cbranch_scc1 ABORT
  s_waitcnt lgkmcnt(0)
  v_cmp_gt_u32 vcc, 22, v10
  s_cbranch_vccnz SP_66
  s_branch JOIN_65
SLOW_67:
SP_69:
  ds_read_b32 v10, v29 offset:0
  s_sub_u32 s13, s13, 1
  s_cbranch_scc1 ABORT
  s_waitcnt lgkmcnt(0)
  v_cmp_gt_u32 vcc, 23, v10
  s_cbranch_vccnz SP_69
  s_branch JOIN_68
SLOW_70:
SP_72:
  ds_read_b32 v10, v29 offset:0
  s_sub_u32 s13, s13, 1
  s_cbranch_scc1 ABORT
  s_waitcnt lgkmcnt(0)
  v_cmp_gt_u32 vcc, 24, v10
  s_cbranch_vccnz SP_72
  s_branch JOIN_71
SLOW_73:
SP_75:
  ds_read_b32 v10, v29 offset:0
  s_sub_u32 s13, s13, 1
  s_cbranch_scc1 ABORT
  s_waitcnt lgkmcnt(0)
  v_cmp_gt_u32 vcc, 25, v10
  s_cbranch_vccnz SP_75
  s_branch JOIN_74
SLOW_76:
SP_78:
  ds_read_b32 v10, v29 offset:0
  s_sub_u32 s13, s13, 1
  s_cbranch_scc1 ABORT
  s_waitcnt lgkmcnt(0)
  v_cmp_gt_u32 vcc, 26, v10
  s_cbranch_vccnz SP_78
  s_branch JOIN_77
MS_79:
  s_nop 15
  v_pk_fma_f32 v[40:41], v[40:41], v[120:121], v[152:153]
  v_pk_fma_f32 v[42:43], v[42:43], v[122:123], v[154:155]
  v_pk_fma_f32 v[44:45], v[44:45], v[124:125], v[156:157]
  v_pk_fma_f32 v[46:47], v[46:47], v[126:127], v[158:159]
  v_pk_mul_f32 v[56:57], v[40:41], v[136:137]
  v_pk_mul_f32 v[58:59], v[42:43], v[138:139]
  v_pk_mul_f32 v[60:61], v[44:45], v[140:141]
  v_pk_mul_f32 v[62:63], v[46:47], v[142:143]
  v_cvt_pk_bf16_f32 v72, v56, v57
  v_cvt_pk_bf16_f32 v73, v58, v59
  v_cvt_pk_bf16_f32 v74, v60, v61
  v_cvt_pk_bf16_f32 v75, v62, v63
  buffer_store_dwordx4 v[72:75], v32, s[20:23], s46 offen offset:0 sc1
  v_pk_fma_f32 v[48:49], v[48:49], v[128:129], v[160:161]
  v_pk_fma_f32 v[50:51], v[50:51], v[130:131], v[162:163]
  v_pk_fma_f32 v[52:53], v[52:53], v[132:133], v[164:165]
  v_pk_fma_f32 v[54:55], v[54:55], v[134:135], v[166:167]
  v_pk_mul_f32 v[64:65], v[48:49], v[144:145]
  v_pk_mul_f32 v[66:67], v[50:51], v[146:147]
  v_pk_mul_f32 v[68:69], v[52:53], v[148:149]
  v_pk_mul_f32 v[70:71], v[54:55], v[150:151]
  v_cvt_pk_bf16_f32 v76, v64, v65
  v_cvt_pk_bf16_f32 v77, v66, v67
  v_cvt_pk_bf16_f32 v78, v68, v69
  v_cvt_pk_bf16_f32 v79, v70, v71
  buffer_store_dwordx4 v[76:79], v32, s[20:23], s46 offen offset:1024 sc1
  v_cvt_pk_bf16_f32 v12, v40, v41
  v_cvt_pk_bf16_f32 v13, v42, v43
  v_cvt_pk_bf16_f32 v14, v44, v45
  v_cvt_pk_bf16_f32 v15, v46, v47
  v_cvt_pk_bf16_f32 v16, v48, v49
  v_cvt_pk_bf16_f32 v17, v50, v51
  v_cvt_pk_bf16_f32 v18, v52, v53
  v_cvt_pk_bf16_f32 v19, v54, v55
  v_dot2_f32_bf16 v4, v12, v8, 0
  v_dot2_f32_bf16 v6, v12, v12, 0
  v_dot2_f32_bf16 v4, v13, v8, v4
  v_dot2_f32_bf16 v6, v13, v13, v6
  v_dot2_f32_bf16 v4, v14, v8, v4
  v_dot2_f32_bf16 v6, v14, v14, v6
  v_dot2_f32_bf16 v4, v15, v8, v4
  v_dot2_f32_bf16 v6, v15, v15, v6
  v_dot2_f32_bf16 v4, v16, v8, v4
  v_dot2_f32_bf16 v6, v16, v16, v6
  v_dot2_f32_bf16 v4, v17, v8, v4
  v_dot2_f32_bf16 v6, v17, v17, v6
  v_dot2_f32_bf16 v4, v18, v8, v4
  v_dot2_f32_bf16 v6, v18, v18, v6
  v_dot2_f32_bf16 v4, v19, v8, v4
  v_dot2_f32_bf16 v6, v19, v19, v6
  s_nop 2
  v_permlane32_swap_b32 v4, v6
  v_add_f32 v4, v4, v6
  v_mov_b32 v5, v4
  s_nop 1
  v_permlane16_swap_b32 v4, v5
  v_add_f32 v4, v4, v5
  s_mov_b32 exec_lo, 0xffff
  s_mov_b32 exec_hi, 0xffff
  buffer_store_dword v4, v7, s[24:27], s47 offen sc1
  s_mov_b64 exec, -1
  s_waitcnt vmcnt(0)
  v_mov_b32 v4, s14
  v_mov_b32 v5, s15
  s_mov_b64 exec, 1
  buffer_store_dwordx2 v[4:5], v33, s[24:27], s50 offen sc1
  s_mov_b64 exec, -1
  s_branch MJ_80
SK3_81a:
  v_mov_b32 v4, 8
  ds_add_u32 v30, v4
  s_branch SK3_81
SLOW_84:
SP_86:
  ds_read_b32 v10, v29 offset:0
  s_sub_u32 s13, s13, 1
  s_cbranch_scc1 ABORT
  s_waitcnt lgkmcnt(0)
  v_cmp_gt_u32 vcc, 29, v10
  s_cbranch_vccnz SP_86
  s_branch JOIN_85
SLOW_87:
SP_89:
  ds_read_b32 v10, v29 offset:0
  s_sub_u32 s13, s13, 1
  s_cbranch_scc1 ABORT
  s_waitcnt lgkmcnt(0)
  v_cmp_gt_u32 vcc, 30, v10
  s_cbranch_vccnz SP_89
  s_branch JOIN_88
SLOW_90:
SP_92:
  ds_read_b32 v10, v29 offset:0
  s_sub_u32 s13, s13, 1
  s_cbranch_scc1 ABORT
  s_waitcnt lgkmcnt(0)
  v_cmp_gt_u32 vcc, 31, v10
  s_cbranch_vccnz SP_92
  s_branch JOIN_91
SLOW_93:
SP_95:
  ds_read_b32 v10, v29 offset:0
  s_sub_u32 s13, s13, 1
  s_cbranch_scc1 ABORT
  s_waitcnt lgkmcnt(0)
  v_cmp_gt_u32 vcc, 32, v10
  s_cbranch_vccnz SP_95
  s_branch JOIN_94
SLOW_96:
SP_98:
  ds_read_b32 v10, v29 offset:0
  s_sub_u32 s13, s13, 1
  s_cbranch_scc1 ABORT
  s_waitcnt lgkmcnt(0)
  v_cmp_gt_u32 vcc, 33, v10
  s_cbranch_vccnz SP_98
  s_branch JOIN_97
SLOW_99:
SP_101:
  ds_read_b32 v10, v29 offset:0
  s_sub_u32 s13, s13, 1
  s_cbranch_scc1 ABORT
  s_waitcnt lgkmcnt(0)
  v_cmp_gt_u32 vcc, 34, v10
  s_cbranch_vccnz SP_101
  s_branch JOIN_100
SLOW_102:
SP_104:
  ds_read_b32 v10, v29 offset:0
  s_sub_u32 s13, s13, 1
  s_cbranch_scc1 ABORT
  s_waitcnt lgkmcnt(0)
  v_cmp_gt_u32 vcc, 35, v10
  s_cbranch_vccnz SP_104
  s_branch JOIN_103
MS_106:
  s_nop 15
  v_pk_fma_f32 v[200:201], v[152:153], v[2:3], v[176:177] op_sel_hi:[1,0,1]
  v_pk_fma_f32 v[202:203], v[154:155], v[2:3], v[178:179] op_sel_hi:[1,0,1]
  v_pk_fma_f32 v[204:205], v[156:157], v[2:3], v[180:181] op_sel_hi:[1,0,1]
  v_pk_fma_f32 v[206:207], v[158:159], v[2:3], v[182:183] op_sel_hi:[1,0,1]
  v_pk_fma_f32 v[40:41], v[40:41], v[4:5], v[200:201] op_sel_hi:[1,0,1]
  v_pk_fma_f32 v[42:43], v[42:43], v[4:5], v[202:203] op_sel_hi:[1,0,1]
  v_pk_fma_f32 v[44:45], v[44:45], v[4:5], v[204:205] op_sel_hi:[1,0,1]
  v_pk_fma_f32 v[46:47], v[46:47], v[4:5], v[206:207] op_sel_hi:[1,0,1]
  v_cvt_pk_bf16_f32 v88, v40, v41
  v_cvt_pk_bf16_f32 v89, v42, v43
  v_cvt_pk_bf16_f32 v90, v44, v45
  v_cvt_pk_bf16_f32 v91, v46, v47
  v_pk_max_i16 v88, v88, 0
  v_pk_max_i16 v89, v89, 0
  v_pk_max_i16 v90, v90, 0
  v_pk_max_i16 v91, v91, 0
  buffer_store_dwordx4 v[88:91], v32, s[20:23], s46 offen offset:0 sc1
  v_pk_fma_f32 v[200:201], v[160:161], v[2:3], v[184:185] op_sel_hi:[1,0,1]
  v_pk_fma_f32 v[202:203], v[162:163], v[2:3], v[186:187] op_sel_hi:[1,0,1]
  v_pk_fma_f32 v[204:205], v[164:165], v[2:3], v[188:189] op_sel_hi:[1,0,1]
  v_pk_fma_f32 v[206:207], v[166:167], v[2:3], v[190:191] op_sel_hi:[1,0,1]
  v_pk_fma_f32 v[48:49], v[48:49], v[4:5], v[200:201] op_sel_hi:[1,0,1]
  v_pk_fma_f32 v[50:51], v[50:51], v[4:5], v[202:203] op_sel_hi:[1,0,1]
  v_pk_fma_f32 v[52:53], v[52:53], v[4:5], v[204:205] op_sel_hi:[1,0,1]
  v_pk_fma_f32 v[54:55], v[54:55], v[4:5], v[206:207] op_sel_hi:[1,0,1]
  v_cvt_pk_bf16_f32 v92, v48, v49
  v_cvt_pk_bf16_f32 v93, v50, v51
  v_cvt_pk_bf16_f32 v94, v52, v53
  v_cvt_pk_bf16_f32 v95, v54, v55
  v_pk_max_i16 v92, v92, 0
  v_pk_max_i16 v93, v93, 0
  v_pk_max_i16 v94, v94, 0
  v_pk_max_i16 v95, v95, 0
  buffer_store_dwordx4 v[92:95], v32, s[20:23], s46 offen offset:1024 sc1
  v_pk_fma_f32 v[200:201], v[168:169], v[2:3], v[192:193] op_sel_hi:[1,0,1]
  v_pk_fma_f32 v[202:203], v[170:171], v[2:3], v[194:195] op_sel_hi:[1,0,1]
  v_pk_fma_f32 v[204:205], v[172:173], v[2:3], v[196:197] op_sel_hi:[1,0,1]
  v_pk_fma_f32 v[206:207], v[174:175], v[2:3], v[198:199] op_sel_hi:[1,0,1]
  v_pk_fma_f32 v[56:57], v[56:57], v[4:5], v[200:201] op_sel_hi:[1,0,1]
  v_pk_fma_f32 v[58:59], v[58:59], v[4:5], v[202:203] op_sel_hi:[1,0,1]
  v_pk_fma_f32 v[60:61], v[60:61], v[4:5], v[204:205] op_sel_hi:[1,0,1]
  v_pk_fma_f32 v[62:63], v[62:63], v[4:5], v[206:207] op_sel_hi:[1,0,1]
  v_cvt_pk_bf16_f32 v96, v56, v57
  v_cvt_pk_bf16_f32 v97, v58, v59
  v_cvt_pk_bf16_f32 v98, v60, v61
  v_cvt_pk_bf16_f32 v99, v62, v63
  v_pk_max_i16 v96, v96, 0
  v_pk_max_i16 v97, v97, 0
  v_pk_max_i16 v98, v98, 0
  v_pk_max_i16 v99, v99, 0
  buffer_store_dwordx4 v[96:99], v32, s[20:23], s46 offen offset:2048 sc1
  v_pk_fma_f32 v[200:201], v[152:153], v[6:7], v[176:177] op_sel_hi:[1,0,1]
  v_pk_fma_f32 v[202:203], v[154:155], v[6:7], v[178:179] op_sel_hi:[1,0,1]
  v_pk_fma_f32 v[204:205], v[156:157], v[6:7], v[180:181] op_sel_hi:[1,0,1]
  v_pk_fma_f32 v[206:207], v[158:159], v[6:7], v[182:183] op_sel_hi:[1,0,1]
  v_pk_fma_f32 v[64:65], v[64:65], v[8:9], v[200:201] op_sel_hi:[1,0,1]
  v_pk_fma_f32 v[66:67], v[66:67], v[8:9], v[202:203] op_sel_hi:[1,0,1]
  v_pk_fma_f32 v[68:69], v[68:69], v[8:9], v[204:205] op_sel_hi:[1,0,1]
  v_pk_fma_f32 v[70:71], v[70:71], v[8:9], v[206:207] op_sel_hi:[1,0,1]
  v_cvt_pk_bf16_f32 v100, v64, v65
  v_cvt_pk_bf16_f32 v101, v66, v67
  v_cvt_pk_bf16_f32 v102, v68, v69
  v_cvt_pk_bf16_f32 v103, v70, v71
  v_pk_max_i16 v100, v100, 0
  v_pk_max_i16 v101, v101, 0
  v_pk_max_i16 v102, v102, 0
  v_pk_max_i16 v103, v103, 0
  buffer_store_dwordx4 v[100:103], v32, s[20:23], s48 offen offset:0 sc1
  v_pk_fma_f32 v[200:201], v[160:161], v[6:7], v[184:185] op_sel_hi:[1,0,1]
  v_pk_fma_f32 v[202:203], v[162:163], v[6:7], v[186:187] op_sel_hi:[1,0,1]
  v_pk_fma_f32 v[204:205], v[164:165], v[6:7], v[188:189] op_sel_hi:[1,0,1]
  v_pk_fma_f32 v[206:207], v[166:167], v[6:7], v[190:191] op_sel_hi:[1,0,1]
  v_pk_fma_f32 v[72:73], v[72:73], v[8:9], v[200:201] op_sel_hi:[1,0,1]
  v_pk_fma_f32 v[74:75], v[74:75], v[8:9], v[202:203] op_sel_hi:[1,0,1]
  v_pk_fma_f32 v[76:77], v[76:77], v[8:9], v[204:205] op_sel_hi:[1,0,1]
  v_pk_fma_f32 v[78:79], v[78:79], v[8:9], v[206:207] op_sel_hi:[1,0,1]
  v_cvt_pk_bf16_f32 v104, v72, v73
  v_cvt_pk_bf16_f32 v105, v74, v75
  v_cvt_pk_bf16_f32 v106, v76, v77
  v_cvt_pk_bf16_f32 v107, v78, v79
  v_pk_max_i16 v104, v104, 0
  v_pk_max_i16 v105, v105, 0
  v_pk_max_i16 v106, v106, 0
  v_pk_max_i16 v107, v107, 0
  buffer_store_dwordx4 v[104:107], v32, s[20:23], s48 offen offset:1024 sc1
  v_pk_fma_f32 v[200:201], v[168:169], v[6:7], v[192:193] op_sel_hi:[1,0,1]
  v_pk_fma_f32 v[202:203], v[170:171], v[6:7], v[194:195] op_sel_hi:[1,0,1]
  v_pk_fma_f32 v[204:205], v[172:173], v[6:7], v[196:197] op_sel_hi:[1,0,1]
  v_pk_fma_f32 v[206:207], v[174:175], v[6:7], v[198:199] op_sel_hi:[1,0,1]
  v_pk_fma_f32 v[80:81], v[80:81], v[8:9], v[200:201] op_sel_hi:[1,0,1]
  v_pk_fma_f32 v[82:83], v[82:83], v[8:9], v[202:203] op_sel_hi:[1,0,1]
  v_pk_fma_f32 v[84:85], v[84:85], v[8:9], v[204:205] op_sel_hi:[1,0,1]
  v_pk_fma_f32 v[86:87], v[86:87], v[8:9], v[206:207] op_sel_hi:[1,0,1]
  v_cvt_pk_bf16_f32 v108, v80, v81
  v_cvt_pk_bf16_f32 v109, v82, v83
  v_cvt_pk_bf16_f32 v110, v84, v85
  v_cvt_pk_bf16_f32 v111, v86, v87
  v_pk_max_i16 v108, v108, 0
  v_pk_max_i16 v109, v109, 0
  v_pk_max_i16 v110, v110, 0
  v_pk_max_i16 v111, v111, 0
  buffer_store_dwordx4 v[108:111], v32, s[20:23], s48 offen offset:2048 sc1
  s_waitcnt vmcnt(0)
  v_mov_b32 v4, s14
  v_mov_b32 v5, s15
  s_mov_b64 exec, 1
  buffer_store_dwordx2 v[4:5], v33, s[24:27], s50 offen sc1
  s_mov_b64 exec, -1
  s_branch MJ_107
SLOW_110:
SP_112:
  ds_read_b32 v10, v29 offset:0
  s_sub_u32 s13, s13, 1
  s_cbranch_scc1 ABORT
  s_waitcnt lgkmcnt(0)
  v_cmp_gt_u32 vcc, 38, v10
  s_cbranch_vccnz SP_112
  s_branch JOIN_111
SLOW_113:
SP_115:
  ds_read_b32 v10, v29 offset:0
  s_sub_u32 s13, s13, 1
  s_cbranch_scc1 ABORT
  s_waitcnt lgkmcnt(0)
  v_cmp_gt_u32 vcc, 39, v10
  s_cbranch_vccnz SP_115
  s_branch JOIN_114
SLOW_116:
SP_118:
  ds_read_b32 v10, v29 offset:0
  s_sub_u32 s13, s13, 1
  s_cbranch_scc1 ABORT
  s_waitcnt lgkmcnt(0)
  v_cmp_gt_u32 vcc, 40, v10
  s_cbranch_vccnz SP_118
  s_branch JOIN_117
SLOW_119:
SP_121:
  ds_read_b32 v10, v29 offset:0
  s_sub_u32 s13, s13, 1
  s_cbranch_scc1 ABORT
  s_waitcnt lgkmcnt(0)
  v_cmp_gt_u32 vcc, 41, v10
  s_cbranch_vccnz SP_121
  s_branch JOIN_120
SLOW_122:
SP_124:
  ds_read_b32 v10, v29 offset:0
  s_sub_u32 s13, s13, 1
  s_cbranch_scc1 ABORT
  s_waitcnt lgkmcnt(0)
  v_cmp_gt_u32 vcc, 42, v10
  s_cbranch_vccnz SP_124
  s_branch JOIN_123
SLOW_125:
SP_127:
  ds_read_b32 v10, v29 offset:0
  s_sub_u32 s13, s13, 1
  s_cbranch_scc1 ABORT
  s_waitcnt lgkmcnt(0)
  v_cmp_gt_u32 vcc, 43, v10
  s_cbranch_vccnz SP_127
  s_branch JOIN_126
SLOW_128:
SP_130:
  ds_read_b32 v10, v29 offset:0
  s_sub_u32 s13, s13, 1
  s_cbranch_scc1 ABORT
  s_waitcnt lgkmcnt(0)
  v_cmp_gt_u32 vcc, 44, v10
  s_cbranch_vccnz SP_130
  s_branch JOIN_129
SLOW_131:
SP_133:
  ds_read_b32 v10, v29 offset:0
  s_sub_u32 s13, s13, 1
  s_cbranch_scc1 ABORT
  s_waitcnt lgkmcnt(0)
  v_cmp_gt_u32 vcc, 45, v10
  s_cbranch_vccnz SP_133
  s_branch JOIN_132
SLOW_134:
SP_136:
  ds_read_b32 v10, v29 offset:0
  s_sub_u32 s13, s13, 1
  s_cbranch_scc1 ABORT
  s_waitcnt lgkmcnt(0)
  v_cmp_gt_u32 vcc, 46, v10
  s_cbranch_vccnz SP_136
  s_branch JOIN_135
SLOW_137:
SP_139:
  ds_read_b32 v10, v29 offset:0
  s_sub_u32 s13, s13, 1
  s_cbranch_scc1 ABORT
  s_waitcnt lgkmcnt(0)
  v_cmp_gt_u32 vcc, 47, v10
  s_cbranch_vccnz SP_139
  s_branch JOIN_138
POLLER:
  v_mov_b32 v6, 0
  v_lshrrev_b32 v42, 3, v1
  v_and_b32 v43, 7, v1
  v_lshlrev_b32 v3, 2, v1
  v_add_u32 v7, 159744, v3
  v_add_u32 v3, 159488, v3
  v_mov_b32 v26, 157696
  v_mov_b32 v11, 160128
  s_add_u32 s24, s88, 0x1800000
  s_addc_u32 s25, s89, 0
  s_and_b32 s25, s25, 0xffff
  s_mov_b32 s26, 0x100000
  s_mov_b32 s27, 0x00020000
  s_mov_b32 s28, s76
  s_and_b32 s29, s77, 0xffff
  s_mov_b32 s30, 0x158000
  s_mov_b32 s31, 0x00020000
  v_lshlrev_b32 v50, 4, v42
  v_mul_u32_u24 v51, 49152, v42
  v_lshl_add_u32 v51, v43, 4, v51
  s_mul_i32 s92, s4, 6
  s_lshr_b32 s44, s5, 2
  s_add_u32 s92, s92, s44
  s_lshl_b32 s93, s8, 8
  s_mul_i32 s94, s8, 786432
  s_lshl_b32 s44, s92, 7
  s_add_u32 s94, s94, s44
  s_mov_b32 s32, s80
  s_and_b32 s33, s81, 0xffff
  s_mov_b32 s34, 0x400
  s_mov_b32 s35, 0x00020000
  s_mov_b32 s36, s82
  s_and_b32 s37, s83, 0xffff
  s_mov_b32 s38, 0x300000
  s_mov_b32 s39, 0x00020000
  s_lshl_b32 s48, s4, 14
  s_lshl_b32 s44, s8, 12
  s_add_u32 s48, s48, s44
  s_lshl_b32 s44, s7, 11
  s_add_u32 s48, s48, s44
  s_add_u32 s48, s48, 0xc0000
  v_mov_b32 v9, -1
  v_writelane_b32 v9, 1, 0
  v_writelane_b32 v9, 2, 1
  v_writelane_b32 v9, 3, 2
  v_writelane_b32 v9, 4, 3
  v_writelane_b32 v9, 5, 4
  v_writelane_b32 v9, 6, 5
  v_writelane_b32 v9, 7, 6
  v_writelane_b32 v9, 7, 7
  v_writelane_b32 v9, 8, 8
  v_writelane_b32 v9, 8, 9
  v_writelane_b32 v9, 8, 10
  v_writelane_b32 v9, 8, 11
  v_writelane_b32 v9, 8, 12
  v_writelane_b32 v9, 8, 13
  v_writelane_b32 v9, 8, 14
  v_writelane_b32 v9, 8, 15
  v_writelane_b32 v9, 8, 16
  v_and_b32 v44, 31, v1
  s_lshl_b32 s52, s4, 8
  s_add_u32 s52, s52, 0x48000
  v_lshl_add_u32 v10, v44, 3, s52
  s_mov_b32 s46, 0
  s_lshl_b32 s47, s97, 1
  v_lshrrev_b32 v44, 2, v1
  v_add_u32 v44, s47, v44
  v_and_b32 v44, 7, v44
  v_and_b32 v45, 3, v1
  v_lshlrev_b32 v45, 4, v45
  v_lshl_add_u32 v8, v44, 8, v45
  s_lshl_b32 s52, s96, 3
  s_add_u32 s52, s52, 0x48000
  s_setprio 3
  v_lshlrev_b32 v44, 7, v1
  v_add_u32 v44, 335872, v44
  s_lshl_b32 s53, s4, 8
  s_add_u32 s53, s53, 0xffff5400
  v_cmp_lt_u32 vcc, 23, v1
  v_add_u32 v45, s53, v44
  s_nop 0
  v_cndmask_b32 v46, v44, v45, vcc
  s_lshl_b32 s53, s9, 9
  s_add_u32 s53, s53, 0x9300
  v_cmp_lt_u32 vcc, 25, v1
  v_add_u32 v45, s53, v44
  s_nop 0
  v_cndmask_b32 v46, v46, v45, vcc
  s_lshl_b32 s53, s11, 9
  s_add_u32 s53, s53, 0x3200
  v_cmp_lt_u32 vcc, 27, v1
  v_add_u32 v45, s53, v44
  s_nop 0
  v_cndmask_b32 v46, v46, v45, vcc
  v_cmp_lt_u32 vcc, 31, v1
  s_nop 1
  v_cndmask_b32 v46, v46, v44, vcc
  s_lshl_b32 s53, s11, 9
  s_add_u32 s53, s53, 0x4a80
  v_cmp_lt_u32 vcc, 42, v1
  v_add_u32 v45, s53, v44
  s_nop 0
  v_cndmask_b32 v46, v46, v45, vcc
  s_mov_b32 exec_hi, 0x7fff
  buffer_load_dword v47, v46, s[24:27], 0 offen sc1
  s_mov_b64 exec, -1
  buffer_load_dword v47, v8, s[24:27], s48 offen sc1
  s_min_u32 s53, s5, 23
  s_lshr_b32 s53, s53, 2
  s_mul_i32 s54, s4, 1536
  s_lshl_b32 s44, s53, 8
  s_add_u32 s54, s54, s44
  s_mul_i32 s44, s8, 12288
  s_add_u32 s54, s54, s44
  s_add_u32 s54, s54, 0x60000
  s_min_u32 s53, s5, 21
  s_mul_i32 s55, s4, 12288
  s_lshl_b32 s44, s53, 8
  s_add_u32 s55, s55, s44
  s_add_u32 s55, s55, 0x80000
  s_lshl_b32 s53, s9, 12
  s_lshl_b32 s44, s10, 9
  s_add_u32 s53, s53, s44
  s_add_u32 s53, s53, 0x10000
  v_and_b32 v44, 1, v1
  v_lshlrev_b32 v44, 7, v44
  v_add_u32 v46, s54, v44
  v_add_u32 v45, s55, v44
  v_cmp_lt_u32 vcc, 1, v1
  s_nop 1
  v_cndmask_b32 v46, v46, v45, vcc
  v_add_u32 v45, 6144, v45
  v_cmp_lt_u32 vcc, 3, v1
  s_nop 1
  v_cndmask_b32 v46, v46, v45, vcc
  v_and_b32 v44, 3, v1
  v_lshl_add_u32 v45, v44, 7, s53
  v_cmp_lt_u32 vcc, 7, v1
  s_nop 1
  v_cndmask_b32 v46, v46, v45, vcc
  s_lshl_b32 s53, s9, 9
  s_add_u32 s53, s53, 0x5c000
  v_lshl_add_u32 v45, v44, 7, s53
  v_cmp_lt_u32 vcc, 11, v1
  s_nop 1
  v_cndmask_b32 v46, v46, v45, vcc
  s_mov_b64 exec, 0xcf00
  buffer_load_dword v47, v46, s[24:27], 0 offen sc1
  s_mov_b64 exec, -1
  s_cmp_ge_u32 s5, 24
  s_cbranch_scc1 NOG_140
  buffer_load_dwordx4 v[56:59], v50, s[32:35], s93 offen offset:0
  buffer_load_dwordx4 v[60:63], v50, s[32:35], s93 offen offset:128
  buffer_load_dwordx4 v[128:131], v51, s[36:39], s94 offen
  s_add_u32 s94, s94, 6144
  buffer_load_dwordx4 v[132:135], v51, s[36:39], s94 offen
  s_add_u32 s94, s94, 6144
  buffer_load_dwordx4 v[136:139], v51, s[36:39], s94 offen
  s_add_u32 s94, s94, 6144
  buffer_load_dwordx4 v[140:143], v51, s[36:39], s94 offen
  s_add_u32 s94, s94, 6144
  buffer_load_dwordx4 v[144:147], v51, s[36:39], s94 offen
  s_add_u32 s94, s94, 6144
  buffer_load_dwordx4 v[148:151], v51, s[36:39], s94 offen
  s_add_u32 s94, s94, 6144
  buffer_load_dwordx4 v[152:155], v51, s[36:39], s94 offen
  s_add_u32 s94, s94, 6144
  buffer_load_dwordx4 v[156:159], v51, s[36:39], s94 offen
  s_add_u32 s94, s94, 350208
  buffer_load_dwordx4 v[160:163], v51, s[36:39], s94 offen
  s_add_u32 s94, s94, 6144
  buffer_load_dwordx4 v[164:167], v51, s[36:39], s94 offen
  s_add_u32 s94, s94, 6144
  buffer_load_dwordx4 v[168:171], v51, s[36:39], s94 offen
  s_add_u32 s94, s94, 6144
  buffer_load_dwordx4 v[172:175], v51, s[36:39], s94 offen
  s_add_u32 s94, s94, 6144
  buffer_load_dwordx4 v[176:179], v51, s[36:39], s94 offen
  s_add_u32 s94, s94, 6144
  buffer_load_dwordx4 v[180:183], v51, s[36:39], s94 offen
  s_add_u32 s94, s94, 6144
  buffer_load_dwordx4 v[184:187], v51, s[36:39], s94 offen
  s_add_u32 s94, s94, 6144
  buffer_load_dwordx4 v[188:191], v51, s[36:39], s94 offen
NOG_140:
WS_141:
  ds_read_b32 v36, v26 offset:2464
  s_sub_u32 s13, s13, 1
  s_cbranch_scc1 ABORT
  s_waitcnt lgkmcnt(0)
  v_cmp_gt_u32 vcc, 4, v36
  s_cbranch_vccnz WS_141
  buffer_load_dwordx2 v[36:37], v6, s[40:43], 0 offen sc1
  s_cmp_ge_u32 s5, 24
  s_cbranch_scc1 NOG_142
  v_and_b32 v52, 7, v1
  v_bfe_u32 v53, v1, 3, 1
  v_lshl_add_u32 v52, v52, 1, v53
  v_bfe_u32 v53, v1, 4, 1
  v_lshl_add_u32 v52, v52, 1, v53
  v_lshrrev_b32 v53, 5, v1
  v_lshl_add_u32 v52, v52, 1, v53
  v_lshlrev_b32 v52, 2, v52
  s_mul_i32 s93, s8, 12288
  s_lshl_b32 s44, s92, 8
  s_add_u32 s93, s93, s44
  s_add_u32 s93, s93, 0x60000
  s_lshl_b32 s94, s92, 6
  s_lshl_b32 s44, s8, 3
  s_add_u32 s94, s94, s44
  s_add_u32 s94, s94, 0x52000
  s_waitcnt vmcnt(17)
  v_lshlrev_b32 v64, 16, v56
  v_and_b32 v65, 0xffff0000, v56
  v_lshlrev_b32 v66, 16, v57
  v_and_b32 v67, 0xffff0000, v57
  v_lshlrev_b32 v68, 16, v58
  v_and_b32 v69, 0xffff0000, v58
  v_lshlrev_b32 v70, 16, v59
  v_and_b32 v71, 0xffff0000, v59
  v_lshlrev_b32 v72, 16, v60
  v_and_b32 v73, 0xffff0000, v60
  v_lshlrev_b32 v74, 16, v61
  v_and_b32 v75, 0xffff0000, v61
  v_lshlrev_b32 v76, 16, v62
  v_and_b32 v77, 0xffff0000, v62
  v_lshlrev_b32 v78, 16, v63
  v_and_b32 v79, 0xffff0000, v63
  v_mul_f32 v80, 0xbfb8aa3b, v64
  v_mul_f32 v81, 0xbfb8aa3b, v65
  v_mul_f32 v82, 0xbfb8aa3b, v66
  v_mul_f32 v83, 0xbfb8aa3b, v67
  v_mul_f32 v84, 0xbfb8aa3b, v68
  v_mul_f32 v85, 0xbfb8aa3b, v69
  v_mul_f32 v86, 0xbfb8aa3b, v70
  v_mul_f32 v87, 0xbfb8aa3b, v71
  v_mul_f32 v88, 0xbfb8aa3b, v72
  v_mul_f32 v89, 0xbfb8aa3b, v73
  v_mul_f32 v90, 0xbfb8aa3b, v74
  v_mul_f32 v91, 0xbfb8aa3b, v75
  v_mul_f32 v92, 0xbfb8aa3b, v76
  v_mul_f32 v93, 0xbfb8aa3b, v77
  v_mul_f32 v94, 0xbfb8aa3b, v78
  v_mul_f32 v95, 0xbfb8aa3b, v79
  v_exp_f32 v80, v80
  v_exp_f32 v81, v81
  v_exp_f32 v82, v82
  v_exp_f32 v83, v83
  v_exp_f32 v84, v84
  v_exp_f32 v85, v85
  v_exp_f32 v86, v86
  v_exp_f32 v87, v87
  v_exp_f32 v88, v88
  v_exp_f32 v89, v89
  v_exp_f32 v90, v90
  v_exp_f32 v91, v91
  v_exp_f32 v92, v92
  v_exp_f32 v93, v93
  v_exp_f32 v94, v94
  v_exp_f32 v95, v95
  v_add_f32 v80, 1.0, v80
  v_add_f32 v81, 1.0, v81
  v_add_f32 v82, 1.0, v82
  v_add_f32 v83, 1.0, v83
  v_add_f32 v84, 1.0, v84
  v_add_f32 v85, 1.0, v85
  v_add_f32 v86, 1.0, v86
  v_add_f32 v87, 1.0, v87
  v_add_f32 v88, 1.0, v88
  v_add_f32 v89, 1.0, v89
  v_add_f32 v90, 1.0, v90
  v_add_f32 v91, 1.0, v91
  v_add_f32 v92, 1.0, v92
  v_add_f32 v93, 1.0, v93
  v_add_f32 v94, 1.0, v94
  v_add_f32 v95, 1.0, v95
  v_rcp_f32 v80, v80
  v_rcp_f32 v81, v81
  v_rcp_f32 v82, v82
  v_rcp_f32 v83, v83
  v_rcp_f32 v84, v84
  v_rcp_f32 v85, v85
  v_rcp_f32 v86, v86
  v_rcp_f32 v87, v87
  v_rcp_f32 v88, v88
  v_rcp_f32 v89, v89
  v_rcp_f32 v90, v90
  v_rcp_f32 v91, v91
  v_rcp_f32 v92, v92
  v_rcp_f32 v93, v93
  v_rcp_f32 v94, v94
  v_rcp_f32 v95, v95
  v_mul_f32 v64, v64, v80
  v_mul_f32 v65, v65, v81
  v_mul_f32 v66, v66, v82
  v_mul_f32 v67, v67, v83
  v_mul_f32 v68, v68, v84
  v_mul_f32 v69, v69, v85
  v_mul_f32 v70, v70, v86
  v_mul_f32 v71, v71, v87
  v_mul_f32 v72, v72, v88
  v_mul_f32 v73, v73, v89
  v_mul_f32 v74, v74, v90
  v_mul_f32 v75, v75, v91
  v_mul_f32 v76, v76, v92
  v_mul_f32 v77, v77, v93
  v_mul_f32 v78, v78, v94
  v_mul_f32 v79, v79, v95
  v_cvt_pk_bf16_f32 v56, v64, v65
  v_cvt_pk_bf16_f32 v57, v66, v67
  v_cvt_pk_bf16_f32 v58, v68, v69
  v_cvt_pk_bf16_f32 v59, v70, v71
  v_cvt_pk_bf16_f32 v60, v72, v73
  v_cvt_pk_bf16_f32 v61, v74, v75
  v_cvt_pk_bf16_f32 v62, v76, v77
  v_cvt_pk_bf16_f32 v63, v78, v79
  s_mov_b32 s54, 0x05040100
  s_mov_b32 s55, 0x07060302
  s_waitcnt vmcnt(15)
  v_perm_b32 v80, v132, v128, s54
  v_perm_b32 v81, v132, v128, s55
  v_perm_b32 v82, v133, v129, s54
  v_perm_b32 v83, v133, v129, s55
  v_perm_b32 v84, v134, v130, s54
  v_perm_b32 v85, v134, v130, s55
  v_perm_b32 v86, v135, v131, s54
  v_perm_b32 v87, v135, v131, s55
  v_dot2_f32_bf16 v96, v80, v56, 0
  v_dot2_f32_bf16 v97, v81, v56, 0
  v_dot2_f32_bf16 v98, v82, v56, 0
  v_dot2_f32_bf16 v99, v83, v56, 0
  v_dot2_f32_bf16 v100, v84, v56, 0
  v_dot2_f32_bf16 v101, v85, v56, 0
  v_dot2_f32_bf16 v102, v86, v56, 0
  v_dot2_f32_bf16 v103, v87, v56, 0
  s_waitcnt vmcnt(13)
  v_perm_b32 v80, v140, v136, s54
  v_perm_b32 v81, v140, v136, s55
  v_perm_b32 v82, v141, v137, s54
  v_perm_b32 v83, v141, v137, s55
  v_perm_b32 v84, v142, v138, s54
  v_perm_b32 v85, v142, v138, s55
  v_perm_b32 v86, v143, v139, s54
  v_perm_b32 v87, v143, v139, s55
  v_dot2_f32_bf16 v96, v80, v57, v96
  v_dot2_f32_bf16 v97, v81, v57, v97
  v_dot2_f32_bf16 v98, v82, v57, v98
  v_dot2_f32_bf16 v99, v83, v57, v99
  v_dot2_f32_bf16 v100, v84, v57, v100
  v_dot2_f32_bf16 v101, v85, v57, v101
  v_dot2_f32_bf16 v102, v86, v57, v102
  v_dot2_f32_bf16 v103, v87, v57, v103
  s_waitcnt vmcnt(11)
  v_perm_b32 v80, v148, v144, s54
  v_perm_b32 v81, v148, v144, s55
  v_perm_b32 v82, v149, v145, s54
  v_perm_b32 v83, v149, v145, s55
  v_perm_b32 v84, v150, v146, s54
  v_perm_b32 v85, v150, v146, s55
  v_perm_b32 v86, v151, v147, s54
  v_perm_b32 v87, v151, v147, s55
  v_dot2_f32_bf16 v96, v80, v58, v96
  v_dot2_f32_bf16 v97, v81, v58, v97
  v_dot2_f32_bf16 v98, v82, v58, v98
  v_dot2_f32_bf16 v99, v83, v58, v99
  v_dot2_f32_bf16 v100, v84, v58, v100
  v_dot2_f32_bf16 v101, v85, v58, v101
  v_dot2_f32_bf16 v102, v86, v58, v102
  v_dot2_f32_bf16 v103, v87, v58, v103
  s_waitcnt vmcnt(9)
  v_perm_b32 v80, v156, v152, s54
  v_perm_b32 v81, v156, v152, s55
  v_perm_b32 v82, v157, v153, s54
  v_perm_b32 v83, v157, v153, s55
  v_perm_b32 v84, v158, v154, s54
  v_perm_b32 v85, v158, v154, s55
  v_perm_b32 v86, v159, v155, s54
  v_perm_b32 v87, v159, v155, s55
  v_dot2_f32_bf16 v96, v80, v59, v96
  v_dot2_f32_bf16 v97, v81, v59, v97
  v_dot2_f32_bf16 v98, v82, v59, v98
  v_dot2_f32_bf16 v99, v83, v59, v99
  v_dot2_f32_bf16 v100, v84, v59, v100
  v_dot2_f32_bf16 v101, v85, v59, v101
  v_dot2_f32_bf16 v102, v86, v59, v102
  v_dot2_f32_bf16 v103, v87, v59, v103
  s_waitcnt vmcnt(7)
  v_perm_b32 v80, v164, v160, s54
  v_perm_b32 v81, v164, v160, s55
  v_perm_b32 v82, v165, v161, s54
  v_perm_b32 v83, v165, v161, s55
  v_perm_b32 v84, v166, v162, s54
  v_perm_b32 v85, v166, v162, s55
  v_perm_b32 v86, v167, v163, s54
  v_perm_b32 v87, v167, v163, s55
  v_dot2_f32_bf16 v96, v80, v60, v96
  v_dot2_f32_bf16 v97, v81, v60, v97
  v_dot2_f32_bf16 v98, v82, v60, v98
  v_dot2_f32_bf16 v99, v83, v60, v99
  v_dot2_f32_bf16 v100, v84, v60, v100
  v_dot2_f32_bf16 v101, v85, v60, v101
  v_dot2_f32_bf16 v102, v86, v60, v102
  v_dot2_f32_bf16 v103, v87, v60, v103
  s_waitcnt vmcnt(5)
  v_perm_b32 v80, v172, v168, s54
  v_perm_b32 v81, v172, v168, s55
  v_perm_b32 v82, v173, v169, s54
  v_perm_b32 v83, v173, v169, s55
  v_perm_b32 v84, v174, v170, s54
  v_perm_b32 v85, v174, v170, s55
  v_perm_b32 v86, v175, v171, s54
  v_perm_b32 v87, v175, v171, s55
  v_dot2_f32_bf16 v96, v80, v61, v96
  v_dot2_f32_bf16 v97, v81, v61, v97
  v_dot2_f32_bf16 v98, v82, v61, v98
  v_dot2_f32_bf16 v99, v83, v61, v99
  v_dot2_f32_bf16 v100, v84, v61, v100
  v_dot2_f32_bf16 v101, v85, v61, v101
  v_dot2_f32_bf16 v102, v86, v61, v102
  v_dot2_f32_bf16 v103, v87, v61, v103
  s_waitcnt vmcnt(3)
  v_perm_b32 v80, v180, v176, s54
  v_perm_b32 v81, v180, v176, s55
  v_perm_b32 v82, v181, v177, s54
  v_perm_b32 v83, v181, v177, s55
  v_perm_b32 v84, v182, v178, s54
  v_perm_b32 v85, v182, v178, s55
  v_perm_b32 v86, v183, v179, s54
  v_perm_b32 v87, v183, v179, s55
  v_dot2_f32_bf16 v96, v80, v62, v96
  v_dot2_f32_bf16 v97, v81, v62, v97
  v_dot2_f32_bf16 v98, v82, v62, v98
  v_dot2_f32_bf16 v99, v83, v62, v99
  v_dot2_f32_bf16 v100, v84, v62, v100
  v_dot2_f32_bf16 v101, v85, v62, v101
  v_dot2_f32_bf16 v102, v86, v62, v102
  v_dot2_f32_bf16 v103, v87, v62, v103
  s_waitcnt vmcnt(1)
  v_perm_b32 v80, v188, v184, s54
  v_perm_b32 v81, v188, v184, s55
  v_perm_b32 v82, v189, v185, s54
  v_perm_b32 v83, v189, v185, s55
  v_perm_b32 v84, v190, v186, s54
  v_perm_b32 v85, v190, v186, s55
  v_perm_b32 v86, v191, v187, s54
  v_perm_b32 v87, v191, v187, s55
  v_dot2_f32_bf16 v96, v80, v63, v96
  v_dot2_f32_bf16 v97, v81, v63, v97
  v_dot2_f32_bf16 v98, v82, v63, v98
  v_dot2_f32_bf16 v99, v83, v63, v99
  v_dot2_f32_bf16 v100, v84, v63, v100
  v_dot2_f32_bf16 v101, v85, v63, v101
  v_dot2_f32_bf16 v102, v86, v63, v102
  v_dot2_f32_bf16 v103, v87, v63, v103
  s_mov_b32 s54, 0xff00ff00
  s_mov_b32 s55, 0xff00ff00
  v_permlane32_swap_b32 v96, v97
  v_permlane32_swap_b32 v98, v99
  v_permlane32_swap_b32 v100, v101
  v_permlane32_swap_b32 v102, v103
  v_add_f32 v96, v96, v97
  v_add_f32 v98, v98, v99
  v_add_f32 v100, v100, v101
  v_add_f32 v102, v102, v103
  v_permlane16_swap_b32 v96, v98
  s_nop 0
  v_permlane16_swap_b32 v100, v102
  v_add_f32 v96, v96, v98
  v_add_f32 v100, v100, v102
  s_nop 0
  v_add_f32_dpp v96, v96, v96 row_ror:8 row_mask:0xf bank_mask:0xf
  v_add_f32_dpp v100, v100, v100 row_ror:8 row_mask:0xf bank_mask:0xf
  v_cndmask_b32 v96, v96, v100, s[54:55]
  s_waitcnt vmcnt(0)
  buffer_store_dword v96, v52, s[24:27], s93 offen sc1
  s_nop 0
  s_branch NOG_142x
NOG_142:
  s_waitcnt vmcnt(0)
NOG_142x:
EP_143:
  v_readfirstlane_b32 s15, v37
  v_readfirstlane_b32 s14, v36
  s_cmp_lg_u32 s15, 0
  s_cbranch_scc1 EPOK_144
  buffer_load_dwordx2 v[36:37], v6, s[40:43], 0 offen sc1
  s_sub_u32 s13, s13, 1
  s_cbranch_scc1 ABORT
  s_waitcnt vmcnt(0)
  s_branch EP_143
EPOK_144:
  ds_write_b64 v26, v[36:37] offset:2448
  s_or_b32 s55, s14, s16
  v_mov_b32 v36, s55
  v_mov_b32 v37, s15
  s_mov_b64 exec, 1
  buffer_store_dwordx2 v[36:37], v6, s[24:27], s52 offen sc1
  s_mov_b64 exec, -1
  s_lshr_b64 s[54:55], s[14:15], 4
  s_mov_b32 s55, s54
PP_145:
  s_add_u32 s44, s46, s47
  s_and_b32 s44, s44, 7
  s_lshl_b32 s44, s44, 8
  s_add_u32 s44, s44, s48
  s_buffer_load_dwordx16 s[56:71], s[24:27], s44 glc
  s_add_u32 s44, s46, s47
  s_add_u32 s44, s44, 1
  s_and_b32 s44, s44, 7
  s_lshl_b32 s44, s44, 8
  s_add_u32 s44, s44, s48
  s_buffer_load_dwordx16 s[72:87], s[24:27], s44 glc
  s_sub_u32 s13, s13, 1
  s_cbranch_scc1 ABORT
  s_waitcnt lgkmcnt(0)
  s_cmp_lg_u64 s[56:57], s[54:55]
  s_cbranch_scc1 PP_145
  s_cmp_lg_u64 s[58:59], s[54:55]
  s_cbranch_scc1 PP_145
  s_cmp_lg_u64 s[60:61], s[54:55]
  s_cbranch_scc1 PP_145
  s_cmp_lg_u64 s[62:63], s[54:55]
  s_cbranch_scc1 PP_145
  s_cmp_lg_u64 s[64:65], s[54:55]
  s_cbranch_scc1 PP_145
  s_cmp_lg_u64 s[66:67], s[54:55]
  s_cbranch_scc1 PP_145
  s_cmp_lg_u64 s[68:69], s[54:55]
  s_cbranch_scc1 PP_145
  s_cmp_lg_u64 s[70:71], s[54:55]
  s_cbranch_scc1 PP_145
  s_add_u32 s46, s46, 1
  s_cmp_lg_u64 s[72:73], s[54:55]
  s_cbranch_scc1 PB_146
  s_cmp_lg_u64 s[74:75], s[54:55]
  s_cbranch_scc1 PB_146
  s_cmp_lg_u64 s[76:77], s[54:55]
  s_cbranch_scc1 PB_146
  s_cmp_lg_u64 s[78:79], s[54:55]
  s_cbranch_scc1 PB_146
  s_cmp_lg_u64 s[80:81], s[54:55]
  s_cbranch_scc1 PB_146
  s_cmp_lg_u64 s[82:83], s[54:55]
  s_cbranch_scc1 PB_146
  s_cmp_lg_u64 s[84:85], s[54:55]
  s_cbranch_scc1 PB_146
  s_cmp_lg_u64 s[86:87], s[54:55]
  s_cbranch_scc1 PB_146
  s_add_u32 s46, s46, 1
PB_146:
  v_cmp_ge_u32 vcc, s46, v9
  s_nop 0
  s_bcnt1_i32_b64 s53, vcc
  v_mov_b32 v5, s53
  ds_write_b32 v3, v5
  s_cmp_lt_u32 s46, 2
  s_cbranch_scc1 PP_145
  s_cmp_ge_u32 s5, 24
  s_cbranch_scc1 NOG_147
  s_waitcnt vmcnt(0)
  v_mov_b32 v36, s14
  v_mov_b32 v37, s15
  s_mov_b64 exec, 1
  buffer_store_dwordx2 v[36:37], v6, s[24:27], s94 offen sc1
  s_mov_b64 exec, -1
NOG_147:
PP_148:
  buffer_load_dwordx4 v[12:15], v8, s[24:27], s48 offen sc1
  s_sub_u32 s13, s13, 1
  s_cbranch_scc1 ABORT
  s_waitcnt vmcnt(0)
  v_cmp_ne_u64 s[50:51], s[54:55], v[12:13]
  v_cmp_ne_u64 vcc, s[54:55], v[14:15]
  s_nop 0
  s_or_b64 s[50:51], s[50:51], vcc
  s_ff1_i32_b64 s52, s[50:51]
  s_lshr_b32 s52, s52, 2
  v_cmp_ge_u32 vcc, s52, v9
  s_nop 0
  s_bcnt1_i32_b64 s53, vcc
  s_add_u32 s53, s53, 0
  v_mov_b32 v5, s53
  ds_write_b32 v3, v5
  s_cmp_lg_u64 s[50:51], 0
  s_cbranch_scc1 PP_148
  s_or_b32 s54, s14, s16
VD_149:
  buffer_load_dwordx2 v[12:13], v10, s[24:27], 0 offen sc1
  s_sub_u32 s13, s13, 1
  s_cbranch_scc1 ABORT
  s_waitcnt vmcnt(0)
  v_cmp_ne_u32 s[50:51], s54, v12
  v_and_b32 v12, -16, v12
  v_cmp_ne_u64 vcc, s[14:15], v[12:13]
  s_cbranch_vccnz VD_149
  s_cmp_eq_u64 s[50:51], 0
  s_cselect_b32 s17, 1, 2
  v_mov_b32 v20, s17
  ds_write_b32 v11, v20
  v_and_b32 v2, 7, v1
  v_cmp_gt_u32 vcc, 4, v2
  s_nop 1
  v_cndmask_b32 v4, 6, v2, vcc
  v_lshlrev_b32 v2, 2, v2
  v_lshl_add_u32 v2, v4, 8, v2
  v_add_u32 v2, 157696, v2
  s_movk_i32 s47, 2
  s_call_b64 s[18:19], WAITC
  s_lshl_b32 s44, s8, 1
  v_and_b32 v45, 1, v42
  v_add_u32 v45, s44, v45
  v_bfe_u32 v46, v42, 1, 1
  v_lshl_add_u32 v45, v46, 3, v45
  s_add_u32 s44, s10, 16
  v_mov_b32 v46, s44
  s_add_u32 s44, s10, 32
  v_mov_b32 v47, s44
  v_cmp_eq_u32 vcc, 4, v42
  s_nop 1
  v_cndmask_b32 v45, v45, v46, vcc
  v_cmp_eq_u32 vcc, 5, v42
  s_nop 1
  v_cndmask_b32 v45, v45, v47, vcc
  v_add_u32 v47, 8, v47
  v_cmp_eq_u32 vcc, 6, v42
  s_nop 1
  v_cndmask_b32 v45, v45, v47, vcc
  s_add_u32 s44, s4, 24
  v_mov_b32 v46, s44
  v_cmp_eq_u32 vcc, 7, v42
  s_nop 1
  v_cndmask_b32 v45, v45, v46, vcc
  v_lshlrev_b32 v45, 6, v45
  v_and_b32 v48, 3, v1
  v_lshl_add_u32 v45, v48, 3, v45
  v_add_u32 v10, 335872, v45
  s_nop 2
  s_branch AP_150f
AP_150:
  s_sleep 16
AP_150f:
  buffer_load_dwordx2 v[12:13], v10, s[24:27], 0 offen sc1
  s_sub_u32 s13, s13, 1
  s_cbranch_scc1 ABORT
  s_waitcnt vmcnt(0)
  v_cmp_ne_u64 vcc, s[14:15], v[12:13]
  s_cbranch_vccnz AP_150
  s_nop 3
  v_lshlrev_b32 v44, 3, v1
  v_lshlrev_b32 v45, 2, v1
  s_lshl_b32 s52, s8, 9
  s_add_u32 s52, s52, 0x60000
  s_lshl_b32 s53, s10, 8
  s_add_u32 s53, s53, 0x61000
  s_add_u32 s54, s53, 4096
  s_lshl_b32 s55, s4, 8
  s_add_u32 s55, s55, 0x61800
  buffer_load_dwordx2 v[64:65], v44, s[24:27], s52 offen sc1
  buffer_load_dwordx2 v[66:67], v44, s[24:27], s52 offen offset:2048 sc1
  s_add_u32 s52, s52, 12288
  buffer_load_dwordx2 v[72:73], v44, s[24:27], s52 offen sc1
  buffer_load_dwordx2 v[74:75], v44, s[24:27], s52 offen offset:2048 sc1
  s_add_u32 s52, s52, 12288
  buffer_load_dwordx2 v[80:81], v44, s[24:27], s52 offen sc1
  buffer_load_dwordx2 v[82:83], v44, s[24:27], s52 offen offset:2048 sc1
  s_add_u32 s52, s52, 12288
  buffer_load_dwordx2 v[88:89], v44, s[24:27], s52 offen sc1
  buffer_load_dwordx2 v[90:91], v44, s[24:27], s52 offen offset:2048 sc1
  v_lshrrev_b32 v46, 2, v1
  v_and_b32 v47, 3, v1
  v_lshl_add_u32 v46, v46, 3, v47
  v_lshlrev_b32 v46, 2, v46
  v_add_u32 v46, 160256, v46
  v_add_u32 v47, 157696, v45
  s_waitcnt vmcnt(0)
  v_add_f32 v64, v64, v80
  v_add_f32 v65, v65, v81
  v_add_f32 v66, v66, v82
  v_add_f32 v67, v67, v83
  v_add_f32 v72, v72, v88
  v_add_f32 v73, v73, v89
  v_add_f32 v74, v74, v90
  v_add_f32 v75, v75, v91
  v_add_f32 v64, v64, v72
  v_add_f32 v65, v65, v73
  v_add_f32 v66, v66, v74
  v_add_f32 v67, v67, v75
  v_cvt_pk_bf16_f32 v64, v64, v64
  v_lshlrev_b32 v64, 16, v64
  v_cvt_pk_bf16_f32 v65, v65, v65
  v_lshlrev_b32 v65, 16, v65
  v_cvt_pk_bf16_f32 v66, v66, v66
  v_lshlrev_b32 v66, 16, v66
  v_cvt_pk_bf16_f32 v67, v67, v67
  v_lshlrev_b32 v67, 16, v67
  v_add_f32 v66, 1.0, v66
  v_add_f32 v67, 1.0, v67
  v_cvt_pk_bf16_f32 v66, v66, v66
  v_lshlrev_b32 v66, 16, v66
  v_cvt_pk_bf16_f32 v67, v67, v67
  v_lshlrev_b32 v67, 16, v67
  ds_write2_b32 v46, v66, v67 offset0:0 offset1:4
  ds_write2_b32 v46, v64, v65 offset0:128 offset1:132
  v_mov_b32 v5, 1
  ds_add_u32 v7, v5
  buffer_load_dword v68, v45, s[24:27], s53 offen sc1
  buffer_load_dword v69, v45, s[24:27], s54 offen sc1
  buffer_load_dword v70, v45, s[24:27], s54 offen offset:2048 sc1
  buffer_load_dword v71, v45, s[24:27], s55 offen sc1
  s_add_u32 s53, s53, 12288
  s_add_u32 s54, s54, 12288
  s_add_u32 s55, s55, 12288
  buffer_load_dword v76, v45, s[24:27], s53 offen sc1
  buffer_load_dword v77, v45, s[24:27], s54 offen sc1
  buffer_load_dword v78, v45, s[24:27], s54 offen offset:2048 sc1
  buffer_load_dword v79, v45, s[24:27], s55 offen sc1
  s_add_u32 s53, s53, 12288
  s_add_u32 s54, s54, 12288
  s_add_u32 s55, s55, 12288
  buffer_load_dword v84, v45, s[24:27], s53 offen sc1
  buffer_load_dword v85, v45, s[24:27], s54 offen sc1
  buffer_load_dword v86, v45, s[24:27], s54 offen offset:2048 sc1
  buffer_load_dword v87, v45, s[24:27], s55 offen sc1
  s_add_u32 s53, s53, 12288
  s_add_u32 s54, s54, 12288
  s_add_u32 s55, s55, 12288
  buffer_load_dword v92, v45, s[24:27], s53 offen sc1
  buffer_load_dword v93, v45, s[24:27], s54 offen sc1
  buffer_load_dword v94, v45, s[24:27], s54 offen offset:2048 sc1
  buffer_load_dword v95, v45, s[24:27], s55 offen sc1
  s_lshl_b32 s52, s4, 6
  s_add_u32 s52, s52, 0x52800
  v_lshl_add_u32 v10, v48, 3, s52
  s_waitcnt vmcnt(0)
  v_add_f32 v68, v68, v84
  v_add_f32 v69, v69, v85
  v_add_f32 v70, v70, v86
  v_add_f32 v71, v71, v87
  v_add_f32 v76, v76, v92
  v_add_f32 v77, v77, v93
  v_add_f32 v78, v78, v94
  v_add_f32 v79, v79, v95
  v_add_f32 v68, v68, v76
  v_add_f32 v69, v69, v77
  v_add_f32 v70, v70, v78
  v_add_f32 v71, v71, v79
  v_cvt_pk_bf16_f32 v68, v68, v68
  v_lshlrev_b32 v68, 16, v68
  v_cvt_pk_bf16_f32 v69, v69, v69
  v_lshlrev_b32 v69, 16, v69
  v_cvt_pk_bf16_f32 v70, v70, v70
  v_lshlrev_b32 v70, 16, v70
  v_cvt_pk_bf16_f32 v71, v71, v71
  v_lshlrev_b32 v71, 16, v71
  v_add_f32 v69, 1.0, v69
  v_cvt_pk_bf16_f32 v69, v69, v69
  v_lshlrev_b32 v69, 16, v69
  ds_write_b32 v47, v68 offset:3840
  ds_write_b32 v47, v69 offset:4096
  ds_write_b32 v47, v70 offset:4352
  ds_write_b32 v47, v71 offset:5632
  s_branch AP_151f
AP_151:
  s_sleep 16
AP_151f:
  buffer_load_dwordx2 v[12:13], v10, s[24:27], 0 offen sc1
  s_sub_u32 s13, s13, 1
  s_cbranch_scc1 ABORT
  s_waitcnt vmcnt(0)
  v_cmp_ne_u64 vcc, s[14:15], v[12:13]
  s_cbranch_vccnz AP_151
  s_nop 3
  s_lshl_b32 s55, s4, 8
  s_add_u32 s55, s55, 0x62000
  buffer_load_dword v80, v45, s[24:27], s55 offen sc1
  s_add_u32 s55, s55, 12288
  buffer_load_dword v81, v45, s[24:27], s55 offen sc1
  s_add_u32 s55, s55, 12288
  buffer_load_dword v82, v45, s[24:27], s55 offen sc1
  s_add_u32 s55, s55, 12288
  buffer_load_dword v83, v45, s[24:27], s55 offen sc1
  s_waitcnt vmcnt(0)
  s_cmp_ge_u32 s5, 22
  s_cbranch_scc1 NOUV_152
  v_lshlrev_b32 v44, 5, v42
  v_add_u32 v44, 163328, v44
  v_add_f32 v80, v80, v82
  v_add_f32 v81, v81, v83
  v_add_f32 v80, v80, v81
  v_cvt_pk_bf16_f32 v80, v80, v80
  v_lshlrev_b32 v80, 16, v80
  v_add_f32 v80, 1.0, v80
  v_cvt_pk_bf16_f32 v80, v80, v80
  v_lshlrev_b32 v80, 16, v80
  ds_write_b32 v47, v80 offset:5888
  v_mov_b32 v5, 8
  s_mov_b64 exec, 1
  ds_add_u32 v26, v5 offset:2304
  s_mov_b64 exec, -1
NOUV_152:
  v_and_b32 v8, 63, v1
  s_lshl_b32 s44, s10, 3
  v_add_u32 v44, s44, v1
  v_and_b32 v44, 24, v44
  v_and_b32 v8, 39, v1
  v_or_b32 v8, v44, v8
  v_lshlrev_b32 v8, 3, v8
  s_lshl_b32 s48, s9, 9
  s_add_u32 s48, s48, 0x5c000
  v_mov_b32 v9, -1
  v_writelane_b32 v9, 1, 0
  v_writelane_b32 v9, 2, 1
  v_writelane_b32 v9, 3, 2
  v_writelane_b32 v9, 5, 3
  v_writelane_b32 v9, 6, 4
  v_writelane_b32 v9, 7, 5
  v_writelane_b32 v9, 8, 6
  v_writelane_b32 v9, 8, 7
  v_writelane_b32 v9, 8, 8
  v_and_b32 v2, 7, v1
  v_cmp_gt_u32 vcc, 4, v2
  s_nop 1
  v_cndmask_b32 v4, 6, v2, vcc
  v_lshlrev_b32 v2, 2, v2
  v_lshl_add_u32 v2, v4, 8, v2
  v_add_u32 v2, 157696, v2
  s_movk_i32 s47, 16
  s_call_b64 s[18:19], WAITC
PP_153:
  buffer_load_dwordx2 v[12:13], v8, s[24:27], s48 offen sc1
  s_sub_u32 s13, s13, 1
  s_cbranch_scc1 ABORT
  s_waitcnt vmcnt(0)
  v_cmp_ne_u64 vcc, s[14:15], v[12:13]
  s_nop 0
  s_mov_b64 s[50:51], vcc
  s_ff1_i32_b64 s52, s[50:51]
  s_lshr_b32 s52, s52, 3
  v_cmp_ge_u32 vcc, s52, v9
  s_nop 0
  s_bcnt1_i32_b64 s53, vcc
  s_add_u32 s53, s53, 17
  v_mov_b32 v5, s53
  ds_write_b32 v3, v5
  s_cmp_lg_u64 s[50:51], 0
  s_cbranch_scc1 PP_153
  s_cmp_eq_u32 s12, 15
  s_cbranch_scc1 SK3_154
  s_mul_i32 s52, s12, 3
  s_lshr_b32 s52, s52, 1
  v_and_b32 v44, 1, v42
  v_add_u32 v44, s52, v44
  v_min_u32 v44, 21, v44
  v_lshlrev_b32 v44, 6, v44
  v_lshl_add_u32 v44, v43, 3, v44
  v_add_u32 v10, 339968, v44
  v_and_b32 v44, 31, v1
  v_min_u32 v44, 23, v44
  v_lshlrev_b32 v44, 4, v44
  v_lshrrev_b32 v45, 5, v1
  v_mul_u32_u24 v46, 6144, v45
  v_add_u32 v46, v46, v44
  v_lshl_add_u32 v44, v45, 9, v44
  v_add_u32 v44, 162304, v44
  s_mul_i32 s52, s12, 384
  s_add_u32 s52, s52, 0x80000
  v_and_b32 v2, 7, v1
  v_cmp_gt_u32 vcc, 4, v2
  s_nop 1
  v_cndmask_b32 v4, 6, v2, vcc
  v_lshlrev_b32 v2, 2, v2
  v_lshl_add_u32 v2, v4, 8, v2
  v_add_u32 v2, 157696, v2
  s_movk_i32 s47, 22
  s_call_b64 s[18:19], WAITC
  s_branch AP_155f
AP_155:
  s_sleep 16
AP_155f:
  buffer_load_dwordx2 v[12:13], v10, s[24:27], 0 offen sc1
  s_sub_u32 s13, s13, 1
  s_cbranch_scc1 ABORT
  s_waitcnt vmcnt(0)
  v_cmp_ne_u64 vcc, s[14:15], v[12:13]
  s_cbranch_vccnz AP_155
  s_nop 3
  buffer_load_dwordx4 v[64:67], v46, s[24:27], s52 offen sc1
  s_add_u32 s52, s52, 12288
  buffer_load_dwordx4 v[68:71], v46, s[24:27], s52 offen sc1
  s_add_u32 s52, s52, 12288
  buffer_load_dwordx4 v[72:75], v46, s[24:27], s52 offen sc1
  s_add_u32 s52, s52, 12288
  buffer_load_dwordx4 v[76:79], v46, s[24:27], s52 offen sc1
  s_add_u32 s52, s52, 12288
  buffer_load_dwordx4 v[80:83], v46, s[24:27], s52 offen sc1
  s_add_u32 s52, s52, 12288
  buffer_load_dwordx4 v[84:87], v46, s[24:27], s52 offen sc1
  s_add_u32 s52, s52, 12288
  buffer_load_dwordx4 v[88:91], v46, s[24:27], s52 offen sc1
  s_add_u32 s52, s52, 12288
  buffer_load_dwordx4 v[92:95], v46, s[24:27], s52 offen sc1
  v_lshlrev_b32 v8, 3, v1
  s_lshl_b32 s48, s11, 9
  s_add_u32 s48, s48, 0x56000
  v_mov_b32 v9, -1
  v_writelane_b32 v9, 2, 0
  v_writelane_b32 v9, 3, 1
  v_writelane_b32 v9, 4, 2
  v_writelane_b32 v9, 5, 3
  v_writelane_b32 v9, 6, 4
  v_writelane_b32 v9, 7, 5
  v_writelane_b32 v9, 8, 6
  v_writelane_b32 v9, 8, 7
  v_writelane_b32 v9, 8, 8
  v_mov_b32 v5, 1
  s_waitcnt vmcnt(0)
  v_add_f32 v64, v64, v80
  v_add_f32 v65, v65, v81
  v_add_f32 v66, v66, v82
  v_add_f32 v67, v67, v83
  v_add_f32 v68, v68, v84
  v_add_f32 v69, v69, v85
  v_add_f32 v70, v70, v86
  v_add_f32 v71, v71, v87
  v_add_f32 v72, v72, v88
  v_add_f32 v73, v73, v89
  v_add_f32 v74, v74, v90
  v_add_f32 v75, v75, v91
  v_add_f32 v76, v76, v92
  v_add_f32 v77, v77, v93
  v_add_f32 v78, v78, v94
  v_add_f32 v79, v79, v95
  v_add_f32 v64, v64, v72
  v_add_f32 v65, v65, v73
  v_add_f32 v66, v66, v74
  v_add_f32 v67, v67, v75
  v_add_f32 v68, v68, v76
  v_add_f32 v69, v69, v77
  v_add_f32 v70, v70, v78
  v_add_f32 v71, v71, v79
  v_add_f32 v64, v64, v68
  v_add_f32 v65, v65, v69
  v_add_f32 v66, v66, v70
  v_add_f32 v67, v67, v71
  ds_write_b128 v44, v[64:67]
  ds_add_u32 v7, v5
  v_and_b32 v2, 7, v1
  v_cmp_gt_u32 vcc, 4, v2
  s_nop 1
  v_cndmask_b32 v4, 6, v2, vcc
  v_lshlrev_b32 v2, 2, v2
  v_lshl_add_u32 v2, v4, 8, v2
  v_add_u32 v2, 157696, v2
  s_movk_i32 s47, 24
  s_call_b64 s[18:19], WAITC
PP_156:
  buffer_load_dwordx2 v[12:13], v8, s[24:27], s48 offen sc1
  s_sub_u32 s13, s13, 1
  s_cbranch_scc1 ABORT
  s_waitcnt vmcnt(0)
  v_cmp_ne_u64 vcc, s[14:15], v[12:13]
  s_nop 0
  s_mov_b64 s[50:51], vcc
  s_ff1_i32_b64 s52, s[50:51]
  s_lshr_b32 s52, s52, 3
  v_cmp_ge_u32 vcc, s52, v9
  s_nop 0
  s_bcnt1_i32_b64 s53, vcc
  s_add_u32 s53, s53, 26
  v_mov_b32 v5, s53
  ds_write_b32 v3, v5
  s_cmp_lg_u64 s[50:51], 0
  s_cbranch_scc1 PP_156
SK3_154:
  v_lshrrev_b32 v44, 1, v1
  v_min_u32 v44, 14, v44
  v_and_b32 v45, 1, v1
  v_lshl_add_u32 v44, v44, 2, v45
  v_lshlrev_b32 v8, 3, v44
  s_and_b32 s45, s9, 1
  s_lshl_b32 s48, s11, 9
  s_lshl_b32 s44, s45, 4
  s_add_u32 s48, s48, s44
  s_add_u32 s48, s48, 0x58000
  v_mov_b32 v9, -1
  v_writelane_b32 v9, 3, 0
  v_writelane_b32 v9, 4, 1
  v_writelane_b32 v9, 5, 2
  v_writelane_b32 v9, 7, 3
  v_writelane_b32 v9, 8, 4
  v_writelane_b32 v9, 9, 5
  v_writelane_b32 v9, 11, 6
  v_writelane_b32 v9, 12, 7
  v_writelane_b32 v9, 13, 8
  v_writelane_b32 v9, 15, 9
  v_writelane_b32 v9, 15, 10
  v_writelane_b32 v9, 15, 11
  v_and_b32 v2, 7, v1
  v_cmp_gt_u32 vcc, 4, v2
  s_nop 1
  v_cndmask_b32 v4, 6, v2, vcc
  v_lshlrev_b32 v2, 2, v2
  v_lshl_add_u32 v2, v4, 8, v2
  v_add_u32 v2, 157696, v2
  s_movk_i32 s47, 32
  s_call_b64 s[18:19], WAITC
PP_157:
  buffer_load_dwordx2 v[12:13], v8, s[24:27], s48 offen sc1
  s_sub_u32 s13, s13, 1
  s_cbranch_scc1 ABORT
  s_waitcnt vmcnt(0)
  v_cmp_ne_u64 vcc, s[14:15], v[12:13]
  s_nop 0
  s_mov_b64 s[50:51], vcc
  s_ff1_i32_b64 s52, s[50:51]
  s_lshr_b32 s52, s52, 1
  v_cmp_ge_u32 vcc, s52, v9
  s_nop 0
  s_bcnt1_i32_b64 s53, vcc
  s_add_u32 s53, s53, 35
  v_mov_b32 v5, s53
  ds_write_b32 v3, v5
  s_cmp_lg_u64 s[50:51], 0
  s_cbranch_scc1 PP_157
  s_endpgm
AUXW:
  v_mov_b32 v6, 0
  v_mov_b32 v7, 157696
  s_add_u32 s24, s88, 0x1800000
  s_addc_u32 s25, s89, 0
  s_and_b32 s25, s25, 0xffff
  s_mov_b32 s26, 0x100000
  s_mov_b32 s27, 0x00020000
  s_lshr_b32 s59, s96, 2
  s_lshl_b32 s60, s59, 7
  s_add_u32 s60, s60, 0x5a000
  buffer_load_dword v56, v6, s[24:27], s60 offen sc1
  v_and_b32 v36, 15, v1
  v_lshrrev_b32 v37, 4, v1
  v_bfe_u32 v38, v1, 1, 3
  v_xor_b32 v38, v37, v38
  v_lshlrev_b32 v38, 4, v38
  v_lshl_add_u32 v38, v36, 7, v38
  v_xor_b32 v8, 0, v38
  v_add_u32 v10, 0x10000, v8
  v_add_u32 v12, 0x20000, v8
  v_xor_b32 v9, 64, v38
  v_add_u32 v11, 0x10000, v9
  v_add_u32 v13, 0x20000, v9
  v_mov_b32 v16, 0x3f803f80
  v_mov_b32 v17, 0x3f803f80
  v_mov_b32 v18, 0x3f803f80
  v_mov_b32 v19, 0x3f803f80
  v_mov_b32 v20, 0
  v_mov_b32 v21, 0
  v_mov_b32 v22, 0
  v_mov_b32 v23, 0
  v_mov_b32 v24, 0
  v_mov_b32 v25, 0
  v_mov_b32 v26, 0
  v_mov_b32 v27, 0
  v_mov_b32 v28, 0
  v_mov_b32 v29, 0
  v_mov_b32 v30, 0
  v_mov_b32 v31, 0
  v_mov_b32 v32, 0
  v_mov_b32 v33, 0
  v_mov_b32 v34, 0
  v_mov_b32 v35, 0
  v_and_b32 v2, 1, v1
  v_mul_u32_u24 v2, 260, v2
  v_add_u32 v2, 158720, v2
  v_lshlrev_b32 v3, 2, v1
  v_add_u32 v3, 159232, v3
  v_mov_b32 v5, 1
  v_lshl_add_u32 v36, v36, 2, v7
  s_and_b32 s44, s96, 1
  s_cselect_b32 s54, s72, s70
  s_cselect_b32 s55, s73, s71
  s_mov_b32 s28, s54
  s_and_b32 s29, s55, 0xffff
  s_mov_b32 s30, 0x80000
  s_mov_b32 s31, 0x00020000
  s_mov_b32 s40, s78
  s_and_b32 s41, s79, 0xffff
  s_mov_b32 s42, 0x158000
  s_mov_b32 s43, 0x00020000
  s_lshr_b32 s56, s96, 1
  s_lshl_b32 s56, s56, 12
  s_mul_i32 s57, s96, 5504
  v_and_b32 v54, 31, v1
  v_lshlrev_b32 v54, 7, v54
  v_min_u32 v55, 42, v1
  v_lshlrev_b32 v55, 7, v55
  s_nop 2
SP_158:
  s_sleep 1
  ds_read_b32 v4, v7 offset:2304
  s_sub_u32 s13, s13, 1
  s_cbranch_scc1 ABORT
  s_waitcnt lgkmcnt(0)
  v_cmp_gt_u32 vcc, 8, v4
  s_cbranch_vccnz SP_158
  s_setprio 3
  buffer_load_dword v56, v54, s[28:31], s56 offen
  buffer_load_dword v57, v55, s[40:43], s57 offen
  s_mov_b32 s32, s76
  s_and_b32 s33, s77, 0xffff
  s_mov_b32 s34, 0x158000
  s_mov_b32 s35, 0x00020000
  s_min_u32 s61, s5, 21
  v_lshrrev_b32 v42, 3, v1
  v_and_b32 v43, 7, v1
  v_mul_u32_u24 v45, 22016, v42
  v_lshl_add_u32 v45, v43, 4, v45
  s_mul_i32 s45, s4, 176128
  s_lshl_b32 s44, s61, 7
  s_add_u32 s45, s45, s44
  s_cmp_ge_u32 s5, 22
  s_cbranch_scc1 NOUVA
  buffer_load_dwordx4 v[176:179], v45, s[32:35], s45 offen
  s_add_u32 s45, s45, 2752
  buffer_load_dwordx4 v[180:183], v45, s[32:35], s45 offen
  s_add_u32 s45, s45, 2752
  buffer_load_dwordx4 v[184:187], v45, s[32:35], s45 offen
  s_add_u32 s45, s45, 2752
  buffer_load_dwordx4 v[188:191], v45, s[32:35], s45 offen
  s_add_u32 s45, s45, 2752
  buffer_load_dwordx4 v[192:195], v45, s[32:35], s45 offen
  s_add_u32 s45, s45, 2752
  buffer_load_dwordx4 v[196:199], v45, s[32:35], s45 offen
  s_add_u32 s45, s45, 2752
  buffer_load_dwordx4 v[200:203], v45, s[32:35], s45 offen
  s_add_u32 s45, s45, 2752
  buffer_load_dwordx4 v[204:207], v45, s[32:35], s45 offen
NOUVA:
  s_setprio 0
SP_159:
  s_sleep 1
  ds_read_b32 v4, v2 offset:0
  s_sub_u32 s13, s13, 1
  s_cbranch_scc1 ABORT
  s_waitcnt lgkmcnt(0)
  v_cmp_gt_u32 vcc, 2, v4
  s_cbranch_vccnz SP_159
  ds_read_b128 v[64:67], v8 offset:0
  ds_read_b128 v[68:71], v8 offset:2048
  ds_read_b128 v[72:75], v8 offset:4096
  ds_read_b128 v[76:79], v8 offset:6144
  ds_read_b128 v[80:83], v9 offset:0
  ds_read_b128 v[84:87], v9 offset:2048
  ds_read_b128 v[88:91], v9 offset:4096
  ds_read_b128 v[92:95], v9 offset:6144
  ds_read_b128 v[96:99], v8 offset:8192
  ds_read_b128 v[100:103], v8 offset:10240
  ds_read_b128 v[104:107], v8 offset:12288
  ds_read_b128 v[108:111], v8 offset:14336
  ds_read_b128 v[112:115], v9 offset:8192
  ds_read_b128 v[116:119], v9 offset:10240
  ds_read_b128 v[120:123], v9 offset:12288
  ds_read_b128 v[124:127], v9 offset:14336
  ds_add_u32 v3, v5
  s_waitcnt lgkmcnt(13)
  v_dot2_f32_bf16 v20, v64, v16, v20
  v_dot2_f32_bf16 v21, v68, v16, v21
  v_dot2_f32_bf16 v22, v72, v16, v22
  v_dot2_f32_bf16 v23, v76, v16, v23
  v_dot2_f32_bf16 v20, v65, v16, v20
  v_dot2_f32_bf16 v21, v69, v16, v21
  v_dot2_f32_bf16 v22, v73, v16, v22
  v_dot2_f32_bf16 v23, v77, v16, v23
  v_dot2_f32_bf16 v20, v66, v16, v20
  v_dot2_f32_bf16 v21, v70, v16, v21
  v_dot2_f32_bf16 v22, v74, v16, v22
  v_dot2_f32_bf16 v23, v78, v16, v23
  v_dot2_f32_bf16 v20, v67, v16, v20
  v_dot2_f32_bf16 v21, v71, v16, v21
  v_dot2_f32_bf16 v22, v75, v16, v22
  v_dot2_f32_bf16 v23, v79, v16, v23
  s_waitcnt lgkmcnt(9)
  v_dot2_f32_bf16 v20, v80, v16, v20
  v_dot2_f32_bf16 v21, v84, v16, v21
  v_dot2_f32_bf16 v22, v88, v16, v22
  v_dot2_f32_bf16 v23, v92, v16, v23
  v_dot2_f32_bf16 v20, v81, v16, v20
  v_dot2_f32_bf16 v21, v85, v16, v21
  v_dot2_f32_bf16 v22, v89, v16, v22
  v_dot2_f32_bf16 v23, v93, v16, v23
  v_dot2_f32_bf16 v20, v82, v16, v20
  v_dot2_f32_bf16 v21, v86, v16, v21
  v_dot2_f32_bf16 v22, v90, v16, v22
  v_dot2_f32_bf16 v23, v94, v16, v23
  v_dot2_f32_bf16 v20, v83, v16, v20
  v_dot2_f32_bf16 v21, v87, v16, v21
  v_dot2_f32_bf16 v22, v91, v16, v22
  v_dot2_f32_bf16 v23, v95, v16, v23
  s_waitcnt lgkmcnt(5)
  v_dot2_f32_bf16 v20, v96, v16, v20
  v_dot2_f32_bf16 v21, v100, v16, v21
  v_dot2_f32_bf16 v22, v104, v16, v22
  v_dot2_f32_bf16 v23, v108, v16, v23
  v_dot2_f32_bf16 v20, v97, v16, v20
  v_dot2_f32_bf16 v21, v101, v16, v21
  v_dot2_f32_bf16 v22, v105, v16, v22
  v_dot2_f32_bf16 v23, v109, v16, v23
  v_dot2_f32_bf16 v20, v98, v16, v20
  v_dot2_f32_bf16 v21, v102, v16, v21
  v_dot2_f32_bf16 v22, v106, v16, v22
  v_dot2_f32_bf16 v23, v110, v16, v23
  v_dot2_f32_bf16 v20, v99, v16, v20
  v_dot2_f32_bf16 v21, v103, v16, v21
  v_dot2_f32_bf16 v22, v107, v16, v22
  v_dot2_f32_bf16 v23, v111, v16, v23
  s_waitcnt lgkmcnt(1)
  v_dot2_f32_bf16 v20, v112, v16, v20
  v_dot2_f32_bf16 v21, v116, v16, v21
  v_dot2_f32_bf16 v22, v120, v16, v22
  v_dot2_f32_bf16 v23, v124, v16, v23
  v_dot2_f32_bf16 v20, v113, v16, v20
  v_dot2_f32_bf16 v21, v117, v16, v21
  v_dot2_f32_bf16 v22, v121, v16, v22
  v_dot2_f32_bf16 v23, v125, v16, v23
  v_dot2_f32_bf16 v20, v114, v16, v20
  v_dot2_f32_bf16 v21, v118, v16, v21
  v_dot2_f32_bf16 v22, v122, v16, v22
  v_dot2_f32_bf16 v23, v126, v16, v23
  v_dot2_f32_bf16 v20, v115, v16, v20
  v_dot2_f32_bf16 v21, v119, v16, v21
  v_dot2_f32_bf16 v22, v123, v16, v22
  v_dot2_f32_bf16 v23, v127, v16, v23
  s_nop 2
SP_160:
  s_sleep 1
  ds_read_b32 v4, v2 offset:0
  s_sub_u32 s13, s13, 1
  s_cbranch_scc1 ABORT
  s_waitcnt lgkmcnt(0)
  v_cmp_gt_u32 vcc, 3, v4
  s_cbranch_vccnz SP_160
  ds_read_b128 v[64:67], v8 offset:16384
  ds_read_b128 v[68:71], v8 offset:18432
  ds_read_b128 v[72:75], v8 offset:20480
  ds_read_b128 v[76:79], v8 offset:22528
  ds_read_b128 v[80:83], v9 offset:16384
  ds_read_b128 v[84:87], v9 offset:18432
  ds_read_b128 v[88:91], v9 offset:20480
  ds_read_b128 v[92:95], v9 offset:22528
  ds_read_b128 v[96:99], v8 offset:24576
  ds_read_b128 v[100:103], v8 offset:26624
  ds_read_b128 v[104:107], v8 offset:28672
  ds_read_b128 v[108:111], v8 offset:30720
  ds_read_b128 v[112:115], v9 offset:24576
  ds_read_b128 v[116:119], v9 offset:26624
  ds_read_b128 v[120:123], v9 offset:28672
  ds_read_b128 v[124:127], v9 offset:30720
  ds_add_u32 v3, v5
  s_waitcnt lgkmcnt(13)
  v_dot2_f32_bf16 v24, v64, v16, v24
  v_dot2_f32_bf16 v25, v68, v16, v25
  v_dot2_f32_bf16 v26, v72, v16, v26
  v_dot2_f32_bf16 v27, v76, v16, v27
  v_dot2_f32_bf16 v24, v65, v16, v24
  v_dot2_f32_bf16 v25, v69, v16, v25
  v_dot2_f32_bf16 v26, v73, v16, v26
  v_dot2_f32_bf16 v27, v77, v16, v27
  v_dot2_f32_bf16 v24, v66, v16, v24
  v_dot2_f32_bf16 v25, v70, v16, v25
  v_dot2_f32_bf16 v26, v74, v16, v26
  v_dot2_f32_bf16 v27, v78, v16, v27
  v_dot2_f32_bf16 v24, v67, v16, v24
  v_dot2_f32_bf16 v25, v71, v16, v25
  v_dot2_f32_bf16 v26, v75, v16, v26
  v_dot2_f32_bf16 v27, v79, v16, v27
  s_waitcnt lgkmcnt(9)
  v_dot2_f32_bf16 v24, v80, v16, v24
  v_dot2_f32_bf16 v25, v84, v16, v25
  v_dot2_f32_bf16 v26, v88, v16, v26
  v_dot2_f32_bf16 v27, v92, v16, v27
  v_dot2_f32_bf16 v24, v81, v16, v24
  v_dot2_f32_bf16 v25, v85, v16, v25
  v_dot2_f32_bf16 v26, v89, v16, v26
  v_dot2_f32_bf16 v27, v93, v16, v27
  v_dot2_f32_bf16 v24, v82, v16, v24
  v_dot2_f32_bf16 v25, v86, v16, v25
  v_dot2_f32_bf16 v26, v90, v16, v26
  v_dot2_f32_bf16 v27, v94, v16, v27
  v_dot2_f32_bf16 v24, v83, v16, v24
  v_dot2_f32_bf16 v25, v87, v16, v25
  v_dot2_f32_bf16 v26, v91, v16, v26
  v_dot2_f32_bf16 v27, v95, v16, v27
  s_waitcnt lgkmcnt(5)
  v_dot2_f32_bf16 v24, v96, v16, v24
  v_dot2_f32_bf16 v25, v100, v16, v25
  v_dot2_f32_bf16 v26, v104, v16, v26
  v_dot2_f32_bf16 v27, v108, v16, v27
  v_dot2_f32_bf16 v24, v97, v16, v24
  v_dot2_f32_bf16 v25, v101, v16, v25
  v_dot2_f32_bf16 v26, v105, v16, v26
  v_dot2_f32_bf16 v27, v109, v16, v27
  v_dot2_f32_bf16 v24, v98, v16, v24
  v_dot2_f32_bf16 v25, v102, v16, v25
  v_dot2_f32_bf16 v26, v106, v16, v26
  v_dot2_f32_bf16 v27, v110, v16, v27
  v_dot2_f32_bf16 v24, v99, v16, v24
  v_dot2_f32_bf16 v25, v103, v16, v25
  v_dot2_f32_bf16 v26, v107, v16, v26
  v_dot2_f32_bf16 v27, v111, v16, v27
  s_waitcnt lgkmcnt(1)
  v_dot2_f32_bf16 v24, v112, v16, v24
  v_dot2_f32_bf16 v25, v116, v16, v25
  v_dot2_f32_bf16 v26, v120, v16, v26
  v_dot2_f32_bf16 v27, v124, v16, v27
  v_dot2_f32_bf16 v24, v113, v16, v24
  v_dot2_f32_bf16 v25, v117, v16, v25
  v_dot2_f32_bf16 v26, v121, v16, v26
  v_dot2_f32_bf16 v27, v125, v16, v27
  v_dot2_f32_bf16 v24, v114, v16, v24
  v_dot2_f32_bf16 v25, v118, v16, v25
  v_dot2_f32_bf16 v26, v122, v16, v26
  v_dot2_f32_bf16 v27, v126, v16, v27
  v_dot2_f32_bf16 v24, v115, v16, v24
  v_dot2_f32_bf16 v25, v119, v16, v25
  v_dot2_f32_bf16 v26, v123, v16, v26
  v_dot2_f32_bf16 v27, v127, v16, v27
  s_nop 2
SP_161:
  s_sleep 1
  ds_read_b32 v4, v2 offset:0
  s_sub_u32 s13, s13, 1
  s_cbranch_scc1 ABORT
  s_waitcnt lgkmcnt(0)
  v_cmp_gt_u32 vcc, 4, v4
  s_cbranch_vccnz SP_161
  ds_read_b128 v[64:67], v8 offset:32768
  ds_read_b128 v[68:71], v8 offset:34816
  ds_read_b128 v[72:75], v8 offset:36864
  ds_read_b128 v[76:79], v8 offset:38912
  ds_read_b128 v[80:83], v9 offset:32768
  ds_read_b128 v[84:87], v9 offset:34816
  ds_read_b128 v[88:91], v9 offset:36864
  ds_read_b128 v[92:95], v9 offset:38912
  ds_read_b128 v[96:99], v8 offset:40960
  ds_read_b128 v[100:103], v8 offset:43008
  ds_read_b128 v[104:107], v8 offset:45056
  ds_read_b128 v[108:111], v8 offset:47104
  ds_read_b128 v[112:115], v9 offset:40960
  ds_read_b128 v[116:119], v9 offset:43008
  ds_read_b128 v[120:123], v9 offset:45056
  ds_read_b128 v[124:127], v9 offset:47104
  ds_add_u32 v3, v5
  s_waitcnt lgkmcnt(13)
  v_dot2_f32_bf16 v20, v64, v16, v20
  v_dot2_f32_bf16 v21, v68, v16, v21
  v_dot2_f32_bf16 v22, v72, v16, v22
  v_dot2_f32_bf16 v23, v76, v16, v23
  v_dot2_f32_bf16 v20, v65, v16, v20
  v_dot2_f32_bf16 v21, v69, v16, v21
  v_dot2_f32_bf16 v22, v73, v16, v22
  v_dot2_f32_bf16 v23, v77, v16, v23
  v_dot2_f32_bf16 v20, v66, v16, v20
  v_dot2_f32_bf16 v21, v70, v16, v21
  v_dot2_f32_bf16 v22, v74, v16, v22
  v_dot2_f32_bf16 v23, v78, v16, v23
  v_dot2_f32_bf16 v20, v67, v16, v20
  v_dot2_f32_bf16 v21, v71, v16, v21
  v_dot2_f32_bf16 v22, v75, v16, v22
  v_dot2_f32_bf16 v23, v79, v16, v23
  s_waitcnt lgkmcnt(9)
  v_dot2_f32_bf16 v20, v80, v16, v20
  v_dot2_f32_bf16 v21, v84, v16, v21
  v_dot2_f32_bf16 v22, v88, v16, v22
  v_dot2_f32_bf16 v23, v92, v16, v23
  v_dot2_f32_bf16 v20, v81, v16, v20
  v_dot2_f32_bf16 v21, v85, v16, v21
  v_dot2_f32_bf16 v22, v89, v16, v22
  v_dot2_f32_bf16 v23, v93, v16, v23
  v_dot2_f32_bf16 v20, v82, v16, v20
  v_dot2_f32_bf16 v21, v86, v16, v21
  v_dot2_f32_bf16 v22, v90, v16, v22
  v_dot2_f32_bf16 v23, v94, v16, v23
  v_dot2_f32_bf16 v20, v83, v16, v20
  v_dot2_f32_bf16 v21, v87, v16, v21
  v_dot2_f32_bf16 v22, v91, v16, v22
  v_dot2_f32_bf16 v23, v95, v16, v23
  s_waitcnt lgkmcnt(5)
  v_dot2_f32_bf16 v20, v96, v16, v20
  v_dot2_f32_bf16 v21, v100, v16, v21
  v_dot2_f32_bf16 v22, v104, v16, v22
  v_dot2_f32_bf16 v23, v108, v16, v23
  v_dot2_f32_bf16 v20, v97, v16, v20
  v_dot2_f32_bf16 v21, v101, v16, v21
  v_dot2_f32_bf16 v22, v105, v16, v22
  v_dot2_f32_bf16 v23, v109, v16, v23
  v_dot2_f32_bf16 v20, v98, v16, v20
  v_dot2_f32_bf16 v21, v102, v16, v21
  v_dot2_f32_bf16 v22, v106, v16, v22
  v_dot2_f32_bf16 v23, v110, v16, v23
  v_dot2_f32_bf16 v20, v99, v16, v20
  v_dot2_f32_bf16 v21, v103, v16, v21
  v_dot2_f32_bf16 v22, v107, v16, v22
  v_dot2_f32_bf16 v23, v111, v16, v23
  s_waitcnt lgkmcnt(1)
  v_dot2_f32_bf16 v20, v112, v16, v20
  v_dot2_f32_bf16 v21, v116, v16, v21
  v_dot2_f32_bf16 v22, v120, v16, v22
  v_dot2_f32_bf16 v23, v124, v16, v23
  v_dot2_f32_bf16 v20, v113, v16, v20
  v_dot2_f32_bf16 v21, v117, v16, v21
  v_dot2_f32_bf16 v22, v121, v16, v22
  v_dot2_f32_bf16 v23, v125, v16, v23
  v_dot2_f32_bf16 v20, v114, v16, v20
  v_dot2_f32_bf16 v21, v118, v16, v21
  v_dot2_f32_bf16 v22, v122, v16, v22
  v_dot2_f32_bf16 v23, v126, v16, v23
  v_dot2_f32_bf16 v20, v115, v16, v20
  v_dot2_f32_bf16 v21, v119, v16, v21
  v_dot2_f32_bf16 v22, v123, v16, v22
  v_dot2_f32_bf16 v23, v127, v16, v23
  s_nop 2
SP_162:
  s_sleep 1
  ds_read_b32 v4, v2 offset:0
  s_sub_u32 s13, s13, 1
  s_cbranch_scc1 ABORT
  s_waitcnt lgkmcnt(0)
  v_cmp_gt_u32 vcc, 5, v4
  s_cbranch_vccnz SP_162
  ds_read_b128 v[64:67], v8 offset:49152
  ds_read_b128 v[68:71], v8 offset:51200
  ds_read_b128 v[72:75], v8 offset:53248
  ds_read_b128 v[76:79], v8 offset:55296
  ds_read_b128 v[80:83], v9 offset:49152
  ds_read_b128 v[84:87], v9 offset:51200
  ds_read_b128 v[88:91], v9 offset:53248
  ds_read_b128 v[92:95], v9 offset:55296
  ds_read_b128 v[96:99], v8 offset:57344
  ds_read_b128 v[100:103], v8 offset:59392
  ds_read_b128 v[104:107], v8 offset:61440
  ds_read_b128 v[108:111], v8 offset:63488
  ds_read_b128 v[112:115], v9 offset:57344
  ds_read_b128 v[116:119], v9 offset:59392
  ds_read_b128 v[120:123], v9 offset:61440
  ds_read_b128 v[124:127], v9 offset:63488
  ds_add_u32 v3, v5
  s_waitcnt lgkmcnt(13)
  v_dot2_f32_bf16 v24, v64, v16, v24
  v_dot2_f32_bf16 v25, v68, v16, v25
  v_dot2_f32_bf16 v26, v72, v16, v26
  v_dot2_f32_bf16 v27, v76, v16, v27
  v_dot2_f32_bf16 v24, v65, v16, v24
  v_dot2_f32_bf16 v25, v69, v16, v25
  v_dot2_f32_bf16 v26, v73, v16, v26
  v_dot2_f32_bf16 v27, v77, v16, v27
  v_dot2_f32_bf16 v24, v66, v16, v24
  v_dot2_f32_bf16 v25, v70, v16, v25
  v_dot2_f32_bf16 v26, v74, v16, v26
  v_dot2_f32_bf16 v27, v78, v16, v27
  v_dot2_f32_bf16 v24, v67, v16, v24
  v_dot2_f32_bf16 v25, v71, v16, v25
  v_dot2_f32_bf16 v26, v75, v16, v26
  v_dot2_f32_bf16 v27, v79, v16, v27
  s_waitcnt lgkmcnt(9)
  v_dot2_f32_bf16 v24, v80, v16, v24
  v_dot2_f32_bf16 v25, v84, v16, v25
  v_dot2_f32_bf16 v26, v88, v16, v26
  v_dot2_f32_bf16 v27, v92, v16, v27
  v_dot2_f32_bf16 v24, v81, v16, v24
  v_dot2_f32_bf16 v25, v85, v16, v25
  v_dot2_f32_bf16 v26, v89, v16, v26
  v_dot2_f32_bf16 v27, v93, v16, v27
  v_dot2_f32_bf16 v24, v82, v16, v24
  v_dot2_f32_bf16 v25, v86, v16, v25
  v_dot2_f32_bf16 v26, v90, v16, v26
  v_dot2_f32_bf16 v27, v94, v16, v27
  v_dot2_f32_bf16 v24, v83, v16, v24
  v_dot2_f32_bf16 v25, v87, v16, v25
  v_dot2_f32_bf16 v26, v91, v16, v26
  v_dot2_f32_bf16 v27, v95, v16, v27
  s_waitcnt lgkmcnt(5)
  v_dot2_f32_bf16 v24, v96, v16, v24
  v_dot2_f32_bf16 v25, v100, v16, v25
  v_dot2_f32_bf16 v26, v104, v16, v26
  v_dot2_f32_bf16 v27, v108, v16, v27
  v_dot2_f32_bf16 v24, v97, v16, v24
  v_dot2_f32_bf16 v25, v101, v16, v25
  v_dot2_f32_bf16 v26, v105, v16, v26
  v_dot2_f32_bf16 v27, v109, v16, v27
  v_dot2_f32_bf16 v24, v98, v16, v24
  v_dot2_f32_bf16 v25, v102, v16, v25
  v_dot2_f32_bf16 v26, v106, v16, v26
  v_dot2_f32_bf16 v27, v110, v16, v27
  v_dot2_f32_bf16 v24, v99, v16, v24
  v_dot2_f32_bf16 v25, v103, v16, v25
  v_dot2_f32_bf16 v26, v107, v16, v26
  v_dot2_f32_bf16 v27, v111, v16, v27
  s_waitcnt lgkmcnt(1)
  v_dot2_f32_bf16 v24, v112, v16, v24
  v_dot2_f32_bf16 v25, v116, v16, v25
  v_dot2_f32_bf16 v26, v120, v16, v26
  v_dot2_f32_bf16 v27, v124, v16, v27
  v_dot2_f32_bf16 v24, v113, v16, v24
  v_dot2_f32_bf16 v25, v117, v16, v25
  v_dot2_f32_bf16 v26, v121, v16, v26
  v_dot2_f32_bf16 v27, v125, v16, v27
  v_dot2_f32_bf16 v24, v114, v16, v24
  v_dot2_f32_bf16 v25, v118, v16, v25
  v_dot2_f32_bf16 v26, v122, v16, v26
  v_dot2_f32_bf16 v27, v126, v16, v27
  v_dot2_f32_bf16 v24, v115, v16, v24
  v_dot2_f32_bf16 v25, v119, v16, v25
  v_dot2_f32_bf16 v26, v123, v16, v26
  v_dot2_f32_bf16 v27, v127, v16, v27
  v_mov_b32 v4, 64
  ds_add_u32 v3, v4
  v_permlane32_swap_b32 v20, v24
  v_permlane32_swap_b32 v21, v25
  v_permlane32_swap_b32 v22, v26
  v_permlane32_swap_b32 v23, v27
  v_add_f32 v20, v20, v24
  v_add_f32 v21, v21, v25
  v_add_f32 v22, v22, v26
  v_add_f32 v23, v23, v27
  v_mov_b32 v24, v20
  v_mov_b32 v25, v21
  v_mov_b32 v26, v22
  v_mov_b32 v27, v23
  v_lshrrev_b32 v37, 5, v1
  v_and_b32 v38, 15, v1
  v_lshl_add_u32 v38, v37, 4, v38
  v_lshlrev_b32 v38, 4, v38
  v_permlane16_swap_b32 v20, v24
  v_permlane16_swap_b32 v21, v25
  v_permlane16_swap_b32 v22, v26
  v_permlane16_swap_b32 v23, v27
  v_add_f32 v20, v20, v24
  v_add_f32 v21, v21, v25
  v_add_f32 v22, v22, v26
  v_add_f32 v23, v23, v27
  s_lshl_b32 s58, s96, 9
  s_add_u32 s58, s58, 0xa0000
  s_lshr_b32 s59, s96, 2
  s_lshl_b32 s60, s59, 7
  s_lshl_b32 s44, s8, 3
  s_add_u32 s60, s60, s44
  s_add_u32 s60, s60, 0x5a000
  s_mov_b32 exec_lo, 0xffff
  s_mov_b32 exec_hi, 0xffff
  buffer_store_dwordx4 v[20:23], v38, s[24:27], s58 offen sc1
  s_mov_b64 exec, -1
EP_163:
  ds_read_b64 v[48:49], v7 offset:2448
  s_sub_u32 s13, s13, 1
  s_cbranch_scc1 ABORT
  s_waitcnt lgkmcnt(0)
  v_readfirstlane_b32 s15, v49
  v_readfirstlane_b32 s14, v48
  s_cmp_eq_u32 s15, 0
  s_cbranch_scc1 EP_163
  s_nop 2
  s_waitcnt vmcnt(0)
  v_mov_b32 v48, s14
  v_mov_b32 v49, s15
  s_mov_b64 exec, 1
  buffer_store_dwordx2 v[48:49], v6, s[24:27], s60 offen sc1
  s_mov_b64 exec, -1
  v_and_b32 v38, 3, v1
  v_lshlrev_b32 v38, 3, v38
  s_lshl_b32 s60, s59, 7
  s_add_u32 s60, s60, 0x5a000
  s_lshl_b32 s58, s59, 11
  s_add_u32 s58, s58, 0xa0000
  v_and_b32 v2, 7, v1
  v_cmp_gt_u32 vcc, 4, v2
  s_nop 1
  v_cndmask_b32 v4, 6, v2, vcc
  v_lshlrev_b32 v2, 2, v2
  v_lshl_add_u32 v2, v4, 8, v2
  v_add_u32 v2, 157696, v2
  s_movk_i32 s47, 3
  s_call_b64 s[18:19], WAITC
AP_164:
  buffer_load_dwordx2 v[48:49], v38, s[24:27], s60 offen sc1
  s_sub_u32 s13, s13, 1
  s_cbranch_scc1 ABORT
  s_waitcnt vmcnt(0)
  v_cmp_ne_u64 vcc, s[14:15], v[48:49]
  s_cbranch_vccz AP_164x
  s_sleep 16
  s_branch AP_164
AP_164x:
  v_lshlrev_b32 v38, 3, v1
  buffer_load_dwordx2 v[20:21], v38, s[24:27], s58 offen offset:0 sc1
  buffer_load_dwordx2 v[22:23], v38, s[24:27], s58 offen offset:512 sc1
  buffer_load_dwordx2 v[24:25], v38, s[24:27], s58 offen offset:1024 sc1
  buffer_load_dwordx2 v[26:27], v38, s[24:27], s58 offen offset:1536 sc1
  v_mul_u32_u24 v37, 1024, v37
  v_bfe_u32 v38, v1, 1, 4
  v_lshl_add_u32 v37, v38, 2, v37
  v_and_b32 v38, 1, v1
  v_lshl_add_u32 v37, v38, 7, v37
  v_add_u32 v37, 161280, v37
  s_waitcnt vmcnt(0)
  v_add_f32 v20, v20, v24
  v_add_f32 v21, v21, v25
  v_add_f32 v22, v22, v26
  v_add_f32 v23, v23, v27
  v_add_f32 v20, v20, v22
  v_add_f32 v21, v21, v23
  ds_write2_b32 v37, v20, v21 offset0:0 offset1:16
  v_mov_b32 v4, 64
  ds_add_u32 v3, v4
  s_mov_b64 exec, 1
  ds_add_u32 v7, v5 offset:2048
  s_mov_b64 exec, -1
  s_cmp_ge_u32 s5, 22
  s_cbranch_scc1 NOUVB
  v_lshlrev_b32 v44, 5, v42
  v_add_u32 v44, 163328, v44
  s_nop 2
SP_165:
  s_sleep 4
  ds_read_b32 v4, v7 offset:2304
  s_sub_u32 s13, s13, 1
  s_cbranch_scc1 ABORT
  s_waitcnt lgkmcnt(0)
  v_cmp_gt_u32 vcc, 16, v4
  s_cbranch_vccnz SP_165
  ds_read_b128 v[72:75], v44
  ds_read_b128 v[76:79], v44 offset:16
  ds_read_b128 v[64:67], v44 offset:256
  ds_read_b128 v[68:71], v44 offset:272
  v_and_b32 v46, 7, v1
  v_bfe_u32 v45, v1, 3, 1
  v_lshl_add_u32 v46, v46, 1, v45
  v_bfe_u32 v45, v1, 4, 1
  v_lshl_add_u32 v46, v46, 1, v45
  v_lshrrev_b32 v45, 5, v1
  v_lshl_add_u32 v46, v46, 1, v45
  v_lshlrev_b32 v46, 2, v46
  s_mul_i32 s52, s4, 12288
  s_lshl_b32 s44, s61, 8
  s_add_u32 s52, s52, s44
  s_add_u32 s52, s52, 0x80000
  s_add_u32 s53, s52, 6144
  s_waitcnt lgkmcnt(0)
  v_lshlrev_b32 v96, 16, v176
  v_and_b32 v97, 0xffff0000, v176
  v_lshlrev_b32 v98, 16, v177
  v_and_b32 v99, 0xffff0000, v177
  v_lshlrev_b32 v100, 16, v178
  v_and_b32 v101, 0xffff0000, v178
  v_lshlrev_b32 v102, 16, v179
  v_and_b32 v103, 0xffff0000, v179
  v_mul_f32 v80, v96, v64
  v_mul_f32 v81, v97, v64
  v_mul_f32 v82, v98, v64
  v_mul_f32 v83, v99, v64
  v_mul_f32 v84, v100, v64
  v_mul_f32 v85, v101, v64
  v_mul_f32 v86, v102, v64
  v_mul_f32 v87, v103, v64
  v_mul_f32 v88, v96, v72
  v_mul_f32 v89, v97, v72
  v_mul_f32 v90, v98, v72
  v_mul_f32 v91, v99, v72
  v_mul_f32 v92, v100, v72
  v_mul_f32 v93, v101, v72
  v_mul_f32 v94, v102, v72
  v_mul_f32 v95, v103, v72
  v_lshlrev_b32 v96, 16, v180
  v_and_b32 v97, 0xffff0000, v180
  v_lshlrev_b32 v98, 16, v181
  v_and_b32 v99, 0xffff0000, v181
  v_lshlrev_b32 v100, 16, v182
  v_and_b32 v101, 0xffff0000, v182
  v_lshlrev_b32 v102, 16, v183
  v_and_b32 v103, 0xffff0000, v183
  v_fmac_f32 v80, v96, v65
  v_fmac_f32 v81, v97, v65
  v_fmac_f32 v82, v98, v65
  v_fmac_f32 v83, v99, v65
  v_fmac_f32 v84, v100, v65
  v_fmac_f32 v85, v101, v65
  v_fmac_f32 v86, v102, v65
  v_fmac_f32 v87, v103, v65
  v_fmac_f32 v88, v96, v73
  v_fmac_f32 v89, v97, v73
  v_fmac_f32 v90, v98, v73
  v_fmac_f32 v91, v99, v73
  v_fmac_f32 v92, v100, v73
  v_fmac_f32 v93, v101, v73
  v_fmac_f32 v94, v102, v73
  v_fmac_f32 v95, v103, v73
  v_lshlrev_b32 v96, 16, v184
  v_and_b32 v97, 0xffff0000, v184
  v_lshlrev_b32 v98, 16, v185
  v_and_b32 v99, 0xffff0000, v185
  v_lshlrev_b32 v100, 16, v186
  v_and_b32 v101, 0xffff0000, v186
  v_lshlrev_b32 v102, 16, v187
  v_and_b32 v103, 0xffff0000, v187
  v_fmac_f32 v80, v96, v66
  v_fmac_f32 v81, v97, v66
  v_fmac_f32 v82, v98, v66
  v_fmac_f32 v83, v99, v66
  v_fmac_f32 v84, v100, v66
  v_fmac_f32 v85, v101, v66
  v_fmac_f32 v86, v102, v66
  v_fmac_f32 v87, v103, v66
  v_fmac_f32 v88, v96, v74
  v_fmac_f32 v89, v97, v74
  v_fmac_f32 v90, v98, v74
  v_fmac_f32 v91, v99, v74
  v_fmac_f32 v92, v100, v74
  v_fmac_f32 v93, v101, v74
  v_fmac_f32 v94, v102, v74
  v_fmac_f32 v95, v103, v74
  v_lshlrev_b32 v96, 16, v188
  v_and_b32 v97, 0xffff0000, v188
  v_lshlrev_b32 v98, 16, v189
  v_and_b32 v99, 0xffff0000, v189
  v_lshlrev_b32 v100, 16, v190
  v_and_b32 v101, 0xffff0000, v190
  v_lshlrev_b32 v102, 16, v191
  v_and_b32 v103, 0xffff0000, v191
  v_fmac_f32 v80, v96, v67
  v_fmac_f32 v81, v97, v67
  v_fmac_f32 v82, v98, v67
  v_fmac_f32 v83, v99, v67
  v_fmac_f32 v84, v100, v67
  v_fmac_f32 v85, v101, v67
  v_fmac_f32 v86, v102, v67
  v_fmac_f32 v87, v103, v67
  v_fmac_f32 v88, v96, v75
  v_fmac_f32 v89, v97, v75
  v_fmac_f32 v90, v98, v75
  v_fmac_f32 v91, v99, v75
  v_fmac_f32 v92, v100, v75
  v_fmac_f32 v93, v101, v75
  v_fmac_f32 v94, v102, v75
  v_fmac_f32 v95, v103, v75
  v_lshlrev_b32 v96, 16, v192
  v_and_b32 v97, 0xffff0000, v192
  v_lshlrev_b32 v98, 16, v193
  v_and_b32 v99, 0xffff0000, v193
  v_lshlrev_b32 v100, 16, v194
  v_and_b32 v101, 0xffff0000, v194
  v_lshlrev_b32 v102, 16, v195
  v_and_b32 v103, 0xffff0000, v195
  v_fmac_f32 v80, v96, v68
  v_fmac_f32 v81, v97, v68
  v_fmac_f32 v82, v98, v68
  v_fmac_f32 v83, v99, v68
  v_fmac_f32 v84, v100, v68
  v_fmac_f32 v85, v101, v68
  v_fmac_f32 v86, v102, v68
  v_fmac_f32 v87, v103, v68
  v_fmac_f32 v88, v96, v76
  v_fmac_f32 v89, v97, v76
  v_fmac_f32 v90, v98, v76
  v_fmac_f32 v91, v99, v76
  v_fmac_f32 v92, v100, v76
  v_fmac_f32 v93, v101, v76
  v_fmac_f32 v94, v102, v76
  v_fmac_f32 v95, v103, v76
  v_lshlrev_b32 v96, 16, v196
  v_and_b32 v97, 0xffff0000, v196
  v_lshlrev_b32 v98, 16, v197
  v_and_b32 v99, 0xffff0000, v197
  v_lshlrev_b32 v100, 16, v198
  v_and_b32 v101, 0xffff0000, v198
  v_lshlrev_b32 v102, 16, v199
  v_and_b32 v103, 0xffff0000, v199
  v_fmac_f32 v80, v96, v69
  v_fmac_f32 v81, v97, v69
  v_fmac_f32 v82, v98, v69
  v_fmac_f32 v83, v99, v69
  v_fmac_f32 v84, v100, v69
  v_fmac_f32 v85, v101, v69
  v_fmac_f32 v86, v102, v69
  v_fmac_f32 v87, v103, v69
  v_fmac_f32 v88, v96, v77
  v_fmac_f32 v89, v97, v77
  v_fmac_f32 v90, v98, v77
  v_fmac_f32 v91, v99, v77
  v_fmac_f32 v92, v100, v77
  v_fmac_f32 v93, v101, v77
  v_fmac_f32 v94, v102, v77
  v_fmac_f32 v95, v103, v77
  v_lshlrev_b32 v96, 16, v200
  v_and_b32 v97, 0xffff0000, v200
  v_lshlrev_b32 v98, 16, v201
  v_and_b32 v99, 0xffff0000, v201
  v_lshlrev_b32 v100, 16, v202
  v_and_b32 v101, 0xffff0000, v202
  v_lshlrev_b32 v102, 16, v203
  v_and_b32 v103, 0xffff0000, v203
  v_fmac_f32 v80, v96, v70
  v_fmac_f32 v81, v97, v70
  v_fmac_f32 v82, v98, v70
  v_fmac_f32 v83, v99, v70
  v_fmac_f32 v84, v100, v70
  v_fmac_f32 v85, v101, v70
  v_fmac_f32 v86, v102, v70
  v_fmac_f32 v87, v103, v70
  v_fmac_f32 v88, v96, v78
  v_fmac_f32 v89, v97, v78
  v_fmac_f32 v90, v98, v78
  v_fmac_f32 v91, v99, v78
  v_fmac_f32 v92, v100, v78
  v_fmac_f32 v93, v101, v78
  v_fmac_f32 v94, v102, v78
  v_fmac_f32 v95, v103, v78
  v_lshlrev_b32 v96, 16, v204
  v_and_b32 v97, 0xffff0000, v204
  v_lshlrev_b32 v98, 16, v205
  v_and_b32 v99, 0xffff0000, v205
  v_lshlrev_b32 v100, 16, v206
  v_and_b32 v101, 0xffff0000, v206
  v_lshlrev_b32 v102, 16, v207
  v_and_b32 v103, 0xffff0000, v207
  v_fmac_f32 v80, v96, v71
  v_fmac_f32 v81, v97, v71
  v_fmac_f32 v82, v98, v71
  v_fmac_f32 v83, v99, v71
  v_fmac_f32 v84, v100, v71
  v_fmac_f32 v85, v101, v71
  v_fmac_f32 v86, v102, v71
  v_fmac_f32 v87, v103, v71
  v_fmac_f32 v88, v96, v79
  v_fmac_f32 v89, v97, v79
  v_fmac_f32 v90, v98, v79
  v_fmac_f32 v91, v99, v79
  v_fmac_f32 v92, v100, v79
  v_fmac_f32 v93, v101, v79
  v_fmac_f32 v94, v102, v79
  v_fmac_f32 v95, v103, v79
  s_mov_b32 s54, 0xff00ff00
  s_mov_b32 s55, 0xff00ff00
  v_permlane32_swap_b32 v80, v81
  v_permlane32_swap_b32 v82, v83
  v_permlane32_swap_b32 v84, v85
  v_permlane32_swap_b32 v86, v87
  v_permlane32_swap_b32 v88, v89
  v_permlane32_swap_b32 v90, v91
  v_permlane32_swap_b32 v92, v93
  v_permlane32_swap_b32 v94, v95
  v_add_f32 v80, v80, v81
  v_add_f32 v82, v82, v83
  v_add_f32 v84, v84, v85
  v_add_f32 v86, v86, v87
  v_add_f32 v88, v88, v89
  v_add_f32 v90, v90, v91
  v_add_f32 v92, v92, v93
  v_add_f32 v94, v94, v95
  v_permlane16_swap_b32 v80, v82
  v_permlane16_swap_b32 v84, v86
  v_permlane16_swap_b32 v88, v90
  v_permlane16_swap_b32 v92, v94
  v_add_f32 v80, v80, v82
  v_add_f32 v84, v84, v86
  v_add_f32 v88, v88, v90
  v_add_f32 v92, v92, v94
  v_add_f32_dpp v80, v80, v80 row_ror:8 row_mask:0xf bank_mask:0xf
  v_add_f32_dpp v84, v84, v84 row_ror:8 row_mask:0xf bank_mask:0xf
  v_add_f32_dpp v88, v88, v88 row_ror:8 row_mask:0xf bank_mask:0xf
  v_add_f32_dpp v92, v92, v92 row_ror:8 row_mask:0xf bank_mask:0xf
  v_cndmask_b32 v80, v80, v84, s[54:55]
  v_cndmask_b32 v88, v88, v92, s[54:55]
  buffer_store_dword v80, v46, s[24:27], s52 offen sc1
  buffer_store_dword v88, v46, s[24:27], s53 offen sc1
  s_lshl_b32 s52, s61, 6
  s_lshl_b32 s44, s4, 3
  s_add_u32 s52, s52, s44
  s_add_u32 s52, s52, 0x53000
  s_waitcnt vmcnt(0)
  v_mov_b32 v48, s14
  v_mov_b32 v49, s15
  s_mov_b64 exec, 1
  buffer_store_dwordx2 v[48:49], v6, s[24:27], s52 offen sc1
  s_mov_b64 exec, -1
NOUVB:
  s_mov_b32 s40, s64
  s_and_b32 s41, s65, 0xffff
  s_mov_b32 s42, 0x200000
  s_mov_b32 s43, 0x00020000
  s_lshl_b32 s57, s9, 16
  s_lshl_b32 s44, s10, 7
  s_add_u32 s57, s57, s44
  v_lshlrev_b32 v55, 10, v1
  buffer_load_dword v57, v55, s[40:43], s57 offen
  s_waitcnt vmcnt(0)
  s_endpgm
LOAD0:
  v_mov_b32 v6, 0
  v_lshlrev_b32 v3, 2, v1
  v_add_u32 v3, 158720, v3
  v_and_b32 v2, 7, v1
  v_cmp_gt_u32 vcc, 4, v2
  s_nop 1
  v_cndmask_b32 v4, 6, v2, vcc
  v_lshlrev_b32 v2, 2, v2
  v_lshl_add_u32 v2, v4, 8, v2
  v_add_u32 v2, 157696, v2
  v_mov_b32 v26, 157696
  v_lshl_add_u32 v12, v42, 10, v45
  v_lshl_add_u32 v13, v42, 10, v46
  v_add_u32 v13, 7168, v13
  v_add_u32 v14, 14336, v12
  v_add_u32 v15, 14336, v13
  v_lshlrev_b32 v45, 1, v44
  v_xor_b32 v45, v43, v45
  v_lshlrev_b32 v45, 4, v45
  v_lshl_add_u32 v20, v42, 10, v45
  v_add_u32 v21, 7168, v20
  v_add_u32 v22, 14336, v20
  v_add_u32 v23, 21504, v20
  v_add_u32 v45, 0, v1
  v_mul_u32_u24 v46, 0x1556, v45
  v_lshrrev_b32 v46, 16, v46
  v_mul_u32_u24 v47, 12, v46
  v_sub_u32 v45, v45, v47
  v_bfe_u32 v47, v46, 2, 1
  v_lshlrev_b32 v47, 1, v47
  v_xor_b32 v45, v45, v47
  v_mul_u32_u24 v46, 2752, v46
  v_lshl_add_u32 v16, v45, 4, v46
  v_add_u32 v45, 64, v1
  v_mul_u32_u24 v46, 0x1556, v45
  v_lshrrev_b32 v46, 16, v46
  v_mul_u32_u24 v47, 12, v46
  v_sub_u32 v45, v45, v47
  v_bfe_u32 v47, v46, 2, 1
  v_lshlrev_b32 v47, 1, v47
  v_xor_b32 v45, v45, v47
  v_mul_u32_u24 v46, 2752, v46
  v_lshl_add_u32 v17, v45, 4, v46
  v_subrev_u32 v17, 1024, v17
  v_add_u32 v45, 128, v1
  v_mul_u32_u24 v46, 0x1556, v45
  v_lshrrev_b32 v46, 16, v46
  v_mul_u32_u24 v47, 12, v46
  v_sub_u32 v45, v45, v47
  v_bfe_u32 v47, v46, 2, 1
  v_lshlrev_b32 v47, 1, v47
  v_xor_b32 v45, v45, v47
  v_mul_u32_u24 v46, 2752, v46
  v_lshl_add_u32 v18, v45, 4, v46
  v_subrev_u32 v18, 2048, v18
  s_mov_b32 s40, s68
  s_and_b32 s41, s69, 0xffff
  s_mov_b32 s42, 0x800000
  s_mov_b32 s43, 0x00020000
  s_lshl_b32 s48, s10, 16
  s_add_u32 s44, s10, 0
  s_and_b32 s44, s44, 3
  s_lshl_b32 s44, s44, 8
  s_add_u32 s60, s48, s44
  s_add_u32 s44, s10, 1
  s_and_b32 s44, s44, 3
  s_lshl_b32 s44, s44, 8
  s_add_u32 s61, s48, s44
  s_add_u32 s44, s10, 2
  s_and_b32 s44, s44, 3
  s_lshl_b32 s44, s44, 8
  s_add_u32 s62, s48, s44
  s_add_u32 s44, s10, 3
  s_and_b32 s44, s44, 3
  s_lshl_b32 s44, s44, 8
  s_add_u32 s63, s48, s44
  s_mul_i32 s49, s12, 192
  s_lshl_b32 s50, s10, 7
WR_166:
  ds_read_b32 v4, v26 offset:2304
  s_sub_u32 s13, s13, 1
  s_cbranch_scc1 ABORT
  s_waitcnt lgkmcnt(0)
  v_cmp_gt_u32 vcc, 4, v4
  s_cbranch_vccnz WR_166
  s_mov_b32 m0, 32768
  s_add_u32 s46, s56, 256
  buffer_load_dwordx4 v8, s[28:31], s46 offen offset:0  lds
  buffer_load_dwordx4 v9, s[28:31], s46 offen offset:1024  lds
  buffer_load_dwordx4 v10, s[28:31], s46 offen offset:2048  lds
  buffer_load_dwordx4 v11, s[28:31], s46 offen offset:3072  lds
  s_mov_b32 m0, 36864
  s_add_u32 s46, s56, 131328
  buffer_load_dwordx4 v8, s[28:31], s46 offen offset:0  lds
  buffer_load_dwordx4 v9, s[28:31], s46 offen offset:1024  lds
  buffer_load_dwordx4 v10, s[28:31], s46 offen offset:2048  lds
  buffer_load_dwordx4 v11, s[28:31], s46 offen offset:3072  lds
  s_mov_b32 m0, 40960
  s_add_u32 s46, s56, 384
  buffer_load_dwordx4 v8, s[28:31], s46 offen offset:0  lds
  buffer_load_dwordx4 v9, s[28:31], s46 offen offset:1024  lds
  buffer_load_dwordx4 v10, s[28:31], s46 offen offset:2048  lds
  buffer_load_dwordx4 v11, s[28:31], s46 offen offset:3072  lds
  s_mov_b32 m0, 45056
  s_add_u32 s46, s56, 131456
  buffer_load_dwordx4 v8, s[28:31], s46 offen offset:0  lds
  buffer_load_dwordx4 v9, s[28:31], s46 offen offset:1024  lds
  buffer_load_dwordx4 v10, s[28:31], s46 offen offset:2048  lds
  buffer_load_dwordx4 v11, s[28:31], s46 offen offset:3072  lds
  s_waitcnt vmcnt(16)
  v_mov_b32 v5, 3
  ds_write_b32 v3, v5
  s_waitcnt vmcnt(0)
  v_mov_b32 v5, 5
  ds_write_b32 v3, v5
  s_mov_b32 m0, 65536
  s_add_u32 s46, s57, 0
  buffer_load_dwordx4 v8, s[28:31], s46 offen offset:0  lds
  buffer_load_dwordx4 v9, s[28:31], s46 offen offset:1024  lds
  buffer_load_dwordx4 v10, s[28:31], s46 offen offset:2048  lds
  buffer_load_dwordx4 v11, s[28:31], s46 offen offset:3072  lds
  s_mov_b32 m0, 69632
  s_add_u32 s46, s57, 131072
  buffer_load_dwordx4 v8, s[28:31], s46 offen offset:0  lds
  buffer_load_dwordx4 v9, s[28:31], s46 offen offset:1024  lds
  buffer_load_dwordx4 v10, s[28:31], s46 offen offset:2048  lds
  buffer_load_dwordx4 v11, s[28:31], s46 offen offset:3072  lds
  s_mov_b32 m0, 73728
  s_add_u32 s46, s57, 128
  buffer_load_dwordx4 v8, s[28:31], s46 offen offset:0  lds
  buffer_load_dwordx4 v9, s[28:31], s46 offen offset:1024  lds
  buffer_load_dwordx4 v10, s[28:31], s46 offen offset:2048  lds
  buffer_load_dwordx4 v11, s[28:31], s46 offen offset:3072  lds
  s_mov_b32 m0, 77824
  s_add_u32 s46, s57, 131200
  buffer_load_dwordx4 v8, s[28:31], s46 offen offset:0  lds
  buffer_load_dwordx4 v9, s[28:31], s46 offen offset:1024  lds
  buffer_load_dwordx4 v10, s[28:31], s46 offen offset:2048  lds
  buffer_load_dwordx4 v11, s[28:31], s46 offen offset:3072  lds
  s_mov_b32 m0, 98304
  s_add_u32 s46, s57, 256
  buffer_load_dwordx4 v8, s[28:31], s46 offen offset:0  lds
  buffer_load_dwordx4 v9, s[28:31], s46 offen offset:1024  lds
  buffer_load_dwordx4 v10, s[28:31], s46 offen offset:2048  lds
  buffer_load_dwordx4 v11, s[28:31], s46 offen offset:3072  lds
  s_mov_b32 m0, 102400
  s_add_u32 s46, s57, 131328
  buffer_load_dwordx4 v8, s[28:31], s46 offen offset:0  lds
  buffer_load_dwordx4 v9, s[28:31], s46 offen offset:1024  lds
  buffer_load_dwordx4 v10, s[28:31], s46 offen offset:2048  lds
  buffer_load_dwordx4 v11, s[28:31], s46 offen offset:3072  lds
  s_mov_b32 m0, 106496
  s_add_u32 s46, s57, 384
  buffer_load_dwordx4 v8, s[28:31], s46 offen offset:0  lds
  buffer_load_dwordx4 v9, s[28:31], s46 offen offset:1024  lds
  buffer_load_dwordx4 v10, s[28:31], s46 offen offset:2048  lds
  buffer_load_dwordx4 v11, s[28:31], s46 offen offset:3072  lds
  s_mov_b32 m0, 110592
  s_add_u32 s46, s57, 131456
  buffer_load_dwordx4 v8, s[28:31], s46 offen offset:0  lds
  buffer_load_dwordx4 v9, s[28:31], s46 offen offset:1024  lds
  buffer_load_dwordx4 v10, s[28:31], s46 offen offset:2048  lds
  buffer_load_dwordx4 v11, s[28:31], s46 offen offset:3072  lds
  s_waitcnt vmcnt(16)
  v_mov_b32 v5, 7
  ds_write_b32 v3, v5
  s_mov_b32 m0, 131072
  s_add_u32 s46, s58, 0
  buffer_load_dwordx4 v8, s[28:31], s46 offen offset:0  lds
  buffer_load_dwordx4 v9, s[28:31], s46 offen offset:1024  lds
  buffer_load_dwordx4 v10, s[28:31], s46 offen offset:2048  lds
  buffer_load_dwordx4 v11, s[28:31], s46 offen offset:3072  lds
  s_mov_b32 m0, 135168
  s_add_u32 s46, s58, 131072
  buffer_load_dwordx4 v8, s[28:31], s46 offen offset:0  lds
  buffer_load_dwordx4 v9, s[28:31], s46 offen offset:1024  lds
  buffer_load_dwordx4 v10, s[28:31], s46 offen offset:2048  lds
  buffer_load_dwordx4 v11, s[28:31], s46 offen offset:3072  lds
  s_mov_b32 m0, 139264
  s_add_u32 s46, s58, 128
  buffer_load_dwordx4 v8, s[28:31], s46 offen offset:0  lds
  buffer_load_dwordx4 v9, s[28:31], s46 offen offset:1024  lds
  buffer_load_dwordx4 v10, s[28:31], s46 offen offset:2048  lds
  buffer_load_dwordx4 v11, s[28:31], s46 offen offset:3072  lds
  s_mov_b32 m0, 143360
  s_add_u32 s46, s58, 131200
  buffer_load_dwordx4 v8, s[28:31], s46 offen offset:0  lds
  buffer_load_dwordx4 v9, s[28:31], s46 offen offset:1024  lds
  buffer_load_dwordx4 v10, s[28:31], s46 offen offset:2048  lds
  buffer_load_dwordx4 v11, s[28:31], s46 offen offset:3072  lds
  s_waitcnt vmcnt(16)
  v_mov_b32 v5, 9
  ds_write_b32 v3, v5
  ds_read_b32 v4, v2
  s_movk_i32 s47, 2
  s_waitcnt lgkmcnt(0)
  v_cmp_gt_u32 vcc, 2, v4
  s_cbranch_vccz CK_167
  s_waitcnt vmcnt(0)
  v_mov_b32 v5, 11
  ds_write_b32 v3, v5
  s_call_b64 s[18:19], WAITC
CK_167:
  s_mov_b32 m0, 8192
  s_add_u32 s46, s58, 256
  buffer_load_dwordx4 v8, s[28:31], s46 offen offset:0  lds
  buffer_load_dwordx4 v9, s[28:31], s46 offen offset:1024  lds
  buffer_load_dwordx4 v10, s[28:31], s46 offen offset:2048  lds
  buffer_load_dwordx4 v11, s[28:31], s46 offen offset:3072  lds
  s_mov_b32 m0, 12288
  s_add_u32 s46, s58, 131328
  buffer_load_dwordx4 v8, s[28:31], s46 offen offset:0  lds
  buffer_load_dwordx4 v9, s[28:31], s46 offen offset:1024  lds
  buffer_load_dwordx4 v10, s[28:31], s46 offen offset:2048  lds
  buffer_load_dwordx4 v11, s[28:31], s46 offen offset:3072  lds
  s_mov_b32 m0, 16384
  s_add_u32 s46, s58, 384
  buffer_load_dwordx4 v8, s[28:31], s46 offen offset:0  lds
  buffer_load_dwordx4 v9, s[28:31], s46 offen offset:1024  lds
  buffer_load_dwordx4 v10, s[28:31], s46 offen offset:2048  lds
  buffer_load_dwordx4 v11, s[28:31], s46 offen offset:3072  lds
  s_mov_b32 m0, 20480
  s_add_u32 s46, s58, 131456
  buffer_load_dwordx4 v8, s[28:31], s46 offen offset:0  lds
  buffer_load_dwordx4 v9, s[28:31], s46 offen offset:1024  lds
  buffer_load_dwordx4 v10, s[28:31], s46 offen offset:2048  lds
  buffer_load_dwordx4 v11, s[28:31], s46 offen offset:3072  lds
  s_waitcnt vmcnt(16)
  v_mov_b32 v5, 11
  ds_write_b32 v3, v5
  ds_read_b32 v4, v2
  s_movk_i32 s47, 4
  s_waitcnt lgkmcnt(0)
  v_cmp_gt_u32 vcc, 4, v4
  s_cbranch_vccz CK_168
  s_waitcnt vmcnt(0)
  v_mov_b32 v5, 13
  ds_write_b32 v3, v5
  s_call_b64 s[18:19], WAITC
CK_168:
  s_mov_b32 m0, 40960
  s_add_u32 s46, s59, 256
  buffer_load_dwordx4 v8, s[28:31], s46 offen offset:0  lds
  buffer_load_dwordx4 v9, s[28:31], s46 offen offset:1024  lds
  buffer_load_dwordx4 v10, s[28:31], s46 offen offset:2048  lds
  buffer_load_dwordx4 v11, s[28:31], s46 offen offset:3072  lds
  s_mov_b32 m0, 45056
  s_add_u32 s46, s59, 131328
  buffer_load_dwordx4 v8, s[28:31], s46 offen offset:0  lds
  buffer_load_dwordx4 v9, s[28:31], s46 offen offset:1024  lds
  buffer_load_dwordx4 v10, s[28:31], s46 offen offset:2048  lds
  buffer_load_dwordx4 v11, s[28:31], s46 offen offset:3072  lds
  s_mov_b32 m0, 49152
  s_add_u32 s46, s59, 384
  buffer_load_dwordx4 v8, s[28:31], s46 offen offset:0  lds
  buffer_load_dwordx4 v9, s[28:31], s46 offen offset:1024  lds
  buffer_load_dwordx4 v10, s[28:31], s46 offen offset:2048  lds
  buffer_load_dwordx4 v11, s[28:31], s46 offen offset:3072  lds
  s_mov_b32 m0, 53248
  s_add_u32 s46, s59, 131456
  buffer_load_dwordx4 v8, s[28:31], s46 offen offset:0  lds
  buffer_load_dwordx4 v9, s[28:31], s46 offen offset:1024  lds
  buffer_load_dwordx4 v10, s[28:31], s46 offen offset:2048  lds
  buffer_load_dwordx4 v11, s[28:31], s46 offen offset:3072  lds
  s_waitcnt vmcnt(16)
  v_mov_b32 v5, 13
  ds_write_b32 v3, v5
  ds_read_b32 v4, v2
  s_movk_i32 s47, 6
  s_waitcnt lgkmcnt(0)
  v_cmp_gt_u32 vcc, 6, v4
  s_cbranch_vccz CK_169
  s_waitcnt vmcnt(0)
  v_mov_b32 v5, 15
  ds_write_b32 v3, v5
  s_call_b64 s[18:19], WAITC
CK_169:
  s_mov_b32 m0, 73728
  s_add_u32 s46, s59, 0
  buffer_load_dwordx4 v8, s[40:43], s46 offen offset:0  lds
  buffer_load_dwordx4 v9, s[40:43], s46 offen offset:1024  lds
  buffer_load_dwordx4 v10, s[40:43], s46 offen offset:2048  lds
  buffer_load_dwordx4 v11, s[40:43], s46 offen offset:3072  lds
  s_mov_b32 m0, 77824
  s_add_u32 s46, s59, 131072
  buffer_load_dwordx4 v8, s[40:43], s46 offen offset:0  lds
  buffer_load_dwordx4 v9, s[40:43], s46 offen offset:1024  lds
  buffer_load_dwordx4 v10, s[40:43], s46 offen offset:2048  lds
  buffer_load_dwordx4 v11, s[40:43], s46 offen offset:3072  lds
  s_mov_b32 m0, 81920
  s_add_u32 s46, s59, 128
  buffer_load_dwordx4 v8, s[40:43], s46 offen offset:0  lds
  buffer_load_dwordx4 v9, s[40:43], s46 offen offset:1024  lds
  buffer_load_dwordx4 v10, s[40:43], s46 offen offset:2048  lds
  buffer_load_dwordx4 v11, s[40:43], s46 offen offset:3072  lds
  s_mov_b32 m0, 86016
  s_add_u32 s46, s59, 131200
  buffer_load_dwordx4 v8, s[40:43], s46 offen offset:0  lds
  buffer_load_dwordx4 v9, s[40:43], s46 offen offset:1024  lds
  buffer_load_dwordx4 v10, s[40:43], s46 offen offset:2048  lds
  buffer_load_dwordx4 v11, s[40:43], s46 offen offset:3072  lds
  s_waitcnt vmcnt(16)
  v_mov_b32 v5, 15
  ds_write_b32 v3, v5
  s_mov_b32 s32, s70
  s_and_b32 s33, s71, 0xffff
  s_mov_b32 s34, 0x80000
  s_mov_b32 s35, 0x00020000
  s_mov_b32 s36, s72
  s_and_b32 s37, s73, 0xffff
  s_mov_b32 s38, 0x80000
  s_mov_b32 s39, 0x00020000
  s_mov_b32 s92, s78
  s_and_b32 s93, s79, 0xffff
  s_mov_b32 s94, 0x158000
  s_mov_b32 s95, 0x00020000
  ds_read_b32 v4, v2
  s_movk_i32 s47, 8
  s_waitcnt lgkmcnt(0)
  v_cmp_gt_u32 vcc, 8, v4
  s_cbranch_vccz CK_170
  s_waitcnt vmcnt(0)
  v_mov_b32 v5, 18
  ds_write_b32 v3, v5
  s_call_b64 s[18:19], WAITC
CK_170:
  s_mov_b32 m0, 106496
  s_add_u32 s46, s60, 0
  buffer_load_dwordx4 v12, s[32:35], s46 offen offset:0  lds
  buffer_load_dwordx4 v13, s[32:35], s46 offen offset:1024  lds
  buffer_load_dwordx4 v14, s[32:35], s46 offen offset:2048  lds
  buffer_load_dwordx4 v15, s[32:35], s46 offen offset:3072  lds
  s_mov_b32 m0, 110592
  s_add_u32 s46, s60, 32768
  buffer_load_dwordx4 v12, s[32:35], s46 offen offset:0  lds
  buffer_load_dwordx4 v13, s[32:35], s46 offen offset:1024  lds
  buffer_load_dwordx4 v14, s[32:35], s46 offen offset:2048  lds
  buffer_load_dwordx4 v15, s[32:35], s46 offen offset:3072  lds
  s_mov_b32 m0, 114688
  s_add_u32 s46, s60, 128
  buffer_load_dwordx4 v12, s[32:35], s46 offen offset:0  lds
  buffer_load_dwordx4 v13, s[32:35], s46 offen offset:1024  lds
  buffer_load_dwordx4 v14, s[32:35], s46 offen offset:2048  lds
  buffer_load_dwordx4 v15, s[32:35], s46 offen offset:3072  lds
  s_mov_b32 m0, 118784
  s_add_u32 s46, s60, 32896
  buffer_load_dwordx4 v12, s[32:35], s46 offen offset:0  lds
  buffer_load_dwordx4 v13, s[32:35], s46 offen offset:1024  lds
  buffer_load_dwordx4 v14, s[32:35], s46 offen offset:2048  lds
  buffer_load_dwordx4 v15, s[32:35], s46 offen offset:3072  lds
  s_waitcnt vmcnt(16)
  v_mov_b32 v5, 18
  ds_write_b32 v3, v5
  ds_read_b32 v4, v2
  s_movk_i32 s47, 10
  s_waitcnt lgkmcnt(0)
  v_cmp_gt_u32 vcc, 10, v4
  s_cbranch_vccz CK_171
  s_waitcnt vmcnt(0)
  v_mov_b32 v5, 20
  ds_write_b32 v3, v5
  s_call_b64 s[18:19], WAITC
CK_171:
  s_mov_b32 m0, 139264
  s_add_u32 s46, s62, 0
  buffer_load_dwordx4 v12, s[32:35], s46 offen offset:0  lds
  buffer_load_dwordx4 v13, s[32:35], s46 offen offset:1024  lds
  buffer_load_dwordx4 v14, s[32:35], s46 offen offset:2048  lds
  buffer_load_dwordx4 v15, s[32:35], s46 offen offset:3072  lds
  s_mov_b32 m0, 143360
  s_add_u32 s46, s62, 32768
  buffer_load_dwordx4 v12, s[32:35], s46 offen offset:0  lds
  buffer_load_dwordx4 v13, s[32:35], s46 offen offset:1024  lds
  buffer_load_dwordx4 v14, s[32:35], s46 offen offset:2048  lds
  buffer_load_dwordx4 v15, s[32:35], s46 offen offset:3072  lds
  s_mov_b32 m0, 147456
  s_add_u32 s46, s62, 128
  buffer_load_dwordx4 v12, s[32:35], s46 offen offset:0  lds
  buffer_load_dwordx4 v13, s[32:35], s46 offen offset:1024  lds
  buffer_load_dwordx4 v14, s[32:35], s46 offen offset:2048  lds
  buffer_load_dwordx4 v15, s[32:35], s46 offen offset:3072  lds
  s_mov_b32 m0, 151552
  s_add_u32 s46, s62, 32896
  buffer_load_dwordx4 v12, s[32:35], s46 offen offset:0  lds
  buffer_load_dwordx4 v13, s[32:35], s46 offen offset:1024  lds
  buffer_load_dwordx4 v14, s[32:35], s46 offen offset:2048  lds
  buffer_load_dwordx4 v15, s[32:35], s46 offen offset:3072  lds
  s_waitcnt vmcnt(16)
  v_mov_b32 v5, 20
  ds_write_b32 v3, v5
  ds_read_b32 v4, v2
  s_movk_i32 s47, 12
  s_waitcnt lgkmcnt(0)
  v_cmp_gt_u32 vcc, 12, v4
  s_cbranch_vccz CK_172
  s_waitcnt vmcnt(0)
  v_mov_b32 v5, 22
  ds_write_b32 v3, v5
  s_call_b64 s[18:19], WAITC
CK_172:
  s_mov_b32 m0, 16384
  s_add_u32 s46, s60, 0
  buffer_load_dwordx4 v12, s[36:39], s46 offen offset:0  lds
  buffer_load_dwordx4 v13, s[36:39], s46 offen offset:1024  lds
  buffer_load_dwordx4 v14, s[36:39], s46 offen offset:2048  lds
  buffer_load_dwordx4 v15, s[36:39], s46 offen offset:3072  lds
  s_mov_b32 m0, 20480
  s_add_u32 s46, s60, 32768
  buffer_load_dwordx4 v12, s[36:39], s46 offen offset:0  lds
  buffer_load_dwordx4 v13, s[36:39], s46 offen offset:1024  lds
  buffer_load_dwordx4 v14, s[36:39], s46 offen offset:2048  lds
  buffer_load_dwordx4 v15, s[36:39], s46 offen offset:3072  lds
  s_mov_b32 m0, 24576
  s_add_u32 s46, s60, 128
  buffer_load_dwordx4 v12, s[36:39], s46 offen offset:0  lds
  buffer_load_dwordx4 v13, s[36:39], s46 offen offset:1024  lds
  buffer_load_dwordx4 v14, s[36:39], s46 offen offset:2048  lds
  buffer_load_dwordx4 v15, s[36:39], s46 offen offset:3072  lds
  s_mov_b32 m0, 28672
  s_add_u32 s46, s60, 32896
  buffer_load_dwordx4 v12, s[36:39], s46 offen offset:0  lds
  buffer_load_dwordx4 v13, s[36:39], s46 offen offset:1024  lds
  buffer_load_dwordx4 v14, s[36:39], s46 offen offset:2048  lds
  buffer_load_dwordx4 v15, s[36:39], s46 offen offset:3072  lds
  s_waitcnt vmcnt(16)
  v_mov_b32 v5, 22
  ds_write_b32 v3, v5
  ds_read_b32 v4, v2
  s_movk_i32 s47, 14
  s_waitcnt lgkmcnt(0)
  v_cmp_gt_u32 vcc, 14, v4
  s_cbranch_vccz CK_173
  s_waitcnt vmcnt(0)
  v_mov_b32 v5, 24
  ds_write_b32 v3, v5
  s_call_b64 s[18:19], WAITC
CK_173:
  s_mov_b32 m0, 49152
  s_add_u32 s46, s62, 0
  buffer_load_dwordx4 v12, s[36:39], s46 offen offset:0  lds
  buffer_load_dwordx4 v13, s[36:39], s46 offen offset:1024  lds
  buffer_load_dwordx4 v14, s[36:39], s46 offen offset:2048  lds
  buffer_load_dwordx4 v15, s[36:39], s46 offen offset:3072  lds
  s_mov_b32 m0, 53248
  s_add_u32 s46, s62, 32768
  buffer_load_dwordx4 v12, s[36:39], s46 offen offset:0  lds
  buffer_load_dwordx4 v13, s[36:39], s46 offen offset:1024  lds
  buffer_load_dwordx4 v14, s[36:39], s46 offen offset:2048  lds
  buffer_load_dwordx4 v15, s[36:39], s46 offen offset:3072  lds
  s_mov_b32 m0, 57344
  s_add_u32 s46, s62, 128
  buffer_load_dwordx4 v12, s[36:39], s46 offen offset:0  lds
  buffer_load_dwordx4 v13, s[36:39], s46 offen offset:1024  lds
  buffer_load_dwordx4 v14, s[36:39], s46 offen offset:2048  lds
  buffer_load_dwordx4 v15, s[36:39], s46 offen offset:3072  lds
  s_mov_b32 m0, 61440
  s_add_u32 s46, s62, 32896
  buffer_load_dwordx4 v12, s[36:39], s46 offen offset:0  lds
  buffer_load_dwordx4 v13, s[36:39], s46 offen offset:1024  lds
  buffer_load_dwordx4 v14, s[36:39], s46 offen offset:2048  lds
  buffer_load_dwordx4 v15, s[36:39], s46 offen offset:3072  lds
  s_waitcnt vmcnt(16)
  v_mov_b32 v5, 24
  ds_write_b32 v3, v5
  s_mov_b32 s28, s76
  s_and_b32 s29, s77, 0xffff
  s_mov_b32 s30, 0x158000
  s_mov_b32 s31, 0x00020000
  s_cmp_eq_u32 s12, 15
  s_cbranch_scc1 SK3_174a
  ds_read_b32 v4, v2
  s_movk_i32 s47, 22
  s_waitcnt lgkmcnt(0)
  v_cmp_gt_u32 vcc, 22, v4
  s_cbranch_vccz CK_175
  s_waitcnt vmcnt(0)
  v_mov_b32 v5, 27
  ds_write_b32 v3, v5
  s_call_b64 s[18:19], WAITC
CK_175:
  s_mov_b32 m0, 81920
  s_add_u32 s46, s49, 0
  buffer_load_dwordx4 v16, s[28:31], s46 offen offset:0  lds
  buffer_load_dwordx4 v17, s[28:31], s46 offen offset:1024  lds
  buffer_load_dwordx4 v18, s[28:31], s46 offen offset:2048  lds
  s_mov_b32 m0, 84992
  s_add_u32 s46, s49, 44032
  buffer_load_dwordx4 v16, s[28:31], s46 offen offset:0  lds
  buffer_load_dwordx4 v17, s[28:31], s46 offen offset:1024  lds
  buffer_load_dwordx4 v18, s[28:31], s46 offen offset:2048  lds
  s_mov_b32 m0, 88064
  s_add_u32 s46, s49, 88064
  buffer_load_dwordx4 v16, s[28:31], s46 offen offset:0  lds
  buffer_load_dwordx4 v17, s[28:31], s46 offen offset:1024  lds
  buffer_load_dwordx4 v18, s[28:31], s46 offen offset:2048  lds
  s_mov_b32 m0, 91136
  s_add_u32 s46, s49, 132096
  buffer_load_dwordx4 v16, s[28:31], s46 offen offset:0  lds
  buffer_load_dwordx4 v17, s[28:31], s46 offen offset:1024  lds
  buffer_load_dwordx4 v18, s[28:31], s46 offen offset:2048  lds
  s_waitcnt vmcnt(12)
  v_mov_b32 v5, 27
  ds_write_b32 v3, v5
  s_mov_b32 m0, 106496
  s_add_u32 s46, s49, 352256
  buffer_load_dwordx4 v16, s[28:31], s46 offen offset:0  lds
  buffer_load_dwordx4 v17, s[28:31], s46 offen offset:1024  lds
  buffer_load_dwordx4 v18, s[28:31], s46 offen offset:2048  lds
  s_mov_b32 m0, 109568
  s_add_u32 s46, s49, 396288
  buffer_load_dwordx4 v16, s[28:31], s46 offen offset:0  lds
  buffer_load_dwordx4 v17, s[28:31], s46 offen offset:1024  lds
  buffer_load_dwordx4 v18, s[28:31], s46 offen offset:2048  lds
  s_mov_b32 m0, 112640
  s_add_u32 s46, s49, 440320
  buffer_load_dwordx4 v16, s[28:31], s46 offen offset:0  lds
  buffer_load_dwordx4 v17, s[28:31], s46 offen offset:1024  lds
  buffer_load_dwordx4 v18, s[28:31], s46 offen offset:2048  lds
  s_mov_b32 m0, 115712
  s_add_u32 s46, s49, 484352
  buffer_load_dwordx4 v16, s[28:31], s46 offen offset:0  lds
  buffer_load_dwordx4 v17, s[28:31], s46 offen offset:1024  lds
  buffer_load_dwordx4 v18, s[28:31], s46 offen offset:2048  lds
  s_waitcnt vmcnt(12)
  v_mov_b32 v5, 29
  ds_write_b32 v3, v5
  s_mov_b32 m0, 131072
  s_add_u32 s46, s49, 704512
  buffer_load_dwordx4 v16, s[28:31], s46 offen offset:0  lds
  buffer_load_dwordx4 v17, s[28:31], s46 offen offset:1024  lds
  buffer_load_dwordx4 v18, s[28:31], s46 offen offset:2048  lds
  s_mov_b32 m0, 134144
  s_add_u32 s46, s49, 748544
  buffer_load_dwordx4 v16, s[28:31], s46 offen offset:0  lds
  buffer_load_dwordx4 v17, s[28:31], s46 offen offset:1024  lds
  buffer_load_dwordx4 v18, s[28:31], s46 offen offset:2048  lds
  s_mov_b32 m0, 137216
  s_add_u32 s46, s49, 792576
  buffer_load_dwordx4 v16, s[28:31], s46 offen offset:0  lds
  buffer_load_dwordx4 v17, s[28:31], s46 offen offset:1024  lds
  buffer_load_dwordx4 v18, s[28:31], s46 offen offset:2048  lds
  s_mov_b32 m0, 140288
  s_add_u32 s46, s49, 836608
  buffer_load_dwordx4 v16, s[28:31], s46 offen offset:0  lds
  buffer_load_dwordx4 v17, s[28:31], s46 offen offset:1024  lds
  buffer_load_dwordx4 v18, s[28:31], s46 offen offset:2048  lds
  s_waitcnt vmcnt(12)
  v_mov_b32 v5, 31
  ds_write_b32 v3, v5
  s_mov_b32 m0, 0
  s_add_u32 s46, s49, 1056768
  buffer_load_dwordx4 v16, s[28:31], s46 offen offset:0  lds
  buffer_load_dwordx4 v17, s[28:31], s46 offen offset:1024  lds
  buffer_load_dwordx4 v18, s[28:31], s46 offen offset:2048  lds
  s_mov_b32 m0, 3072
  s_add_u32 s46, s49, 1100800
  buffer_load_dwordx4 v16, s[28:31], s46 offen offset:0  lds
  buffer_load_dwordx4 v17, s[28:31], s46 offen offset:1024  lds
  buffer_load_dwordx4 v18, s[28:31], s46 offen offset:2048  lds
  s_mov_b32 m0, 6144
  s_add_u32 s46, s49, 1144832
  buffer_load_dwordx4 v16, s[28:31], s46 offen offset:0  lds
  buffer_load_dwordx4 v17, s[28:31], s46 offen offset:1024  lds
  buffer_load_dwordx4 v18, s[28:31], s46 offen offset:2048  lds
  s_mov_b32 m0, 9216
  s_add_u32 s46, s49, 1188864
  buffer_load_dwordx4 v16, s[28:31], s46 offen offset:0  lds
  buffer_load_dwordx4 v17, s[28:31], s46 offen offset:1024  lds
  buffer_load_dwordx4 v18, s[28:31], s46 offen offset:2048  lds
  s_waitcnt vmcnt(12)
  v_mov_b32 v5, 33
  ds_write_b32 v3, v5
SK3_174:
  ds_read_b32 v4, v2
  s_movk_i32 s47, 22
  s_waitcnt lgkmcnt(0)
  v_cmp_gt_u32 vcc, 22, v4
  s_cbranch_vccz CK_176
  s_waitcnt vmcnt(0)
  v_mov_b32 v5, 36
  ds_write_b32 v3, v5
  s_call_b64 s[18:19], WAITC
CK_176:
  s_mov_b32 m0, 24576
  s_add_u32 s46, s50, 0
  buffer_load_dwordx4 v20, s[92:95], s46 offen offset:0  lds
  buffer_load_dwordx4 v21, s[92:95], s46 offen offset:1024  lds
  buffer_load_dwordx4 v22, s[92:95], s46 offen offset:2048  lds
  buffer_load_dwordx4 v23, s[92:95], s46 offen offset:3072  lds
  s_mov_b32 m0, 28672
  s_add_u32 s46, s50, 32768
  buffer_load_dwordx4 v20, s[92:95], s46 offen offset:0  lds
  buffer_load_dwordx4 v21, s[92:95], s46 offen offset:1024  lds
  buffer_load_dwordx4 v22, s[92:95], s46 offen offset:2048  lds
  buffer_load_dwordx4 v23, s[92:95], s46 offen offset:3072  lds
  s_mov_b32 m0, 32768
  s_add_u32 s46, s50, 65536
  buffer_load_dwordx4 v20, s[92:95], s46 offen offset:0  lds
  buffer_load_dwordx4 v21, s[92:95], s46 offen offset:1024  lds
  buffer_load_dwordx4 v22, s[92:95], s46 offen offset:2048  lds
  buffer_load_dwordx4 v23, s[92:95], s46 offen offset:3072  lds
  s_mov_b32 m0, 36864
  s_add_u32 s46, s50, 98304
  buffer_load_dwordx4 v20, s[92:95], s46 offen offset:0  lds
  buffer_load_dwordx4 v21, s[92:95], s46 offen offset:1024  lds
  buffer_load_dwordx4 v22, s[92:95], s46 offen offset:2048  lds
  buffer_load_dwordx4 v23, s[92:95], s46 offen offset:3072  lds
  s_waitcnt vmcnt(16)
  v_mov_b32 v5, 36
  ds_write_b32 v3, v5
  ds_read_b32 v4, v2
  s_movk_i32 s47, 24
  s_waitcnt lgkmcnt(0)
  v_cmp_gt_u32 vcc, 24, v4
  s_cbranch_vccz CK_177
  s_waitcnt vmcnt(0)
  v_mov_b32 v5, 38
  ds_write_b32 v3, v5
  s_call_b64 s[18:19], WAITC
CK_177:
  s_mov_b32 m0, 57344
  s_add_u32 s46, s50, 262144
  buffer_load_dwordx4 v20, s[92:95], s46 offen offset:0  lds
  buffer_load_dwordx4 v21, s[92:95], s46 offen offset:1024  lds
  buffer_load_dwordx4 v22, s[92:95], s46 offen offset:2048  lds
  buffer_load_dwordx4 v23, s[92:95], s46 offen offset:3072  lds
  s_mov_b32 m0, 61440
  s_add_u32 s46, s50, 294912
  buffer_load_dwordx4 v20, s[92:95], s46 offen offset:0  lds
  buffer_load_dwordx4 v21, s[92:95], s46 offen offset:1024  lds
  buffer_load_dwordx4 v22, s[92:95], s46 offen offset:2048  lds
  buffer_load_dwordx4 v23, s[92:95], s46 offen offset:3072  lds
  s_mov_b32 m0, 65536
  s_add_u32 s46, s50, 327680
  buffer_load_dwordx4 v20, s[92:95], s46 offen offset:0  lds
  buffer_load_dwordx4 v21, s[92:95], s46 offen offset:1024  lds
  buffer_load_dwordx4 v22, s[92:95], s46 offen offset:2048  lds
  buffer_load_dwordx4 v23, s[92:95], s46 offen offset:3072  lds
  s_mov_b32 m0, 69632
  s_add_u32 s46, s50, 360448
  buffer_load_dwordx4 v20, s[92:95], s46 offen offset:0  lds
  buffer_load_dwordx4 v21, s[92:95], s46 offen offset:1024  lds
  buffer_load_dwordx4 v22, s[92:95], s46 offen offset:2048  lds
  buffer_load_dwordx4 v23, s[92:95], s46 offen offset:3072  lds
  s_waitcnt vmcnt(16)
  v_mov_b32 v5, 38
  ds_write_b32 v3, v5
  ds_read_b32 v4, v2
  s_movk_i32 s47, 26
  s_waitcnt lgkmcnt(0)
  v_cmp_gt_u32 vcc, 26, v4
  s_cbranch_vccz CK_178
  s_waitcnt vmcnt(0)
  v_mov_b32 v5, 40
  ds_write_b32 v3, v5
  s_call_b64 s[18:19], WAITC
CK_178:
  s_mov_b32 m0, 90112
  s_add_u32 s46, s50, 524288
  buffer_load_dwordx4 v20, s[92:95], s46 offen offset:0  lds
  buffer_load_dwordx4 v21, s[92:95], s46 offen offset:1024  lds
  buffer_load_dwordx4 v22, s[92:95], s46 offen offset:2048  lds
  buffer_load_dwordx4 v23, s[92:95], s46 offen offset:3072  lds
  s_mov_b32 m0, 94208
  s_add_u32 s46, s50, 557056
  buffer_load_dwordx4 v20, s[92:95], s46 offen offset:0  lds
  buffer_load_dwordx4 v21, s[92:95], s46 offen offset:1024  lds
  buffer_load_dwordx4 v22, s[92:95], s46 offen offset:2048  lds
  buffer_load_dwordx4 v23, s[92:95], s46 offen offset:3072  lds
  s_mov_b32 m0, 98304
  s_add_u32 s46, s50, 589824
  buffer_load_dwordx4 v20, s[92:95], s46 offen offset:0  lds
  buffer_load_dwordx4 v21, s[92:95], s46 offen offset:1024  lds
  buffer_load_dwordx4 v22, s[92:95], s46 offen offset:2048  lds
  buffer_load_dwordx4 v23, s[92:95], s46 offen offset:3072  lds
  s_mov_b32 m0, 102400
  s_add_u32 s46, s50, 622592
  buffer_load_dwordx4 v20, s[92:95], s46 offen offset:0  lds
  buffer_load_dwordx4 v21, s[92:95], s46 offen offset:1024  lds
  buffer_load_dwordx4 v22, s[92:95], s46 offen offset:2048  lds
  buffer_load_dwordx4 v23, s[92:95], s46 offen offset:3072  lds
  s_waitcnt vmcnt(16)
  v_mov_b32 v5, 40
  ds_write_b32 v3, v5
  ds_read_b32 v4, v2
  s_movk_i32 s47, 29
  s_waitcnt lgkmcnt(0)
  v_cmp_gt_u32 vcc, 29, v4
  s_cbranch_vccz CK_179
  s_waitcnt vmcnt(0)
  v_mov_b32 v5, 42
  ds_write_b32 v3, v5
  s_call_b64 s[18:19], WAITC
CK_179:
  s_mov_b32 m0, 122880
  s_add_u32 s46, s50, 786432
  buffer_load_dwordx4 v20, s[92:95], s46 offen offset:0  lds
  buffer_load_dwordx4 v21, s[92:95], s46 offen offset:1024  lds
  buffer_load_dwordx4 v22, s[92:95], s46 offen offset:2048  lds
  buffer_load_dwordx4 v23, s[92:95], s46 offen offset:3072  lds
  s_mov_b32 m0, 126976
  s_add_u32 s46, s50, 819200
  buffer_load_dwordx4 v20, s[92:95], s46 offen offset:0  lds
  buffer_load_dwordx4 v21, s[92:95], s46 offen offset:1024  lds
  buffer_load_dwordx4 v22, s[92:95], s46 offen offset:2048  lds
  buffer_load_dwordx4 v23, s[92:95], s46 offen offset:3072  lds
  s_mov_b32 m0, 131072
  s_add_u32 s46, s50, 851968
  buffer_load_dwordx4 v20, s[92:95], s46 offen offset:0  lds
  buffer_load_dwordx4 v21, s[92:95], s46 offen offset:1024  lds
  buffer_load_dwordx4 v22, s[92:95], s46 offen offset:2048  lds
  buffer_load_dwordx4 v23, s[92:95], s46 offen offset:3072  lds
  s_mov_b32 m0, 135168
  s_add_u32 s46, s50, 884736
  buffer_load_dwordx4 v20, s[92:95], s46 offen offset:0  lds
  buffer_load_dwordx4 v21, s[92:95], s46 offen offset:1024  lds
  buffer_load_dwordx4 v22, s[92:95], s46 offen offset:2048  lds
  buffer_load_dwordx4 v23, s[92:95], s46 offen offset:3072  lds
  s_waitcnt vmcnt(16)
  v_mov_b32 v5, 42
  ds_write_b32 v3, v5
  ds_read_b32 v4, v2
  s_movk_i32 s47, 32
  s_waitcnt lgkmcnt(0)
  v_cmp_gt_u32 vcc, 32, v4
  s_cbranch_vccz CK_180
  s_waitcnt vmcnt(0)
  v_mov_b32 v5, 44
  ds_write_b32 v3, v5
  s_call_b64 s[18:19], WAITC
CK_180:
  s_mov_b32 m0, 0
  s_add_u32 s46, s50, 1048576
  buffer_load_dwordx4 v20, s[92:95], s46 offen offset:0  lds
  buffer_load_dwordx4 v21, s[92:95], s46 offen offset:1024  lds
  buffer_load_dwordx4 v22, s[92:95], s46 offen offset:2048  lds
  buffer_load_dwordx4 v23, s[92:95], s46 offen offset:3072  lds
  s_mov_b32 m0, 4096
  s_add_u32 s46, s50, 1081344
  buffer_load_dwordx4 v20, s[92:95], s46 offen offset:0  lds
  buffer_load_dwordx4 v21, s[92:95], s46 offen offset:1024  lds
  buffer_load_dwordx4 v22, s[92:95], s46 offen offset:2048  lds
  buffer_load_dwordx4 v23, s[92:95], s46 offen offset:3072  lds
  s_mov_b32 m0, 8192
  s_add_u32 s46, s50, 1114112
  buffer_load_dwordx4 v20, s[92:95], s46 offen offset:0  lds
  buffer_load_dwordx4 v21, s[92:95], s46 offen offset:1024  lds
  buffer_load_dwordx4 v22, s[92:95], s46 offen offset:2048  lds
  buffer_load_dwordx4 v23, s[92:95], s46 offen offset:3072  lds
  s_mov_b32 m0, 12288
  s_add_u32 s46, s50, 1146880
  buffer_load_dwordx4 v20, s[92:95], s46 offen offset:0  lds
  buffer_load_dwordx4 v21, s[92:95], s46 offen offset:1024  lds
  buffer_load_dwordx4 v22, s[92:95], s46 offen offset:2048  lds
  buffer_load_dwordx4 v23, s[92:95], s46 offen offset:3072  lds
  s_waitcnt vmcnt(16)
  v_mov_b32 v5, 44
  ds_write_b32 v3, v5
  ds_read_b32 v4, v2
  s_movk_i32 s47, 34
  s_waitcnt lgkmcnt(0)
  v_cmp_gt_u32 vcc, 34, v4
  s_cbranch_vccz CK_181
  s_waitcnt vmcnt(0)
  v_mov_b32 v5, 46
  ds_write_b32 v3, v5
  s_call_b64 s[18:19], WAITC
CK_181:
  s_mov_b32 m0, 32768
  s_add_u32 s46, s50, 1310720
  buffer_load_dwordx4 v20, s[92:95], s46 offen offset:0  lds
  buffer_load_dwordx4 v21, s[92:95], s46 offen offset:1024  lds
  buffer_load_dwordx4 v22, s[92:95], s46 offen offset:2048  lds
  buffer_load_dwordx4 v23, s[92:95], s46 offen offset:3072  lds
  s_mov_b32 m0, 36864
  s_add_u32 s46, s50, 1343488
  buffer_load_dwordx4 v20, s[92:95], s46 offen offset:0  lds
  buffer_load_dwordx4 v21, s[92:95], s46 offen offset:1024  lds
  buffer_load_dwordx4 v22, s[92:95], s46 offen offset:2048  lds
  buffer_load_dwordx4 v23, s[92:95], s46 offen offset:3072  lds
  s_mov_b32 m0, 40960
  s_add_u32 s46, s50, 1376256
  buffer_load_dwordx4 v20, s[92:95], s46 offen offset:0  lds
  buffer_load_dwordx4 v21, s[92:95], s46 offen offset:1024  lds
  buffer_load_dwordx4 v22, s[92:95], s46 offen offset:2048  lds
  buffer_load_dwordx4 v23, s[92:95], s46 offen offset:3072  lds
  s_waitcnt vmcnt(12)
  v_mov_b32 v5, 46
  ds_write_b32 v3, v5
  s_waitcnt vmcnt(0)
  v_mov_b32 v5, 47
  ds_write_b32 v3, v5
  s_endpgm
SK3_174a:
  s_waitcnt vmcnt(0)
  v_mov_b32 v5, 27
  ds_write_b32 v3, v5
  s_branch SK3_174
LOAD1:
  v_mov_b32 v6, 0
  v_lshlrev_b32 v3, 2, v1
  v_add_u32 v3, 158976, v3
  v_and_b32 v2, 7, v1
  v_cmp_gt_u32 vcc, 4, v2
  s_nop 1
  v_cndmask_b32 v4, 6, v2, vcc
  v_lshlrev_b32 v2, 2, v2
  v_lshl_add_u32 v2, v4, 8, v2
  v_add_u32 v2, 157696, v2
  v_mov_b32 v26, 157696
  v_lshl_add_u32 v12, v42, 10, v45
  v_lshl_add_u32 v13, v42, 10, v46
  v_add_u32 v13, 7168, v13
  v_add_u32 v14, 14336, v12
  v_add_u32 v15, 14336, v13
  v_lshlrev_b32 v45, 1, v44
  v_xor_b32 v45, v43, v45
  v_lshlrev_b32 v45, 4, v45
  v_lshl_add_u32 v20, v42, 10, v45
  v_add_u32 v21, 7168, v20
  v_add_u32 v22, 14336, v20
  v_add_u32 v23, 21504, v20
  v_add_u32 v45, 0, v1
  v_mul_u32_u24 v46, 0x1556, v45
  v_lshrrev_b32 v46, 16, v46
  v_mul_u32_u24 v47, 12, v46
  v_sub_u32 v45, v45, v47
  v_bfe_u32 v47, v46, 2, 1
  v_lshlrev_b32 v47, 1, v47
  v_xor_b32 v45, v45, v47
  v_mul_u32_u24 v46, 2752, v46
  v_lshl_add_u32 v16, v45, 4, v46
  v_add_u32 v45, 64, v1
  v_mul_u32_u24 v46, 0x1556, v45
  v_lshrrev_b32 v46, 16, v46
  v_mul_u32_u24 v47, 12, v46
  v_sub_u32 v45, v45, v47
  v_bfe_u32 v47, v46, 2, 1
  v_lshlrev_b32 v47, 1, v47
  v_xor_b32 v45, v45, v47
  v_mul_u32_u24 v46, 2752, v46
  v_lshl_add_u32 v17, v45, 4, v46
  v_subrev_u32 v17, 1024, v17
  v_add_u32 v45, 128, v1
  v_mul_u32_u24 v46, 0x1556, v45
  v_lshrrev_b32 v46, 16, v46
  v_mul_u32_u24 v47, 12, v46
  v_sub_u32 v45, v45, v47
  v_bfe_u32 v47, v46, 2, 1
  v_lshlrev_b32 v47, 1, v47
  v_xor_b32 v45, v45, v47
  v_mul_u32_u24 v46, 2752, v46
  v_lshl_add_u32 v18, v45, 4, v46
  v_subrev_u32 v18, 2048, v18
  s_mov_b32 s40, s66
  s_and_b32 s41, s67, 0xffff
  s_mov_b32 s42, 0x800000
  s_mov_b32 s43, 0x00020000
  s_lshl_b32 s48, s10, 16
  s_add_u32 s44, s10, 0
  s_and_b32 s44, s44, 3
  s_lshl_b32 s44, s44, 8
  s_add_u32 s60, s48, s44
  s_add_u32 s44, s10, 1
  s_and_b32 s44, s44, 3
  s_lshl_b32 s44, s44, 8
  s_add_u32 s61, s48, s44
  s_add_u32 s44, s10, 2
  s_and_b32 s44, s44, 3
  s_lshl_b32 s44, s44, 8
  s_add_u32 s62, s48, s44
  s_add_u32 s44, s10, 3
  s_and_b32 s44, s44, 3
  s_lshl_b32 s44, s44, 8
  s_add_u32 s63, s48, s44
  s_mul_i32 s49, s12, 192
  s_lshl_b32 s50, s10, 7
WR_182:
  ds_read_b32 v4, v26 offset:2304
  s_sub_u32 s13, s13, 1
  s_cbranch_scc1 ABORT
  s_waitcnt lgkmcnt(0)
  v_cmp_gt_u32 vcc, 4, v4
  s_cbranch_vccnz WR_182
  s_mov_b32 m0, 49152
  s_add_u32 s46, s56, 256
  buffer_load_dwordx4 v8, s[28:31], s46 offen offset:0  lds
  buffer_load_dwordx4 v9, s[28:31], s46 offen offset:1024  lds
  buffer_load_dwordx4 v10, s[28:31], s46 offen offset:2048  lds
  buffer_load_dwordx4 v11, s[28:31], s46 offen offset:3072  lds
  s_mov_b32 m0, 53248
  s_add_u32 s46, s56, 131328
  buffer_load_dwordx4 v8, s[28:31], s46 offen offset:0  lds
  buffer_load_dwordx4 v9, s[28:31], s46 offen offset:1024  lds
  buffer_load_dwordx4 v10, s[28:31], s46 offen offset:2048  lds
  buffer_load_dwordx4 v11, s[28:31], s46 offen offset:3072  lds
  s_mov_b32 m0, 57344
  s_add_u32 s46, s56, 384
  buffer_load_dwordx4 v8, s[28:31], s46 offen offset:0  lds
  buffer_load_dwordx4 v9, s[28:31], s46 offen offset:1024  lds
  buffer_load_dwordx4 v10, s[28:31], s46 offen offset:2048  lds
  buffer_load_dwordx4 v11, s[28:31], s46 offen offset:3072  lds
  s_mov_b32 m0, 61440
  s_add_u32 s46, s56, 131456
  buffer_load_dwordx4 v8, s[28:31], s46 offen offset:0  lds
  buffer_load_dwordx4 v9, s[28:31], s46 offen offset:1024  lds
  buffer_load_dwordx4 v10, s[28:31], s46 offen offset:2048  lds
  buffer_load_dwordx4 v11, s[28:31], s46 offen offset:3072  lds
  s_waitcnt vmcnt(16)
  v_mov_b32 v5, 4
  ds_write_b32 v3, v5
  s_waitcnt vmcnt(0)
  v_mov_b32 v5, 6
  ds_write_b32 v3, v5
  s_mov_b32 m0, 81920
  s_add_u32 s46, s57, 0
  buffer_load_dwordx4 v8, s[28:31], s46 offen offset:0  lds
  buffer_load_dwordx4 v9, s[28:31], s46 offen offset:1024  lds
  buffer_load_dwordx4 v10, s[28:31], s46 offen offset:2048  lds
  buffer_load_dwordx4 v11, s[28:31], s46 offen offset:3072  lds
  s_mov_b32 m0, 86016
  s_add_u32 s46, s57, 131072
  buffer_load_dwordx4 v8, s[28:31], s46 offen offset:0  lds
  buffer_load_dwordx4 v9, s[28:31], s46 offen offset:1024  lds
  buffer_load_dwordx4 v10, s[28:31], s46 offen offset:2048  lds
  buffer_load_dwordx4 v11, s[28:31], s46 offen offset:3072  lds
  s_mov_b32 m0, 90112
  s_add_u32 s46, s57, 128
  buffer_load_dwordx4 v8, s[28:31], s46 offen offset:0  lds
  buffer_load_dwordx4 v9, s[28:31], s46 offen offset:1024  lds
  buffer_load_dwordx4 v10, s[28:31], s46 offen offset:2048  lds
  buffer_load_dwordx4 v11, s[28:31], s46 offen offset:3072  lds
  s_mov_b32 m0, 94208
  s_add_u32 s46, s57, 131200
  buffer_load_dwordx4 v8, s[28:31], s46 offen offset:0  lds
  buffer_load_dwordx4 v9, s[28:31], s46 offen offset:1024  lds
  buffer_load_dwordx4 v10, s[28:31], s46 offen offset:2048  lds
  buffer_load_dwordx4 v11, s[28:31], s46 offen offset:3072  lds
  s_mov_b32 m0, 114688
  s_add_u32 s46, s57, 256
  buffer_load_dwordx4 v8, s[28:31], s46 offen offset:0  lds
  buffer_load_dwordx4 v9, s[28:31], s46 offen offset:1024  lds
  buffer_load_dwordx4 v10, s[28:31], s46 offen offset:2048  lds
  buffer_load_dwordx4 v11, s[28:31], s46 offen offset:3072  lds
  s_mov_b32 m0, 118784
  s_add_u32 s46, s57, 131328
  buffer_load_dwordx4 v8, s[28:31], s46 offen offset:0  lds
  buffer_load_dwordx4 v9, s[28:31], s46 offen offset:1024  lds
  buffer_load_dwordx4 v10, s[28:31], s46 offen offset:2048  lds
  buffer_load_dwordx4 v11, s[28:31], s46 offen offset:3072  lds
  s_mov_b32 m0, 122880
  s_add_u32 s46, s57, 384
  buffer_load_dwordx4 v8, s[28:31], s46 offen offset:0  lds
  buffer_load_dwordx4 v9, s[28:31], s46 offen offset:1024  lds
  buffer_load_dwordx4 v10, s[28:31], s46 offen offset:2048  lds
  buffer_load_dwordx4 v11, s[28:31], s46 offen offset:3072  lds
  s_mov_b32 m0, 126976
  s_add_u32 s46, s57, 131456
  buffer_load_dwordx4 v8, s[28:31], s46 offen offset:0  lds
  buffer_load_dwordx4 v9, s[28:31], s46 offen offset:1024  lds
  buffer_load_dwordx4 v10, s[28:31], s46 offen offset:2048  lds
  buffer_load_dwordx4 v11, s[28:31], s46 offen offset:3072  lds
  s_waitcnt vmcnt(16)
  v_mov_b32 v5, 8
  ds_write_b32 v3, v5
  ds_read_b32 v4, v2
  s_movk_i32 s47, 1
  s_waitcnt lgkmcnt(0)
  v_cmp_gt_u32 vcc, 1, v4
  s_cbranch_vccz CK_183
  s_waitcnt vmcnt(0)
  v_mov_b32 v5, 10
  ds_write_b32 v3, v5
  s_call_b64 s[18:19], WAITC
CK_183:
  s_mov_b32 m0, 147456
  s_add_u32 s46, s58, 0
  buffer_load_dwordx4 v8, s[28:31], s46 offen offset:0  lds
  buffer_load_dwordx4 v9, s[28:31], s46 offen offset:1024  lds
  buffer_load_dwordx4 v10, s[28:31], s46 offen offset:2048  lds
  buffer_load_dwordx4 v11, s[28:31], s46 offen offset:3072  lds
  s_mov_b32 m0, 151552
  s_add_u32 s46, s58, 131072
  buffer_load_dwordx4 v8, s[28:31], s46 offen offset:0  lds
  buffer_load_dwordx4 v9, s[28:31], s46 offen offset:1024  lds
  buffer_load_dwordx4 v10, s[28:31], s46 offen offset:2048  lds
  buffer_load_dwordx4 v11, s[28:31], s46 offen offset:3072  lds
  s_mov_b32 m0, 0
  s_add_u32 s46, s58, 128
  buffer_load_dwordx4 v8, s[28:31], s46 offen offset:0  lds
  buffer_load_dwordx4 v9, s[28:31], s46 offen offset:1024  lds
  buffer_load_dwordx4 v10, s[28:31], s46 offen offset:2048  lds
  buffer_load_dwordx4 v11, s[28:31], s46 offen offset:3072  lds
  s_mov_b32 m0, 4096
  s_add_u32 s46, s58, 131200
  buffer_load_dwordx4 v8, s[28:31], s46 offen offset:0  lds
  buffer_load_dwordx4 v9, s[28:31], s46 offen offset:1024  lds
  buffer_load_dwordx4 v10, s[28:31], s46 offen offset:2048  lds
  buffer_load_dwordx4 v11, s[28:31], s46 offen offset:3072  lds
  s_waitcnt vmcnt(16)
  v_mov_b32 v5, 10
  ds_write_b32 v3, v5
  ds_read_b32 v4, v2
  s_movk_i32 s47, 3
  s_waitcnt lgkmcnt(0)
  v_cmp_gt_u32 vcc, 3, v4
  s_cbranch_vccz CK_184
  s_waitcnt vmcnt(0)
  v_mov_b32 v5, 12
  ds_write_b32 v3, v5
  s_call_b64 s[18:19], WAITC
CK_184:
  s_mov_b32 m0, 24576
  s_add_u32 s46, s59, 0
  buffer_load_dwordx4 v8, s[40:43], s46 offen offset:0  lds
  buffer_load_dwordx4 v9, s[40:43], s46 offen offset:1024  lds
  buffer_load_dwordx4 v10, s[40:43], s46 offen offset:2048  lds
  buffer_load_dwordx4 v11, s[40:43], s46 offen offset:3072  lds
  s_mov_b32 m0, 28672
  s_add_u32 s46, s59, 131072
  buffer_load_dwordx4 v8, s[40:43], s46 offen offset:0  lds
  buffer_load_dwordx4 v9, s[40:43], s46 offen offset:1024  lds
  buffer_load_dwordx4 v10, s[40:43], s46 offen offset:2048  lds
  buffer_load_dwordx4 v11, s[40:43], s46 offen offset:3072  lds
  s_mov_b32 m0, 32768
  s_add_u32 s46, s59, 128
  buffer_load_dwordx4 v8, s[40:43], s46 offen offset:0  lds
  buffer_load_dwordx4 v9, s[40:43], s46 offen offset:1024  lds
  buffer_load_dwordx4 v10, s[40:43], s46 offen offset:2048  lds
  buffer_load_dwordx4 v11, s[40:43], s46 offen offset:3072  lds
  s_mov_b32 m0, 36864
  s_add_u32 s46, s59, 131200
  buffer_load_dwordx4 v8, s[40:43], s46 offen offset:0  lds
  buffer_load_dwordx4 v9, s[40:43], s46 offen offset:1024  lds
  buffer_load_dwordx4 v10, s[40:43], s46 offen offset:2048  lds
  buffer_load_dwordx4 v11, s[40:43], s46 offen offset:3072  lds
  s_waitcnt vmcnt(16)
  v_mov_b32 v5, 12
  ds_write_b32 v3, v5
  ds_read_b32 v4, v2
  s_movk_i32 s47, 5
  s_waitcnt lgkmcnt(0)
  v_cmp_gt_u32 vcc, 5, v4
  s_cbranch_vccz CK_185
  s_waitcnt vmcnt(0)
  v_mov_b32 v5, 14
  ds_write_b32 v3, v5
  s_call_b64 s[18:19], WAITC
CK_185:
  s_mov_b32 m0, 57344
  s_add_u32 s46, s58, 256
  buffer_load_dwordx4 v8, s[28:31], s46 offen offset:0  lds
  buffer_load_dwordx4 v9, s[28:31], s46 offen offset:1024  lds
  buffer_load_dwordx4 v10, s[28:31], s46 offen offset:2048  lds
  buffer_load_dwordx4 v11, s[28:31], s46 offen offset:3072  lds
  s_mov_b32 m0, 61440
  s_add_u32 s46, s58, 131328
  buffer_load_dwordx4 v8, s[28:31], s46 offen offset:0  lds
  buffer_load_dwordx4 v9, s[28:31], s46 offen offset:1024  lds
  buffer_load_dwordx4 v10, s[28:31], s46 offen offset:2048  lds
  buffer_load_dwordx4 v11, s[28:31], s46 offen offset:3072  lds
  s_mov_b32 m0, 65536
  s_add_u32 s46, s58, 384
  buffer_load_dwordx4 v8, s[28:31], s46 offen offset:0  lds
  buffer_load_dwordx4 v9, s[28:31], s46 offen offset:1024  lds
  buffer_load_dwordx4 v10, s[28:31], s46 offen offset:2048  lds
  buffer_load_dwordx4 v11, s[28:31], s46 offen offset:3072  lds
  s_mov_b32 m0, 69632
  s_add_u32 s46, s58, 131456
  buffer_load_dwordx4 v8, s[28:31], s46 offen offset:0  lds
  buffer_load_dwordx4 v9, s[28:31], s46 offen offset:1024  lds
  buffer_load_dwordx4 v10, s[28:31], s46 offen offset:2048  lds
  buffer_load_dwordx4 v11, s[28:31], s46 offen offset:3072  lds
  s_waitcnt vmcnt(16)
  v_mov_b32 v5, 14
  ds_write_b32 v3, v5
  ds_read_b32 v4, v2
  s_movk_i32 s47, 7
  s_waitcnt lgkmcnt(0)
  v_cmp_gt_u32 vcc, 7, v4
  s_cbranch_vccz CK_186
  s_waitcnt vmcnt(0)
  v_mov_b32 v5, 16
  ds_write_b32 v3, v5
  s_call_b64 s[18:19], WAITC
CK_186:
  s_mov_b32 m0, 90112
  s_add_u32 s46, s59, 256
  buffer_load_dwordx4 v8, s[28:31], s46 offen offset:0  lds
  buffer_load_dwordx4 v9, s[28:31], s46 offen offset:1024  lds
  buffer_load_dwordx4 v10, s[28:31], s46 offen offset:2048  lds
  buffer_load_dwordx4 v11, s[28:31], s46 offen offset:3072  lds
  s_mov_b32 m0, 94208
  s_add_u32 s46, s59, 131328
  buffer_load_dwordx4 v8, s[28:31], s46 offen offset:0  lds
  buffer_load_dwordx4 v9, s[28:31], s46 offen offset:1024  lds
  buffer_load_dwordx4 v10, s[28:31], s46 offen offset:2048  lds
  buffer_load_dwordx4 v11, s[28:31], s46 offen offset:3072  lds
  s_mov_b32 m0, 98304
  s_add_u32 s46, s59, 384
  buffer_load_dwordx4 v8, s[28:31], s46 offen offset:0  lds
  buffer_load_dwordx4 v9, s[28:31], s46 offen offset:1024  lds
  buffer_load_dwordx4 v10, s[28:31], s46 offen offset:2048  lds
  buffer_load_dwordx4 v11, s[28:31], s46 offen offset:3072  lds
  s_mov_b32 m0, 102400
  s_add_u32 s46, s59, 131456
  buffer_load_dwordx4 v8, s[28:31], s46 offen offset:0  lds
  buffer_load_dwordx4 v9, s[28:31], s46 offen offset:1024  lds
  buffer_load_dwordx4 v10, s[28:31], s46 offen offset:2048  lds
  buffer_load_dwordx4 v11, s[28:31], s46 offen offset:3072  lds
  s_waitcnt vmcnt(16)
  v_mov_b32 v5, 16
  ds_write_b32 v3, v5
  s_mov_b32 s32, s70
  s_and_b32 s33, s71, 0xffff
  s_mov_b32 s34, 0x80000
  s_mov_b32 s35, 0x00020000
  s_mov_b32 s36, s72
  s_and_b32 s37, s73, 0xffff
  s_mov_b32 s38, 0x80000
  s_mov_b32 s39, 0x00020000
  s_mov_b32 s92, s78
  s_and_b32 s93, s79, 0xffff
  s_mov_b32 s94, 0x158000
  s_mov_b32 s95, 0x00020000
  ds_read_b32 v4, v2
  s_movk_i32 s47, 9
  s_waitcnt lgkmcnt(0)
  v_cmp_gt_u32 vcc, 9, v4
  s_cbranch_vccz CK_187
  s_waitcnt vmcnt(0)
  v_mov_b32 v5, 19
  ds_write_b32 v3, v5
  s_call_b64 s[18:19], WAITC
CK_187:
  s_mov_b32 m0, 122880
  s_add_u32 s46, s61, 0
  buffer_load_dwordx4 v12, s[32:35], s46 offen offset:0  lds
  buffer_load_dwordx4 v13, s[32:35], s46 offen offset:1024  lds
  buffer_load_dwordx4 v14, s[32:35], s46 offen offset:2048  lds
  buffer_load_dwordx4 v15, s[32:35], s46 offen offset:3072  lds
  s_mov_b32 m0, 126976
  s_add_u32 s46, s61, 32768
  buffer_load_dwordx4 v12, s[32:35], s46 offen offset:0  lds
  buffer_load_dwordx4 v13, s[32:35], s46 offen offset:1024  lds
  buffer_load_dwordx4 v14, s[32:35], s46 offen offset:2048  lds
  buffer_load_dwordx4 v15, s[32:35], s46 offen offset:3072  lds
  s_mov_b32 m0, 131072
  s_add_u32 s46, s61, 128
  buffer_load_dwordx4 v12, s[32:35], s46 offen offset:0  lds
  buffer_load_dwordx4 v13, s[32:35], s46 offen offset:1024  lds
  buffer_load_dwordx4 v14, s[32:35], s46 offen offset:2048  lds
  buffer_load_dwordx4 v15, s[32:35], s46 offen offset:3072  lds
  s_mov_b32 m0, 135168
  s_add_u32 s46, s61, 32896
  buffer_load_dwordx4 v12, s[32:35], s46 offen offset:0  lds
  buffer_load_dwordx4 v13, s[32:35], s46 offen offset:1024  lds
  buffer_load_dwordx4 v14, s[32:35], s46 offen offset:2048  lds
  buffer_load_dwordx4 v15, s[32:35], s46 offen offset:3072  lds
  s_waitcnt vmcnt(16)
  v_mov_b32 v5, 19
  ds_write_b32 v3, v5
  ds_read_b32 v4, v2
  s_movk_i32 s47, 11
  s_waitcnt lgkmcnt(0)
  v_cmp_gt_u32 vcc, 11, v4
  s_cbranch_vccz CK_188
  s_waitcnt vmcnt(0)
  v_mov_b32 v5, 21
  ds_write_b32 v3, v5
  s_call_b64 s[18:19], WAITC
CK_188:
  s_mov_b32 m0, 0
  s_add_u32 s46, s63, 0
  buffer_load_dwordx4 v12, s[32:35], s46 offen offset:0  lds
  buffer_load_dwordx4 v13, s[32:35], s46 offen offset:1024  lds
  buffer_load_dwordx4 v14, s[32:35], s46 offen offset:2048  lds
  buffer_load_dwordx4 v15, s[32:35], s46 offen offset:3072  lds
  s_mov_b32 m0, 4096
  s_add_u32 s46, s63, 32768
  buffer_load_dwordx4 v12, s[32:35], s46 offen offset:0  lds
  buffer_load_dwordx4 v13, s[32:35], s46 offen offset:1024  lds
  buffer_load_dwordx4 v14, s[32:35], s46 offen offset:2048  lds
  buffer_load_dwordx4 v15, s[32:35], s46 offen offset:3072  lds
  s_mov_b32 m0, 8192
  s_add_u32 s46, s63, 128
  buffer_load_dwordx4 v12, s[32:35], s46 offen offset:0  lds
  buffer_load_dwordx4 v13, s[32:35], s46 offen offset:1024  lds
  buffer_load_dwordx4 v14, s[32:35], s46 offen offset:2048  lds
  buffer_load_dwordx4 v15, s[32:35], s46 offen offset:3072  lds
  s_mov_b32 m0, 12288
  s_add_u32 s46, s63, 32896
  buffer_load_dwordx4 v12, s[32:35], s46 offen offset:0  lds
  buffer_load_dwordx4 v13, s[32:35], s46 offen offset:1024  lds
  buffer_load_dwordx4 v14, s[32:35], s46 offen offset:2048  lds
  buffer_load_dwordx4 v15, s[32:35], s46 offen offset:3072  lds
  s_waitcnt vmcnt(16)
  v_mov_b32 v5, 21
  ds_write_b32 v3, v5
  ds_read_b32 v4, v2
  s_movk_i32 s47, 13
  s_waitcnt lgkmcnt(0)
  v_cmp_gt_u32 vcc, 13, v4
  s_cbranch_vccz CK_189
  s_waitcnt vmcnt(0)
  v_mov_b32 v5, 23
  ds_write_b32 v3, v5
  s_call_b64 s[18:19], WAITC
CK_189:
  s_mov_b32 m0, 32768
  s_add_u32 s46, s61, 0
  buffer_load_dwordx4 v12, s[36:39], s46 offen offset:0  lds
  buffer_load_dwordx4 v13, s[36:39], s46 offen offset:1024  lds
  buffer_load_dwordx4 v14, s[36:39], s46 offen offset:2048  lds
  buffer_load_dwordx4 v15, s[36:39], s46 offen offset:3072  lds
  s_mov_b32 m0, 36864
  s_add_u32 s46, s61, 32768
  buffer_load_dwordx4 v12, s[36:39], s46 offen offset:0  lds
  buffer_load_dwordx4 v13, s[36:39], s46 offen offset:1024  lds
  buffer_load_dwordx4 v14, s[36:39], s46 offen offset:2048  lds
  buffer_load_dwordx4 v15, s[36:39], s46 offen offset:3072  lds
  s_mov_b32 m0, 40960
  s_add_u32 s46, s61, 128
  buffer_load_dwordx4 v12, s[36:39], s46 offen offset:0  lds
  buffer_load_dwordx4 v13, s[36:39], s46 offen offset:1024  lds
  buffer_load_dwordx4 v14, s[36:39], s46 offen offset:2048  lds
  buffer_load_dwordx4 v15, s[36:39], s46 offen offset:3072  lds
  s_mov_b32 m0, 45056
  s_add_u32 s46, s61, 32896
  buffer_load_dwordx4 v12, s[36:39], s46 offen offset:0  lds
  buffer_load_dwordx4 v13, s[36:39], s46 offen offset:1024  lds
  buffer_load_dwordx4 v14, s[36:39], s46 offen offset:2048  lds
  buffer_load_dwordx4 v15, s[36:39], s46 offen offset:3072  lds
  s_waitcnt vmcnt(16)
  v_mov_b32 v5, 23
  ds_write_b32 v3, v5
  ds_read_b32 v4, v2
  s_movk_i32 s47, 15
  s_waitcnt lgkmcnt(0)
  v_cmp_gt_u32 vcc, 15, v4
  s_cbranch_vccz CK_190
  s_waitcnt vmcnt(0)
  v_mov_b32 v5, 25
  ds_write_b32 v3, v5
  s_call_b64 s[18:19], WAITC
CK_190:
  s_mov_b32 m0, 65536
  s_add_u32 s46, s63, 0
  buffer_load_dwordx4 v12, s[36:39], s46 offen offset:0  lds
  buffer_load_dwordx4 v13, s[36:39], s46 offen offset:1024  lds
  buffer_load_dwordx4 v14, s[36:39], s46 offen offset:2048  lds
  buffer_load_dwordx4 v15, s[36:39], s46 offen offset:3072  lds
  s_mov_b32 m0, 69632
  s_add_u32 s46, s63, 32768
  buffer_load_dwordx4 v12, s[36:39], s46 offen offset:0  lds
  buffer_load_dwordx4 v13, s[36:39], s46 offen offset:1024  lds
  buffer_load_dwordx4 v14, s[36:39], s46 offen offset:2048  lds
  buffer_load_dwordx4 v15, s[36:39], s46 offen offset:3072  lds
  s_mov_b32 m0, 73728
  s_add_u32 s46, s63, 128
  buffer_load_dwordx4 v12, s[36:39], s46 offen offset:0  lds
  buffer_load_dwordx4 v13, s[36:39], s46 offen offset:1024  lds
  buffer_load_dwordx4 v14, s[36:39], s46 offen offset:2048  lds
  buffer_load_dwordx4 v15, s[36:39], s46 offen offset:3072  lds
  s_mov_b32 m0, 77824
  s_add_u32 s46, s63, 32896
  buffer_load_dwordx4 v12, s[36:39], s46 offen offset:0  lds
  buffer_load_dwordx4 v13, s[36:39], s46 offen offset:1024  lds
  buffer_load_dwordx4 v14, s[36:39], s46 offen offset:2048  lds
  buffer_load_dwordx4 v15, s[36:39], s46 offen offset:3072  lds
  s_waitcnt vmcnt(16)
  v_mov_b32 v5, 25
  ds_write_b32 v3, v5
  s_mov_b32 s28, s76
  s_and_b32 s29, s77, 0xffff
  s_mov_b32 s30, 0x158000
  s_mov_b32 s31, 0x00020000
  s_cmp_eq_u32 s12, 15
  s_cbranch_scc1 SK3_191a
  ds_read_b32 v4, v2
  s_movk_i32 s47, 22
  s_waitcnt lgkmcnt(0)
  v_cmp_gt_u32 vcc, 22, v4
  s_cbranch_vccz CK_192
  s_waitcnt vmcnt(0)
  v_mov_b32 v5, 28
  ds_write_b32 v3, v5
  s_call_b64 s[18:19], WAITC
CK_192:
  s_mov_b32 m0, 94208
  s_add_u32 s46, s49, 176128
  buffer_load_dwordx4 v16, s[28:31], s46 offen offset:0  lds
  buffer_load_dwordx4 v17, s[28:31], s46 offen offset:1024  lds
  buffer_load_dwordx4 v18, s[28:31], s46 offen offset:2048  lds
  s_mov_b32 m0, 97280
  s_add_u32 s46, s49, 220160
  buffer_load_dwordx4 v16, s[28:31], s46 offen offset:0  lds
  buffer_load_dwordx4 v17, s[28:31], s46 offen offset:1024  lds
  buffer_load_dwordx4 v18, s[28:31], s46 offen offset:2048  lds
  s_mov_b32 m0, 100352
  s_add_u32 s46, s49, 264192
  buffer_load_dwordx4 v16, s[28:31], s46 offen offset:0  lds
  buffer_load_dwordx4 v17, s[28:31], s46 offen offset:1024  lds
  buffer_load_dwordx4 v18, s[28:31], s46 offen offset:2048  lds
  s_mov_b32 m0, 103424
  s_add_u32 s46, s49, 308224
  buffer_load_dwordx4 v16, s[28:31], s46 offen offset:0  lds
  buffer_load_dwordx4 v17, s[28:31], s46 offen offset:1024  lds
  buffer_load_dwordx4 v18, s[28:31], s46 offen offset:2048  lds
  s_waitcnt vmcnt(12)
  v_mov_b32 v5, 28
  ds_write_b32 v3, v5
  s_mov_b32 m0, 118784
  s_add_u32 s46, s49, 528384
  buffer_load_dwordx4 v16, s[28:31], s46 offen offset:0  lds
  buffer_load_dwordx4 v17, s[28:31], s46 offen offset:1024  lds
  buffer_load_dwordx4 v18, s[28:31], s46 offen offset:2048  lds
  s_mov_b32 m0, 121856
  s_add_u32 s46, s49, 572416
  buffer_load_dwordx4 v16, s[28:31], s46 offen offset:0  lds
  buffer_load_dwordx4 v17, s[28:31], s46 offen offset:1024  lds
  buffer_load_dwordx4 v18, s[28:31], s46 offen offset:2048  lds
  s_mov_b32 m0, 124928
  s_add_u32 s46, s49, 616448
  buffer_load_dwordx4 v16, s[28:31], s46 offen offset:0  lds
  buffer_load_dwordx4 v17, s[28:31], s46 offen offset:1024  lds
  buffer_load_dwordx4 v18, s[28:31], s46 offen offset:2048  lds
  s_mov_b32 m0, 128000
  s_add_u32 s46, s49, 660480
  buffer_load_dwordx4 v16, s[28:31], s46 offen offset:0  lds
  buffer_load_dwordx4 v17, s[28:31], s46 offen offset:1024  lds
  buffer_load_dwordx4 v18, s[28:31], s46 offen offset:2048  lds
  s_waitcnt vmcnt(12)
  v_mov_b32 v5, 30
  ds_write_b32 v3, v5
  s_mov_b32 m0, 143360
  s_add_u32 s46, s49, 880640
  buffer_load_dwordx4 v16, s[28:31], s46 offen offset:0  lds
  buffer_load_dwordx4 v17, s[28:31], s46 offen offset:1024  lds
  buffer_load_dwordx4 v18, s[28:31], s46 offen offset:2048  lds
  s_mov_b32 m0, 146432
  s_add_u32 s46, s49, 924672
  buffer_load_dwordx4 v16, s[28:31], s46 offen offset:0  lds
  buffer_load_dwordx4 v17, s[28:31], s46 offen offset:1024  lds
  buffer_load_dwordx4 v18, s[28:31], s46 offen offset:2048  lds
  s_mov_b32 m0, 149504
  s_add_u32 s46, s49, 968704
  buffer_load_dwordx4 v16, s[28:31], s46 offen offset:0  lds
  buffer_load_dwordx4 v17, s[28:31], s46 offen offset:1024  lds
  buffer_load_dwordx4 v18, s[28:31], s46 offen offset:2048  lds
  s_mov_b32 m0, 152576
  s_add_u32 s46, s49, 1012736
  buffer_load_dwordx4 v16, s[28:31], s46 offen offset:0  lds
  buffer_load_dwordx4 v17, s[28:31], s46 offen offset:1024  lds
  buffer_load_dwordx4 v18, s[28:31], s46 offen offset:2048  lds
  s_waitcnt vmcnt(12)
  v_mov_b32 v5, 32
  ds_write_b32 v3, v5
  s_mov_b32 m0, 12288
  s_add_u32 s46, s49, 1232896
  buffer_load_dwordx4 v16, s[28:31], s46 offen offset:0  lds
  buffer_load_dwordx4 v17, s[28:31], s46 offen offset:1024  lds
  buffer_load_dwordx4 v18, s[28:31], s46 offen offset:2048  lds
  s_mov_b32 m0, 15360
  s_add_u32 s46, s49, 1276928
  buffer_load_dwordx4 v16, s[28:31], s46 offen offset:0  lds
  buffer_load_dwordx4 v17, s[28:31], s46 offen offset:1024  lds
  buffer_load_dwordx4 v18, s[28:31], s46 offen offset:2048  lds
  s_mov_b32 m0, 18432
  s_add_u32 s46, s49, 1320960
  buffer_load_dwordx4 v16, s[28:31], s46 offen offset:0  lds
  buffer_load_dwordx4 v17, s[28:31], s46 offen offset:1024  lds
  buffer_load_dwordx4 v18, s[28:31], s46 offen offset:2048  lds
  s_mov_b32 m0, 21504
  s_add_u32 s46, s49, 1364992
  buffer_load_dwordx4 v16, s[28:31], s46 offen offset:0  lds
  buffer_load_dwordx4 v17, s[28:31], s46 offen offset:1024  lds
  buffer_load_dwordx4 v18, s[28:31], s46 offen offset:2048  lds
  s_waitcnt vmcnt(12)
  v_mov_b32 v5, 34
  ds_write_b32 v3, v5
SK3_191:
  ds_read_b32 v4, v2
  s_movk_i32 s47, 23
  s_waitcnt lgkmcnt(0)
  v_cmp_gt_u32 vcc, 23, v4
  s_cbranch_vccz CK_193
  s_waitcnt vmcnt(0)
  v_mov_b32 v5, 37
  ds_write_b32 v3, v5
  s_call_b64 s[18:19], WAITC
CK_193:
  s_mov_b32 m0, 40960
  s_add_u32 s46, s50, 131072
  buffer_load_dwordx4 v20, s[92:95], s46 offen offset:0  lds
  buffer_load_dwordx4 v21, s[92:95], s46 offen offset:1024  lds
  buffer_load_dwordx4 v22, s[92:95], s46 offen offset:2048  lds
  buffer_load_dwordx4 v23, s[92:95], s46 offen offset:3072  lds
  s_mov_b32 m0, 45056
  s_add_u32 s46, s50, 163840
  buffer_load_dwordx4 v20, s[92:95], s46 offen offset:0  lds
  buffer_load_dwordx4 v21, s[92:95], s46 offen offset:1024  lds
  buffer_load_dwordx4 v22, s[92:95], s46 offen offset:2048  lds
  buffer_load_dwordx4 v23, s[92:95], s46 offen offset:3072  lds
  s_mov_b32 m0, 49152
  s_add_u32 s46, s50, 196608
  buffer_load_dwordx4 v20, s[92:95], s46 offen offset:0  lds
  buffer_load_dwordx4 v21, s[92:95], s46 offen offset:1024  lds
  buffer_load_dwordx4 v22, s[92:95], s46 offen offset:2048  lds
  buffer_load_dwordx4 v23, s[92:95], s46 offen offset:3072  lds
  s_mov_b32 m0, 53248
  s_add_u32 s46, s50, 229376
  buffer_load_dwordx4 v20, s[92:95], s46 offen offset:0  lds
  buffer_load_dwordx4 v21, s[92:95], s46 offen offset:1024  lds
  buffer_load_dwordx4 v22, s[92:95], s46 offen offset:2048  lds
  buffer_load_dwordx4 v23, s[92:95], s46 offen offset:3072  lds
  s_waitcnt vmcnt(16)
  v_mov_b32 v5, 37
  ds_write_b32 v3, v5
  ds_read_b32 v4, v2
  s_movk_i32 s47, 25
  s_waitcnt lgkmcnt(0)
  v_cmp_gt_u32 vcc, 25, v4
  s_cbranch_vccz CK_194
  s_waitcnt vmcnt(0)
  v_mov_b32 v5, 39
  ds_write_b32 v3, v5
  s_call_b64 s[18:19], WAITC
CK_194:
  s_mov_b32 m0, 73728
  s_add_u32 s46, s50, 393216
  buffer_load_dwordx4 v20, s[92:95], s46 offen offset:0  lds
  buffer_load_dwordx4 v21, s[92:95], s46 offen offset:1024  lds
  buffer_load_dwordx4 v22, s[92:95], s46 offen offset:2048  lds
  buffer_load_dwordx4 v23, s[92:95], s46 offen offset:3072  lds
  s_mov_b32 m0, 77824
  s_add_u32 s46, s50, 425984
  buffer_load_dwordx4 v20, s[92:95], s46 offen offset:0  lds
  buffer_load_dwordx4 v21, s[92:95], s46 offen offset:1024  lds
  buffer_load_dwordx4 v22, s[92:95], s46 offen offset:2048  lds
  buffer_load_dwordx4 v23, s[92:95], s46 offen offset:3072  lds
  s_mov_b32 m0, 81920
  s_add_u32 s46, s50, 458752
  buffer_load_dwordx4 v20, s[92:95], s46 offen offset:0  lds
  buffer_load_dwordx4 v21, s[92:95], s46 offen offset:1024  lds
  buffer_load_dwordx4 v22, s[92:95], s46 offen offset:2048  lds
  buffer_load_dwordx4 v23, s[92:95], s46 offen offset:3072  lds
  s_mov_b32 m0, 86016
  s_add_u32 s46, s50, 491520
  buffer_load_dwordx4 v20, s[92:95], s46 offen offset:0  lds
  buffer_load_dwordx4 v21, s[92:95], s46 offen offset:1024  lds
  buffer_load_dwordx4 v22, s[92:95], s46 offen offset:2048  lds
  buffer_load_dwordx4 v23, s[92:95], s46 offen offset:3072  lds
  s_waitcnt vmcnt(16)
  v_mov_b32 v5, 39
  ds_write_b32 v3, v5
  ds_read_b32 v4, v2
  s_movk_i32 s47, 28
  s_waitcnt lgkmcnt(0)
  v_cmp_gt_u32 vcc, 28, v4
  s_cbranch_vccz CK_195
  s_waitcnt vmcnt(0)
  v_mov_b32 v5, 41
  ds_write_b32 v3, v5
  s_call_b64 s[18:19], WAITC
CK_195:
  s_mov_b32 m0, 106496
  s_add_u32 s46, s50, 655360
  buffer_load_dwordx4 v20, s[92:95], s46 offen offset:0  lds
  buffer_load_dwordx4 v21, s[92:95], s46 offen offset:1024  lds
  buffer_load_dwordx4 v22, s[92:95], s46 offen offset:2048  lds
  buffer_load_dwordx4 v23, s[92:95], s46 offen offset:3072  lds
  s_mov_b32 m0, 110592
  s_add_u32 s46, s50, 688128
  buffer_load_dwordx4 v20, s[92:95], s46 offen offset:0  lds
  buffer_load_dwordx4 v21, s[92:95], s46 offen offset:1024  lds
  buffer_load_dwordx4 v22, s[92:95], s46 offen offset:2048  lds
  buffer_load_dwordx4 v23, s[92:95], s46 offen offset:3072  lds
  s_mov_b32 m0, 114688
  s_add_u32 s46, s50, 720896
  buffer_load_dwordx4 v20, s[92:95], s46 offen offset:0  lds
  buffer_load_dwordx4 v21, s[92:95], s46 offen offset:1024  lds
  buffer_load_dwordx4 v22, s[92:95], s46 offen offset:2048  lds
  buffer_load_dwordx4 v23, s[92:95], s46 offen offset:3072  lds
  s_mov_b32 m0, 118784
  s_add_u32 s46, s50, 753664
  buffer_load_dwordx4 v20, s[92:95], s46 offen offset:0  lds
  buffer_load_dwordx4 v21, s[92:95], s46 offen offset:1024  lds
  buffer_load_dwordx4 v22, s[92:95], s46 offen offset:2048  lds
  buffer_load_dwordx4 v23, s[92:95], s46 offen offset:3072  lds
  s_waitcnt vmcnt(16)
  v_mov_b32 v5, 41
  ds_write_b32 v3, v5
  ds_read_b32 v4, v2
  s_movk_i32 s47, 30
  s_waitcnt lgkmcnt(0)
  v_cmp_gt_u32 vcc, 30, v4
  s_cbranch_vccz CK_196
  s_waitcnt vmcnt(0)
  v_mov_b32 v5, 43
  ds_write_b32 v3, v5
  s_call_b64 s[18:19], WAITC
CK_196:
  s_mov_b32 m0, 139264
  s_add_u32 s46, s50, 917504
  buffer_load_dwordx4 v20, s[92:95], s46 offen offset:0  lds
  buffer_load_dwordx4 v21, s[92:95], s46 offen offset:1024  lds
  buffer_load_dwordx4 v22, s[92:95], s46 offen offset:2048  lds
  buffer_load_dwordx4 v23, s[92:95], s46 offen offset:3072  lds
  s_mov_b32 m0, 143360
  s_add_u32 s46, s50, 950272
  buffer_load_dwordx4 v20, s[92:95], s46 offen offset:0  lds
  buffer_load_dwordx4 v21, s[92:95], s46 offen offset:1024  lds
  buffer_load_dwordx4 v22, s[92:95], s46 offen offset:2048  lds
  buffer_load_dwordx4 v23, s[92:95], s46 offen offset:3072  lds
  s_mov_b32 m0, 147456
  s_add_u32 s46, s50, 983040
  buffer_load_dwordx4 v20, s[92:95], s46 offen offset:0  lds
  buffer_load_dwordx4 v21, s[92:95], s46 offen offset:1024  lds
  buffer_load_dwordx4 v22, s[92:95], s46 offen offset:2048  lds
  buffer_load_dwordx4 v23, s[92:95], s46 offen offset:3072  lds
  s_mov_b32 m0, 151552
  s_add_u32 s46, s50, 1015808
  buffer_load_dwordx4 v20, s[92:95], s46 offen offset:0  lds
  buffer_load_dwordx4 v21, s[92:95], s46 offen offset:1024  lds
  buffer_load_dwordx4 v22, s[92:95], s46 offen offset:2048  lds
  buffer_load_dwordx4 v23, s[92:95], s46 offen offset:3072  lds
  s_waitcnt vmcnt(16)
  v_mov_b32 v5, 43
  ds_write_b32 v3, v5
  ds_read_b32 v4, v2
  s_movk_i32 s47, 33
  s_waitcnt lgkmcnt(0)
  v_cmp_gt_u32 vcc, 33, v4
  s_cbranch_vccz CK_197
  s_waitcnt vmcnt(0)
  v_mov_b32 v5, 45
  ds_write_b32 v3, v5
  s_call_b64 s[18:19], WAITC
CK_197:
  s_mov_b32 m0, 16384
  s_add_u32 s46, s50, 1179648
  buffer_load_dwordx4 v20, s[92:95], s46 offen offset:0  lds
  buffer_load_dwordx4 v21, s[92:95], s46 offen offset:1024  lds
  buffer_load_dwordx4 v22, s[92:95], s46 offen offset:2048  lds
  buffer_load_dwordx4 v23, s[92:95], s46 offen offset:3072  lds
  s_mov_b32 m0, 20480
  s_add_u32 s46, s50, 1212416
  buffer_load_dwordx4 v20, s[92:95], s46 offen offset:0  lds
  buffer_load_dwordx4 v21, s[92:95], s46 offen offset:1024  lds
  buffer_load_dwordx4 v22, s[92:95], s46 offen offset:2048  lds
  buffer_load_dwordx4 v23, s[92:95], s46 offen offset:3072  lds
  s_mov_b32 m0, 24576
  s_add_u32 s46, s50, 1245184
  buffer_load_dwordx4 v20, s[92:95], s46 offen offset:0  lds
  buffer_load_dwordx4 v21, s[92:95], s46 offen offset:1024  lds
  buffer_load_dwordx4 v22, s[92:95], s46 offen offset:2048  lds
  buffer_load_dwordx4 v23, s[92:95], s46 offen offset:3072  lds
  s_mov_b32 m0, 28672
  s_add_u32 s46, s50, 1277952
  buffer_load_dwordx4 v20, s[92:95], s46 offen offset:0  lds
  buffer_load_dwordx4 v21, s[92:95], s46 offen offset:1024  lds
  buffer_load_dwordx4 v22, s[92:95], s46 offen offset:2048  lds
  buffer_load_dwordx4 v23, s[92:95], s46 offen offset:3072  lds
  s_waitcnt vmcnt(16)
  v_mov_b32 v5, 45
  ds_write_b32 v3, v5
  s_waitcnt vmcnt(0)
  v_mov_b32 v5, 47
  ds_write_b32 v3, v5
  s_endpgm
WAITC:
  s_sleep 1
  ds_read_b32 v4, v2
  s_sub_u32 s13, s13, 1
  s_cbranch_scc1 ABORT
  s_waitcnt lgkmcnt(0)
  v_cmp_gt_u32 vcc, s47, v4
  s_cbranch_vccnz WAITC
  s_setpc_b64 s[18:19]
SK3_191a:
  s_waitcnt vmcnt(0)
  v_mov_b32 v5, 28
  ds_write_b32 v3, v5
  s_branch SK3_191
CODE_END:
.section .rodata,"a"
.p2align 6
.amdhsa_kernel adaLN_cond__spectral_fnet__dense_activation_relu__prompt_kernel
  .amdhsa_next_free_vgpr 256
  .amdhsa_next_free_sgpr 102
  .amdhsa_accum_offset 256
  .amdhsa_group_segment_fixed_size 0
  .amdhsa_kernarg_size 104
  .amdhsa_user_sgpr_count 2
  .amdhsa_user_sgpr_kernarg_segment_ptr 1
  .amdhsa_system_sgpr_workgroup_id_x 1
.end_amdhsa_kernel
```
